```python
import torch

def _softmax(x, axis=-1):
    return torch.softmax(x, dim=axis)
def _gelu(x):
    return torch.nn.functional.gelu(x, approximate="tanh")
def _silu(x):
    return torch.nn.functional.silu(x)
def _sigmoid(x):
    return torch.sigmoid(x)
def _layernorm(x, axis=-1, eps=1e-5):
    m = x.mean(dim=axis, keepdim=True)
    v = x.var(dim=axis, keepdim=True, unbiased=False)
    return (x - m) / torch.sqrt(v + eps)
def _scatter_add(tgt, idx, src, axis=0):
    return tgt.clone().index_add_(axis, idx, src)
def _segment_sum(src, seg, n):
    out = torch.zeros((n,) + src.shape[1:], dtype=src.dtype)
    return out.index_add_(0, seg, src)
def _pad(x, pw):
    flat = tuple(v for pair in reversed(pw) for v in pair)
    return torch.nn.functional.pad(x, flat)

kernel_name = 'gated_mix__linear_attn_block__dense_activation_squared_relu__prompt'

def setup_inputs():

    _w = (lambda a: (lambda t: t.to(torch.bfloat16) if t.is_floating_point() else t)(torch.as_tensor(a)))
    def _A_setup():
        B, S, D = 1, 2048, 640
        return {
            "x": _w((lambda *s: torch.randn(*s, dtype=torch.bfloat16) * 0.05)(B, S, D)),
            "wqkv": _w((lambda *s: torch.randn(*s, dtype=torch.bfloat16) * 0.8)(D, 3 * D)),
            "wo": _w((lambda *s: torch.randn(*s, dtype=torch.bfloat16) * 0.2)(D, D)),
        }
    _A_in = _A_setup()

    def _B_setup():
        B, S, D, F = 1, 2048, 640, 1536
        return {
            "x": _w((lambda *s: torch.randn(*s, dtype=torch.bfloat16) * 0.05)(B, S, D)),
            "w1": _w((lambda *s: torch.randn(*s, dtype=torch.bfloat16) * 0.1)(D, F)),
            "b1": _w((lambda *s: torch.randn(*s, dtype=torch.bfloat16) * 0.05)(F)),
            "w2": _w((lambda *s: torch.randn(*s, dtype=torch.bfloat16) * 0.05)(F, D)),
            "b2": _w((lambda *s: torch.randn(*s, dtype=torch.bfloat16) * 0.05)(D)),
        }
    _B_in = _B_setup()

    return {
        "A_x": _A_in["x"],
        "A_wqkv": _A_in["wqkv"],
        "A_wo": _A_in["wo"],
        "B_x": _B_in["x"],
        "B_w1": _B_in["w1"],
        "B_b1": _B_in["b1"],
        "B_w2": _B_in["w2"],
        "B_b2": _B_in["b2"],
        "gate_w": _w((lambda *s: torch.randn(*s, dtype=torch.bfloat16) * 0.05)(640) * 16.0),
    }

def reference(A_x, A_wqkv, A_wo, B_x, B_w1, B_b1, B_w2, B_b2, gate_w):
    def _A_ref(x, wqkv, wo):
        B, S, D = x.shape
        H = 32; Dh = D // H
        qkv = (lambda x, *d: x.permute(*d))((x @ wqkv).reshape(B, S, 3, H, Dh), 2, 0, 3, 1, 4)
        q, k, v = qkv[0], qkv[1], qkv[2]
        phi = lambda t: torch.where(t > 0, t + 1, torch.exp(t)) + 1e-6
        pq, pk = phi(q), phi(k)
        kv = torch.einsum("bhsd,bhse->bhde", pk, v)
        z = torch.einsum("bhsd->bhd", pk)
        num = torch.einsum("bhqd,bhde->bhqe", pq, kv)
        den = torch.einsum("bhqd,bhd->bhq", pq, z)[..., None] + 1e-6
        o = num / den
        return (lambda x, *d: x.permute(*d))(o, 0, 2, 1, 3).reshape(B, S, D) @ wo

    def _B_ref(x, w1, b1, w2, b2):
        h = torch.einsum("bsd,df->bsf", x, w1) + b1
        zero = torch.zeros_like(h)
        r = torch.where(h > zero, h, zero)
        h = r * r
        out = torch.einsum("bsf,fd->bsd", h, w2) + b2
        return out

    x = A_x
    g = _sigmoid((x * gate_w).sum(-1, keepdims=True))
    a = _A_ref(x, A_wqkv, A_wo)
    b = _B_ref(x, B_w1, B_b1, B_w2, B_b2)
    return g * a + (1 - g) * b
```

```asm
; @launch kernel=fused_kernel grid=(256,1,1) block=(512,1,1) lds=163840
.amdgcn_target "amdgcn-amd-amdhsa--gfx950"
.text
.globl fused_kernel
.p2align 8
.type fused_kernel,@function
fused_kernel:
  s_cmp_ge_u32 s2, 256
  s_cbranch_scc1 f_exit
  s_load_dwordx16 s[16:31], s[0:1], 0
  s_load_dwordx8 s[32:39], s[0:1], 64
  s_and_b32 s3, s2, 7
  s_lshr_b32 s4, s2, 3
  s_lshr_b32 s5, s3, 2
  s_lshl_b32 s5, s5, 3
  s_and_b32 s6, s4, 7
  s_add_u32 s5, s5, s6
  s_lshr_b32 s6, s4, 3
  s_and_b32 s7, s3, 3
  s_lshl_b32 s7, s7, 1
  s_and_b32 s8, s6, 1
  s_add_u32 s7, s7, s8
  s_and_b32 s8, s7, 1
  s_lshr_b32 s74, s3, 1
  s_lshl_b32 s74, s74, 3
  s_and_b32 s10, s4, 7
  s_add_u32 s74, s74, s10
  s_and_b32 s75, s3, 1
  s_lshl_b32 s75, s75, 2
  s_add_u32 s75, s75, s6
  v_lshrrev_b32 v1, 6, v0
  v_and_b32 v0, 63, v0
  s_nop 0
  v_readfirstlane_b32 s9, v1
  v_and_b32 v2, 15, v0
  v_lshrrev_b32 v3, 4, v0
  v_lshlrev_b32 v7, 4, v0
  s_and_b32 s73, s74, 7
  s_lshl_b32 s73, s73, 2
  s_and_b32 s10, s75, 3
  s_add_u32 s73, s73, s10
  s_cmp_ge_u32 s9, 4
  s_cbranch_scc0 f_cons
  s_sub_u32 s9, s9, 4
  s_lshl_b32 s10, s5, 7
  s_lshl_b32 s11, s9, 5
  s_add_u32 s10, s10, s11
  v_lshrrev_b32 v14, 3, v0
  v_add_u32 v15, s10, v14
  v_mul_u32_u24 v15, 1280, v15
  v_lshrrev_b32 v14, 1, v14
  v_and_b32 v16, 7, v0
  v_xor_b32 v16, v16, v14
  v_lshl_add_u32 v44, v16, 4, v15
  v_xor_b32 v16, 4, v16
  v_lshl_add_u32 v45, v16, 4, v15
  v_add_u32 v45, 9216, v45
  v_add_u32 v46, 18432, v44
  v_add_u32 v47, 18432, v45
  s_lshl_b32 s14, s9, 12
  s_mul_i32 s15, s9, 3072
  s_add_u32 s15, s15, 65536
  s_and_b32 s68, s5, 7
  s_mul_i32 s69, s6, 3
  s_add_u32 s68, s68, s69
  s_add_u32 s68, s68, s3
  s_cmp_ge_u32 s68, 10
  s_cselect_b32 s69, 10, 0
  s_sub_u32 s68, s68, s69
  s_cmp_ge_u32 s68, 10
  s_cselect_b32 s69, 10, 0
  s_sub_u32 s68, s68, s69
  s_mov_b32 s70, s68
  s_lshl_b32 s68, s68, 1
  s_cmp_ge_u32 s6, 2
  s_cbranch_scc1 fp_h
  s_and_b32 s12, s9, 1
  s_mul_i32 s12, s12, 192
  s_lshr_b32 s13, s9, 1
  s_mul_i32 s10, s7, 160
  s_lshl_b32 s11, s8, 5
  s_sub_u32 s10, s10, s11
  s_mul_i32 s11, s13, 1280
  s_add_u32 s10, s10, s11
  s_add_u32 s10, s10, 1280
  v_add_u32 v19, s12, v0
  v_mul_u32_u24 v20, 5462, v19
  v_lshrrev_b32 v20, 16, v20
  v_mul_u32_u24 v21, 12, v20
  v_sub_u32 v19, v19, v21
  v_bfe_u32 v21, v20, 2, 1
  v_lshlrev_b32 v21, 1, v21
  v_xor_b32 v19, v19, v21
  v_and_b32 v21, 0xffffffe3, v20
  v_bfe_u32 v22, v20, 2, 2
  v_lshl_or_b32 v21, v22, 3, v21
  v_bfe_u32 v23, v20, 4, 1
  v_lshl_or_b32 v21, v23, 2, v21
  v_mul_u32_u24 v21, 3840, v21
  v_lshl_add_u32 v8, v19, 4, v21
  v_add_u32 v8, s10, v8
  v_add_u32 v19, s12, v0
  v_add_u32 v19, 64, v19
  v_mul_u32_u24 v20, 5462, v19
  v_lshrrev_b32 v20, 16, v20
  v_mul_u32_u24 v21, 12, v20
  v_sub_u32 v19, v19, v21
  v_bfe_u32 v21, v20, 2, 1
  v_lshlrev_b32 v21, 1, v21
  v_xor_b32 v19, v19, v21
  v_and_b32 v21, 0xffffffe3, v20
  v_bfe_u32 v22, v20, 2, 2
  v_lshl_or_b32 v21, v22, 3, v21
  v_bfe_u32 v23, v20, 4, 1
  v_lshl_or_b32 v21, v23, 2, v21
  v_mul_u32_u24 v21, 3840, v21
  v_lshl_add_u32 v9, v19, 4, v21
  v_add_u32 v9, s10, v9
  v_subrev_u32 v9, 1024, v9
  v_add_u32 v19, s12, v0
  v_add_u32 v19, 128, v19
  v_mul_u32_u24 v20, 5462, v19
  v_lshrrev_b32 v20, 16, v20
  v_mul_u32_u24 v21, 12, v20
  v_sub_u32 v19, v19, v21
  v_bfe_u32 v21, v20, 2, 1
  v_lshlrev_b32 v21, 1, v21
  v_xor_b32 v19, v19, v21
  v_and_b32 v21, 0xffffffe3, v20
  v_bfe_u32 v22, v20, 2, 2
  v_lshl_or_b32 v21, v22, 3, v21
  v_bfe_u32 v23, v20, 4, 1
  v_lshl_or_b32 v21, v23, 2, v21
  v_mul_u32_u24 v21, 3840, v21
  v_lshl_add_u32 v10, v19, 4, v21
  v_add_u32 v10, s10, v10
  v_subrev_u32 v10, 2048, v10
  s_waitcnt lgkmcnt(0)
  s_mov_b32 s40, s16
  s_and_b32 s41, s17, 0xffff
  s_mov_b32 s42, 0x280000
  s_mov_b32 s43, 0x00020000
  s_mov_b32 s48, s38
  s_and_b32 s49, s39, 0xffff
  s_mov_b32 s50, 0x1200000
  s_mov_b32 s51, 0x00020000
  s_mov_b32 s44, s18
  s_and_b32 s45, s19, 0xffff
  s_mov_b32 s46, 0x258000
  s_mov_b32 s47, 0x00020000
  s_lshl_b32 s52, s70, 7
  s_add_u32 m0, s14, 0
  s_add_u32 s70, s70, 1
  buffer_load_dwordx4 v44, s[40:43], s52 offen offset:0 lds
  buffer_load_dwordx4 v45, s[40:43], s52 offen offset:1024 lds
  buffer_load_dwordx4 v46, s[40:43], s52 offen offset:2048 lds
  buffer_load_dwordx4 v47, s[40:43], s52 offen offset:3072 lds
  s_cmp_ge_u32 s70, 10
  s_cselect_b32 s70, 0, s70
  s_mul_i32 s52, s68, 122880
  s_add_u32 m0, s15, 0
  s_add_u32 s68, s68, 1
  s_cmp_ge_u32 s68, 20
  s_cselect_b32 s68, 0, s68
  buffer_load_dwordx4 v8, s[44:47], s52 offen offset:0 lds
  buffer_load_dwordx4 v9, s[44:47], s52 offen offset:1024 lds
  buffer_load_dwordx4 v10, s[44:47], s52 offen offset:2048 lds
  s_mul_i32 s52, s68, 122880
  s_add_u32 m0, s15, 12288
  s_add_u32 s68, s68, 1
  s_cmp_ge_u32 s68, 20
  s_cselect_b32 s68, 0, s68
  buffer_load_dwordx4 v8, s[44:47], s52 offen offset:0 lds
  buffer_load_dwordx4 v9, s[44:47], s52 offen offset:1024 lds
  buffer_load_dwordx4 v10, s[44:47], s52 offen offset:2048 lds
  s_lshl_b32 s52, s70, 7
  s_add_u32 m0, s14, 16384
  s_add_u32 s70, s70, 1
  buffer_load_dwordx4 v44, s[40:43], s52 offen offset:0 lds
  buffer_load_dwordx4 v45, s[40:43], s52 offen offset:1024 lds
  buffer_load_dwordx4 v46, s[40:43], s52 offen offset:2048 lds
  buffer_load_dwordx4 v47, s[40:43], s52 offen offset:3072 lds
  s_cmp_ge_u32 s70, 10
  s_cselect_b32 s70, 0, s70
  s_mul_i32 s52, s68, 122880
  s_add_u32 m0, s15, 24576
  s_add_u32 s68, s68, 1
  s_cmp_ge_u32 s68, 20
  s_cselect_b32 s68, 0, s68
  buffer_load_dwordx4 v8, s[44:47], s52 offen offset:0 lds
  buffer_load_dwordx4 v9, s[44:47], s52 offen offset:1024 lds
  buffer_load_dwordx4 v10, s[44:47], s52 offen offset:2048 lds
  s_waitcnt vmcnt(10)
  s_barrier
  s_min_u32 s53, s9, 2
  s_mul_i32 s54, s74, 3
  s_add_u32 s54, s54, s53
  s_min_u32 s54, s54, 87
  s_movk_i32 s57, 1280
  s_mov_b32 s66, 0xc8000
  s_cmp_lt_u32 s54, 20
  s_cselect_b32 s64, s18, s20
  s_cselect_b32 s65, s19, s21
  s_cselect_b32 s57, 3840, s57
  s_cselect_b32 s58, 0, 20
  s_cselect_b32 s66, 0x258000, s66
  s_cmp_lt_u32 s54, 40
  s_cselect_b32 s64, s64, s28
  s_cselect_b32 s65, s65, s29
  s_cselect_b32 s58, s58, 40
  s_cselect_b32 s66, s66, 0x1e0000
  s_and_b32 s65, s65, 0xffff
  s_mov_b32 s67, 0x00020000
  s_sub_u32 s58, s54, s58
  s_lshl_b32 s58, s58, 5
  s_mul_i32 s58, s58, s57
  s_mul_i32 s59, s75, 160
  s_and_b32 s60, s75, 1
  s_lshl_b32 s60, s60, 5
  s_sub_u32 s59, s59, s60
  s_add_u32 s58, s58, s59
  s_mul_i32 s59, s53, 6144
  s_add_u32 s59, s59, 139264
  v_add_u32 v19, 0, v0
  v_mul_u32_u24 v20, 5462, v19
  v_lshrrev_b32 v20, 16, v20
  v_mul_u32_u24 v21, 12, v20
  v_sub_u32 v19, v19, v21
  v_bfe_u32 v21, v20, 2, 1
  v_lshlrev_b32 v21, 1, v21
  v_xor_b32 v19, v19, v21
  v_and_b32 v21, 0xffffffe3, v20
  v_bfe_u32 v22, v20, 2, 2
  v_lshl_or_b32 v21, v22, 3, v21
  v_bfe_u32 v23, v20, 4, 1
  v_lshl_or_b32 v21, v23, 2, v21
  v_mul_lo_u32 v21, v21, s57
  v_lshl_add_u32 v19, v19, 4, v21
  s_add_u32 m0, s59, 0
  s_nop 0
  buffer_load_dwordx4 v19, s[64:67], s58 offen lds
  v_add_u32 v19, 64, v0
  v_mul_u32_u24 v20, 5462, v19
  v_lshrrev_b32 v20, 16, v20
  v_mul_u32_u24 v21, 12, v20
  v_sub_u32 v19, v19, v21
  v_bfe_u32 v21, v20, 2, 1
  v_lshlrev_b32 v21, 1, v21
  v_xor_b32 v19, v19, v21
  v_and_b32 v21, 0xffffffe3, v20
  v_bfe_u32 v22, v20, 2, 2
  v_lshl_or_b32 v21, v22, 3, v21
  v_bfe_u32 v23, v20, 4, 1
  v_lshl_or_b32 v21, v23, 2, v21
  v_mul_lo_u32 v21, v21, s57
  v_lshl_add_u32 v19, v19, 4, v21
  s_add_u32 m0, s59, 1024
  s_nop 0
  buffer_load_dwordx4 v19, s[64:67], s58 offen lds
  v_add_u32 v19, 128, v0
  v_mul_u32_u24 v20, 5462, v19
  v_lshrrev_b32 v20, 16, v20
  v_mul_u32_u24 v21, 12, v20
  v_sub_u32 v19, v19, v21
  v_bfe_u32 v21, v20, 2, 1
  v_lshlrev_b32 v21, 1, v21
  v_xor_b32 v19, v19, v21
  v_and_b32 v21, 0xffffffe3, v20
  v_bfe_u32 v22, v20, 2, 2
  v_lshl_or_b32 v21, v22, 3, v21
  v_bfe_u32 v23, v20, 4, 1
  v_lshl_or_b32 v21, v23, 2, v21
  v_mul_lo_u32 v21, v21, s57
  v_lshl_add_u32 v19, v19, 4, v21
  s_add_u32 m0, s59, 2048
  s_nop 0
  buffer_load_dwordx4 v19, s[64:67], s58 offen lds
  v_add_u32 v19, 192, v0
  v_mul_u32_u24 v20, 5462, v19
  v_lshrrev_b32 v20, 16, v20
  v_mul_u32_u24 v21, 12, v20
  v_sub_u32 v19, v19, v21
  v_bfe_u32 v21, v20, 2, 1
  v_lshlrev_b32 v21, 1, v21
  v_xor_b32 v19, v19, v21
  v_and_b32 v21, 0xffffffe3, v20
  v_bfe_u32 v22, v20, 2, 2
  v_lshl_or_b32 v21, v22, 3, v21
  v_bfe_u32 v23, v20, 4, 1
  v_lshl_or_b32 v21, v23, 2, v21
  v_mul_lo_u32 v21, v21, s57
  v_lshl_add_u32 v19, v19, 4, v21
  s_add_u32 m0, s59, 3072
  s_nop 0
  buffer_load_dwordx4 v19, s[64:67], s58 offen lds
  v_add_u32 v19, 256, v0
  v_mul_u32_u24 v20, 5462, v19
  v_lshrrev_b32 v20, 16, v20
  v_mul_u32_u24 v21, 12, v20
  v_sub_u32 v19, v19, v21
  v_bfe_u32 v21, v20, 2, 1
  v_lshlrev_b32 v21, 1, v21
  v_xor_b32 v19, v19, v21
  v_and_b32 v21, 0xffffffe3, v20
  v_bfe_u32 v22, v20, 2, 2
  v_lshl_or_b32 v21, v22, 3, v21
  v_bfe_u32 v23, v20, 4, 1
  v_lshl_or_b32 v21, v23, 2, v21
  v_mul_lo_u32 v21, v21, s57
  v_lshl_add_u32 v19, v19, 4, v21
  s_add_u32 m0, s59, 4096
  s_nop 0
  buffer_load_dwordx4 v19, s[64:67], s58 offen lds
  v_add_u32 v19, 320, v0
  v_mul_u32_u24 v20, 5462, v19
  v_lshrrev_b32 v20, 16, v20
  v_mul_u32_u24 v21, 12, v20
  v_sub_u32 v19, v19, v21
  v_bfe_u32 v21, v20, 2, 1
  v_lshlrev_b32 v21, 1, v21
  v_xor_b32 v19, v19, v21
  v_and_b32 v21, 0xffffffe3, v20
  v_bfe_u32 v22, v20, 2, 2
  v_lshl_or_b32 v21, v22, 3, v21
  v_bfe_u32 v23, v20, 4, 1
  v_lshl_or_b32 v21, v23, 2, v21
  v_mul_lo_u32 v21, v21, s57
  v_lshl_add_u32 v19, v19, 4, v21
  s_add_u32 m0, s59, 5120
  s_nop 0
  buffer_load_dwordx4 v19, s[64:67], s58 offen lds
  s_lshl_b32 s52, s70, 7
  s_add_u32 m0, s14, 32768
  s_add_u32 s70, s70, 1
  buffer_load_dwordx4 v44, s[40:43], s52 offen offset:0 lds
  buffer_load_dwordx4 v45, s[40:43], s52 offen offset:1024 lds
  buffer_load_dwordx4 v46, s[40:43], s52 offen offset:2048 lds
  buffer_load_dwordx4 v47, s[40:43], s52 offen offset:3072 lds
  s_cmp_ge_u32 s70, 10
  s_cselect_b32 s70, 0, s70
  s_mul_i32 s52, s68, 122880
  s_add_u32 m0, s15, 36864
  s_add_u32 s68, s68, 1
  s_cmp_ge_u32 s68, 20
  s_cselect_b32 s68, 0, s68
  buffer_load_dwordx4 v8, s[44:47], s52 offen offset:0 lds
  buffer_load_dwordx4 v9, s[44:47], s52 offen offset:1024 lds
  buffer_load_dwordx4 v10, s[44:47], s52 offen offset:2048 lds
  s_mul_i32 s52, s68, 122880
  s_add_u32 m0, s15, 49152
  s_add_u32 s68, s68, 1
  s_cmp_ge_u32 s68, 20
  s_cselect_b32 s68, 0, s68
  buffer_load_dwordx4 v8, s[44:47], s52 offen offset:0 lds
  buffer_load_dwordx4 v9, s[44:47], s52 offen offset:1024 lds
  buffer_load_dwordx4 v10, s[44:47], s52 offen offset:2048 lds
  s_waitcnt vmcnt(23)
  s_barrier
  s_lshl_b32 s52, s70, 7
  s_add_u32 m0, s14, 49152
  s_add_u32 s70, s70, 1
  buffer_load_dwordx4 v44, s[40:43], s52 offen offset:0 lds
  buffer_load_dwordx4 v45, s[40:43], s52 offen offset:1024 lds
  buffer_load_dwordx4 v46, s[40:43], s52 offen offset:2048 lds
  buffer_load_dwordx4 v47, s[40:43], s52 offen offset:3072 lds
  s_cmp_ge_u32 s70, 10
  s_cselect_b32 s70, 0, s70
  s_mul_i32 s52, s68, 122880
  s_add_u32 m0, s15, 61440
  s_add_u32 s68, s68, 1
  s_cmp_ge_u32 s68, 20
  s_cselect_b32 s68, 0, s68
  buffer_load_dwordx4 v8, s[44:47], s52 offen offset:0 lds
  buffer_load_dwordx4 v9, s[44:47], s52 offen offset:1024 lds
  buffer_load_dwordx4 v10, s[44:47], s52 offen offset:2048 lds
  s_waitcnt vmcnt(17)
  s_barrier
  s_waitcnt vmcnt(10)
  s_barrier
  s_waitcnt vmcnt(7)
  s_barrier
  s_mul_i32 s52, s68, 122880
  s_add_u32 m0, s15, 73728
  s_add_u32 s68, s68, 1
  s_cmp_ge_u32 s68, 20
  s_cselect_b32 s68, 0, s68
  buffer_load_dwordx4 v8, s[44:47], s52 offen offset:0 lds
  buffer_load_dwordx4 v9, s[44:47], s52 offen offset:1024 lds
  buffer_load_dwordx4 v10, s[44:47], s52 offen offset:2048 lds
  s_lshl_b32 s52, s70, 7
  s_add_u32 m0, s14, 0
  s_add_u32 s70, s70, 1
  buffer_load_dwordx4 v44, s[40:43], s52 offen offset:0 lds
  buffer_load_dwordx4 v45, s[40:43], s52 offen offset:1024 lds
  buffer_load_dwordx4 v46, s[40:43], s52 offen offset:2048 lds
  buffer_load_dwordx4 v47, s[40:43], s52 offen offset:3072 lds
  s_cmp_ge_u32 s70, 10
  s_cselect_b32 s70, 0, s70
  s_mul_i32 s52, s68, 122880
  s_add_u32 m0, s15, 86016
  s_add_u32 s68, s68, 1
  s_cmp_ge_u32 s68, 20
  s_cselect_b32 s68, 0, s68
  buffer_load_dwordx4 v8, s[44:47], s52 offen offset:0 lds
  buffer_load_dwordx4 v9, s[44:47], s52 offen offset:1024 lds
  buffer_load_dwordx4 v10, s[44:47], s52 offen offset:2048 lds
  s_waitcnt vmcnt(10)
  s_barrier
  s_mul_i32 s52, s68, 122880
  s_add_u32 m0, s15, 0
  s_add_u32 s68, s68, 1
  s_cmp_ge_u32 s68, 20
  s_cselect_b32 s68, 0, s68
  buffer_load_dwordx4 v8, s[44:47], s52 offen offset:0 lds
  buffer_load_dwordx4 v9, s[44:47], s52 offen offset:1024 lds
  buffer_load_dwordx4 v10, s[44:47], s52 offen offset:2048 lds
  s_lshl_b32 s52, s70, 7
  s_add_u32 m0, s14, 16384
  s_add_u32 s70, s70, 1
  buffer_load_dwordx4 v44, s[40:43], s52 offen offset:0 lds
  buffer_load_dwordx4 v45, s[40:43], s52 offen offset:1024 lds
  buffer_load_dwordx4 v46, s[40:43], s52 offen offset:2048 lds
  buffer_load_dwordx4 v47, s[40:43], s52 offen offset:3072 lds
  s_cmp_ge_u32 s70, 10
  s_cselect_b32 s70, 0, s70
  s_mul_i32 s52, s68, 122880
  s_add_u32 m0, s15, 12288
  s_add_u32 s68, s68, 1
  s_cmp_ge_u32 s68, 20
  s_cselect_b32 s68, 0, s68
  buffer_load_dwordx4 v8, s[44:47], s52 offen offset:0 lds
  buffer_load_dwordx4 v9, s[44:47], s52 offen offset:1024 lds
  buffer_load_dwordx4 v10, s[44:47], s52 offen offset:2048 lds
  s_waitcnt vmcnt(17)
  s_barrier
  s_mul_i32 s52, s68, 122880
  s_add_u32 m0, s15, 24576
  s_add_u32 s68, s68, 1
  s_cmp_ge_u32 s68, 20
  s_cselect_b32 s68, 0, s68
  buffer_load_dwordx4 v8, s[44:47], s52 offen offset:0 lds
  buffer_load_dwordx4 v9, s[44:47], s52 offen offset:1024 lds
  buffer_load_dwordx4 v10, s[44:47], s52 offen offset:2048 lds
  s_mul_i32 s52, s68, 122880
  s_add_u32 m0, s15, 36864
  s_add_u32 s68, s68, 1
  s_cmp_ge_u32 s68, 20
  s_cselect_b32 s68, 0, s68
  buffer_load_dwordx4 v8, s[44:47], s52 offen offset:0 lds
  buffer_load_dwordx4 v9, s[44:47], s52 offen offset:1024 lds
  buffer_load_dwordx4 v10, s[44:47], s52 offen offset:2048 lds
  s_waitcnt vmcnt(16)
  s_barrier
  s_lshl_b32 s52, s70, 7
  s_add_u32 m0, s14, 32768
  s_add_u32 s70, s70, 1
  buffer_load_dwordx4 v44, s[40:43], s52 offen offset:0 lds
  buffer_load_dwordx4 v45, s[40:43], s52 offen offset:1024 lds
  buffer_load_dwordx4 v46, s[40:43], s52 offen offset:2048 lds
  buffer_load_dwordx4 v47, s[40:43], s52 offen offset:3072 lds
  s_cmp_ge_u32 s70, 10
  s_cselect_b32 s70, 0, s70
  s_mul_i32 s52, s68, 122880
  s_add_u32 m0, s15, 49152
  s_add_u32 s68, s68, 1
  s_cmp_ge_u32 s68, 20
  s_cselect_b32 s68, 0, s68
  buffer_load_dwordx4 v8, s[44:47], s52 offen offset:0 lds
  buffer_load_dwordx4 v9, s[44:47], s52 offen offset:1024 lds
  buffer_load_dwordx4 v10, s[44:47], s52 offen offset:2048 lds
  s_mul_i32 s52, s68, 122880
  s_add_u32 m0, s15, 61440
  s_add_u32 s68, s68, 1
  s_cmp_ge_u32 s68, 20
  s_cselect_b32 s68, 0, s68
  buffer_load_dwordx4 v8, s[44:47], s52 offen offset:0 lds
  buffer_load_dwordx4 v9, s[44:47], s52 offen offset:1024 lds
  buffer_load_dwordx4 v10, s[44:47], s52 offen offset:2048 lds
  s_waitcnt vmcnt(23)
  s_barrier
  s_mul_i32 s52, s68, 122880
  s_add_u32 m0, s15, 73728
  s_add_u32 s68, s68, 1
  s_cmp_ge_u32 s68, 20
  s_cselect_b32 s68, 0, s68
  buffer_load_dwordx4 v8, s[44:47], s52 offen offset:0 lds
  buffer_load_dwordx4 v9, s[44:47], s52 offen offset:1024 lds
  buffer_load_dwordx4 v10, s[44:47], s52 offen offset:2048 lds
  s_waitcnt vmcnt(19)
  s_barrier
  s_lshl_b32 s52, s70, 7
  s_add_u32 m0, s14, 49152
  s_add_u32 s70, s70, 1
  buffer_load_dwordx4 v44, s[40:43], s52 offen offset:0 lds
  buffer_load_dwordx4 v45, s[40:43], s52 offen offset:1024 lds
  buffer_load_dwordx4 v46, s[40:43], s52 offen offset:2048 lds
  buffer_load_dwordx4 v47, s[40:43], s52 offen offset:3072 lds
  s_cmp_ge_u32 s70, 10
  s_cselect_b32 s70, 0, s70
  s_mul_i32 s52, s68, 122880
  s_add_u32 m0, s15, 86016
  s_add_u32 s68, s68, 1
  s_cmp_ge_u32 s68, 20
  s_cselect_b32 s68, 0, s68
  buffer_load_dwordx4 v8, s[44:47], s52 offen offset:0 lds
  buffer_load_dwordx4 v9, s[44:47], s52 offen offset:1024 lds
  buffer_load_dwordx4 v10, s[44:47], s52 offen offset:2048 lds
  s_lshl_b32 s10, s75, 7
  s_add_u32 s10, s10, 0x11f0000
  v_mov_b32 v40, s10
  s_mov_b32 s77, 0
  s_waitcnt vmcnt(23)
  s_barrier
  s_mul_i32 s52, s68, 122880
  s_add_u32 m0, s15, 0
  s_add_u32 s68, s68, 1
  s_cmp_ge_u32 s68, 20
  s_cselect_b32 s68, 0, s68
  buffer_load_dwordx4 v8, s[44:47], s52 offen offset:0 lds
  buffer_load_dwordx4 v9, s[44:47], s52 offen offset:1024 lds
  buffer_load_dwordx4 v10, s[44:47], s52 offen offset:2048 lds
  s_waitcnt vmcnt(23)
  s_barrier
  s_lshl_b32 s52, s70, 7
  s_add_u32 m0, s14, 0
  s_add_u32 s70, s70, 1
  buffer_load_dwordx4 v44, s[40:43], s52 offen offset:0 lds
  buffer_load_dwordx4 v45, s[40:43], s52 offen offset:1024 lds
  buffer_load_dwordx4 v46, s[40:43], s52 offen offset:2048 lds
  buffer_load_dwordx4 v47, s[40:43], s52 offen offset:3072 lds
  s_cmp_ge_u32 s70, 10
  s_cselect_b32 s70, 0, s70
  s_mul_i32 s52, s68, 122880
  s_add_u32 m0, s15, 12288
  s_add_u32 s68, s68, 1
  s_cmp_ge_u32 s68, 20
  s_cselect_b32 s68, 0, s68
  buffer_load_dwordx4 v8, s[44:47], s52 offen offset:0 lds
  buffer_load_dwordx4 v9, s[44:47], s52 offen offset:1024 lds
  buffer_load_dwordx4 v10, s[44:47], s52 offen offset:2048 lds
  s_waitcnt vmcnt(23)
  s_barrier
  s_mul_i32 s52, s68, 122880
  s_add_u32 m0, s15, 24576
  s_add_u32 s68, s68, 1
  s_cmp_ge_u32 s68, 20
  s_cselect_b32 s68, 0, s68
  buffer_load_dwordx4 v8, s[44:47], s52 offen offset:0 lds
  buffer_load_dwordx4 v9, s[44:47], s52 offen offset:1024 lds
  buffer_load_dwordx4 v10, s[44:47], s52 offen offset:2048 lds
  s_waitcnt vmcnt(23)
  s_barrier
  s_lshl_b32 s52, s70, 7
  s_add_u32 m0, s14, 16384
  s_add_u32 s70, s70, 1
  buffer_load_dwordx4 v44, s[40:43], s52 offen offset:0 lds
  buffer_load_dwordx4 v45, s[40:43], s52 offen offset:1024 lds
  buffer_load_dwordx4 v46, s[40:43], s52 offen offset:2048 lds
  buffer_load_dwordx4 v47, s[40:43], s52 offen offset:3072 lds
  s_cmp_ge_u32 s70, 10
  s_cselect_b32 s70, 0, s70
  s_mul_i32 s52, s68, 122880
  s_add_u32 m0, s15, 36864
  s_add_u32 s68, s68, 1
  s_cmp_ge_u32 s68, 20
  s_cselect_b32 s68, 0, s68
  buffer_load_dwordx4 v8, s[44:47], s52 offen offset:0 lds
  buffer_load_dwordx4 v9, s[44:47], s52 offen offset:1024 lds
  buffer_load_dwordx4 v10, s[44:47], s52 offen offset:2048 lds
  s_waitcnt vmcnt(23)
  s_barrier
  s_waitcnt vmcnt(20)
  s_barrier
  s_waitcnt vmcnt(13)
  s_barrier
  s_waitcnt vmcnt(10)
  s_barrier
  s_waitcnt vmcnt(3)
  s_barrier
  buffer_load_dword v42, v40, s[48:51], 0 offen sc1
  s_waitcnt vmcnt(1)
  s_barrier
  s_branch fp_tail
fp_h:
  v_lshrrev_b32 v14, 3, v0
  v_and_b32 v15, 3, v14
  v_lshrrev_b32 v16, 2, v14
  v_lshl_add_u32 v15, v16, 3, v15
  v_mul_u32_u24 v8, 3072, v15
  v_bfe_u32 v15, v0, 1, 2
  v_lshrrev_b32 v16, 1, v14
  v_xor_b32 v15, v15, v16
  v_lshl_add_u32 v8, v15, 5, v8
  v_and_b32 v15, 1, v0
  v_lshl_add_u32 v8, v15, 4, v8
  s_and_b32 s12, s9, 1
  s_lshl_b32 s12, s12, 4
  s_lshr_b32 s13, s9, 1
  s_lshl_b32 s13, s13, 2
  s_add_u32 s12, s12, s13
  s_mul_i32 s12, s12, 3072
  s_mul_i32 s13, s7, 384
  s_add_u32 s12, s12, s13
  v_add_u32 v8, s12, v8
  s_waitcnt lgkmcnt(0)
  s_mov_b32 s40, s16
  s_and_b32 s41, s17, 0xffff
  s_mov_b32 s42, 0x280000
  s_mov_b32 s43, 0x00020000
  s_mov_b32 s48, s38
  s_and_b32 s49, s39, 0xffff
  s_mov_b32 s50, 0x1200000
  s_mov_b32 s51, 0x00020000
  s_mov_b32 s44, s24
  s_and_b32 s45, s25, 0xffff
  s_mov_b32 s46, 0x1e0000
  s_mov_b32 s47, 0x00020000
  s_lshl_b32 s52, s70, 7
  s_add_u32 m0, s14, 0
  s_add_u32 s70, s70, 1
  buffer_load_dwordx4 v44, s[40:43], s52 offen offset:0 lds
  buffer_load_dwordx4 v45, s[40:43], s52 offen offset:1024 lds
  buffer_load_dwordx4 v46, s[40:43], s52 offen offset:2048 lds
  buffer_load_dwordx4 v47, s[40:43], s52 offen offset:3072 lds
  s_cmp_ge_u32 s70, 10
  s_cselect_b32 s70, 0, s70
  s_mul_i32 s52, s68, 98304
  s_add_u32 m0, s15, 0
  s_add_u32 s68, s68, 1
  s_cmp_ge_u32 s68, 20
  s_cselect_b32 s68, 0, s68
  buffer_load_dwordx4 v8, s[44:47], s52 offen lds
  s_add_u32 m0, s15, 1024
  s_add_u32 s52, s52, 128
  buffer_load_dwordx4 v8, s[44:47], s52 offen lds
  s_add_u32 m0, s15, 2048
  s_add_u32 s52, s52, 128
  buffer_load_dwordx4 v8, s[44:47], s52 offen lds
  s_mul_i32 s52, s68, 98304
  s_add_u32 m0, s15, 12288
  s_add_u32 s68, s68, 1
  s_cmp_ge_u32 s68, 20
  s_cselect_b32 s68, 0, s68
  buffer_load_dwordx4 v8, s[44:47], s52 offen lds
  s_add_u32 m0, s15, 13312
  s_add_u32 s52, s52, 128
  buffer_load_dwordx4 v8, s[44:47], s52 offen lds
  s_add_u32 m0, s15, 14336
  s_add_u32 s52, s52, 128
  buffer_load_dwordx4 v8, s[44:47], s52 offen lds
  s_lshl_b32 s52, s70, 7
  s_add_u32 m0, s14, 16384
  s_add_u32 s70, s70, 1
  buffer_load_dwordx4 v44, s[40:43], s52 offen offset:0 lds
  buffer_load_dwordx4 v45, s[40:43], s52 offen offset:1024 lds
  buffer_load_dwordx4 v46, s[40:43], s52 offen offset:2048 lds
  buffer_load_dwordx4 v47, s[40:43], s52 offen offset:3072 lds
  s_cmp_ge_u32 s70, 10
  s_cselect_b32 s70, 0, s70
  s_mul_i32 s52, s68, 98304
  s_add_u32 m0, s15, 24576
  s_add_u32 s68, s68, 1
  s_cmp_ge_u32 s68, 20
  s_cselect_b32 s68, 0, s68
  buffer_load_dwordx4 v8, s[44:47], s52 offen lds
  s_add_u32 m0, s15, 25600
  s_add_u32 s52, s52, 128
  buffer_load_dwordx4 v8, s[44:47], s52 offen lds
  s_add_u32 m0, s15, 26624
  s_add_u32 s52, s52, 128
  buffer_load_dwordx4 v8, s[44:47], s52 offen lds
  s_waitcnt vmcnt(10)
  s_barrier
  s_min_u32 s53, s9, 2
  s_mul_i32 s54, s74, 3
  s_add_u32 s54, s54, s53
  s_min_u32 s54, s54, 87
  s_movk_i32 s57, 1280
  s_mov_b32 s66, 0xc8000
  s_cmp_lt_u32 s54, 20
  s_cselect_b32 s64, s18, s20
  s_cselect_b32 s65, s19, s21
  s_cselect_b32 s57, 3840, s57
  s_cselect_b32 s58, 0, 20
  s_cselect_b32 s66, 0x258000, s66
  s_cmp_lt_u32 s54, 40
  s_cselect_b32 s64, s64, s28
  s_cselect_b32 s65, s65, s29
  s_cselect_b32 s58, s58, 40
  s_cselect_b32 s66, s66, 0x1e0000
  s_and_b32 s65, s65, 0xffff
  s_mov_b32 s67, 0x00020000
  s_sub_u32 s58, s54, s58
  s_lshl_b32 s58, s58, 5
  s_mul_i32 s58, s58, s57
  s_mul_i32 s59, s75, 160
  s_and_b32 s60, s75, 1
  s_lshl_b32 s60, s60, 5
  s_sub_u32 s59, s59, s60
  s_add_u32 s58, s58, s59
  s_mul_i32 s59, s53, 6144
  s_add_u32 s59, s59, 139264
  v_add_u32 v19, 0, v0
  v_mul_u32_u24 v20, 5462, v19
  v_lshrrev_b32 v20, 16, v20
  v_mul_u32_u24 v21, 12, v20
  v_sub_u32 v19, v19, v21
  v_bfe_u32 v21, v20, 2, 1
  v_lshlrev_b32 v21, 1, v21
  v_xor_b32 v19, v19, v21
  v_and_b32 v21, 0xffffffe3, v20
  v_bfe_u32 v22, v20, 2, 2
  v_lshl_or_b32 v21, v22, 3, v21
  v_bfe_u32 v23, v20, 4, 1
  v_lshl_or_b32 v21, v23, 2, v21
  v_mul_lo_u32 v21, v21, s57
  v_lshl_add_u32 v19, v19, 4, v21
  s_add_u32 m0, s59, 0
  s_nop 0
  buffer_load_dwordx4 v19, s[64:67], s58 offen lds
  v_add_u32 v19, 64, v0
  v_mul_u32_u24 v20, 5462, v19
  v_lshrrev_b32 v20, 16, v20
  v_mul_u32_u24 v21, 12, v20
  v_sub_u32 v19, v19, v21
  v_bfe_u32 v21, v20, 2, 1
  v_lshlrev_b32 v21, 1, v21
  v_xor_b32 v19, v19, v21
  v_and_b32 v21, 0xffffffe3, v20
  v_bfe_u32 v22, v20, 2, 2
  v_lshl_or_b32 v21, v22, 3, v21
  v_bfe_u32 v23, v20, 4, 1
  v_lshl_or_b32 v21, v23, 2, v21
  v_mul_lo_u32 v21, v21, s57
  v_lshl_add_u32 v19, v19, 4, v21
  s_add_u32 m0, s59, 1024
  s_nop 0
  buffer_load_dwordx4 v19, s[64:67], s58 offen lds
  v_add_u32 v19, 128, v0
  v_mul_u32_u24 v20, 5462, v19
  v_lshrrev_b32 v20, 16, v20
  v_mul_u32_u24 v21, 12, v20
  v_sub_u32 v19, v19, v21
  v_bfe_u32 v21, v20, 2, 1
  v_lshlrev_b32 v21, 1, v21
  v_xor_b32 v19, v19, v21
  v_and_b32 v21, 0xffffffe3, v20
  v_bfe_u32 v22, v20, 2, 2
  v_lshl_or_b32 v21, v22, 3, v21
  v_bfe_u32 v23, v20, 4, 1
  v_lshl_or_b32 v21, v23, 2, v21
  v_mul_lo_u32 v21, v21, s57
  v_lshl_add_u32 v19, v19, 4, v21
  s_add_u32 m0, s59, 2048
  s_nop 0
  buffer_load_dwordx4 v19, s[64:67], s58 offen lds
  v_add_u32 v19, 192, v0
  v_mul_u32_u24 v20, 5462, v19
  v_lshrrev_b32 v20, 16, v20
  v_mul_u32_u24 v21, 12, v20
  v_sub_u32 v19, v19, v21
  v_bfe_u32 v21, v20, 2, 1
  v_lshlrev_b32 v21, 1, v21
  v_xor_b32 v19, v19, v21
  v_and_b32 v21, 0xffffffe3, v20
  v_bfe_u32 v22, v20, 2, 2
  v_lshl_or_b32 v21, v22, 3, v21
  v_bfe_u32 v23, v20, 4, 1
  v_lshl_or_b32 v21, v23, 2, v21
  v_mul_lo_u32 v21, v21, s57
  v_lshl_add_u32 v19, v19, 4, v21
  s_add_u32 m0, s59, 3072
  s_nop 0
  buffer_load_dwordx4 v19, s[64:67], s58 offen lds
  v_add_u32 v19, 256, v0
  v_mul_u32_u24 v20, 5462, v19
  v_lshrrev_b32 v20, 16, v20
  v_mul_u32_u24 v21, 12, v20
  v_sub_u32 v19, v19, v21
  v_bfe_u32 v21, v20, 2, 1
  v_lshlrev_b32 v21, 1, v21
  v_xor_b32 v19, v19, v21
  v_and_b32 v21, 0xffffffe3, v20
  v_bfe_u32 v22, v20, 2, 2
  v_lshl_or_b32 v21, v22, 3, v21
  v_bfe_u32 v23, v20, 4, 1
  v_lshl_or_b32 v21, v23, 2, v21
  v_mul_lo_u32 v21, v21, s57
  v_lshl_add_u32 v19, v19, 4, v21
  s_add_u32 m0, s59, 4096
  s_nop 0
  buffer_load_dwordx4 v19, s[64:67], s58 offen lds
  v_add_u32 v19, 320, v0
  v_mul_u32_u24 v20, 5462, v19
  v_lshrrev_b32 v20, 16, v20
  v_mul_u32_u24 v21, 12, v20
  v_sub_u32 v19, v19, v21
  v_bfe_u32 v21, v20, 2, 1
  v_lshlrev_b32 v21, 1, v21
  v_xor_b32 v19, v19, v21
  v_and_b32 v21, 0xffffffe3, v20
  v_bfe_u32 v22, v20, 2, 2
  v_lshl_or_b32 v21, v22, 3, v21
  v_bfe_u32 v23, v20, 4, 1
  v_lshl_or_b32 v21, v23, 2, v21
  v_mul_lo_u32 v21, v21, s57
  v_lshl_add_u32 v19, v19, 4, v21
  s_add_u32 m0, s59, 5120
  s_nop 0
  buffer_load_dwordx4 v19, s[64:67], s58 offen lds
  s_lshl_b32 s52, s70, 7
  s_add_u32 m0, s14, 32768
  s_add_u32 s70, s70, 1
  buffer_load_dwordx4 v44, s[40:43], s52 offen offset:0 lds
  buffer_load_dwordx4 v45, s[40:43], s52 offen offset:1024 lds
  buffer_load_dwordx4 v46, s[40:43], s52 offen offset:2048 lds
  buffer_load_dwordx4 v47, s[40:43], s52 offen offset:3072 lds
  s_cmp_ge_u32 s70, 10
  s_cselect_b32 s70, 0, s70
  s_mul_i32 s52, s68, 98304
  s_add_u32 m0, s15, 36864
  s_add_u32 s68, s68, 1
  s_cmp_ge_u32 s68, 20
  s_cselect_b32 s68, 0, s68
  buffer_load_dwordx4 v8, s[44:47], s52 offen lds
  s_add_u32 m0, s15, 37888
  s_add_u32 s52, s52, 128
  buffer_load_dwordx4 v8, s[44:47], s52 offen lds
  s_add_u32 m0, s15, 38912
  s_add_u32 s52, s52, 128
  buffer_load_dwordx4 v8, s[44:47], s52 offen lds
  s_mul_i32 s52, s68, 98304
  s_add_u32 m0, s15, 49152
  s_add_u32 s68, s68, 1
  s_cmp_ge_u32 s68, 20
  s_cselect_b32 s68, 0, s68
  buffer_load_dwordx4 v8, s[44:47], s52 offen lds
  s_add_u32 m0, s15, 50176
  s_add_u32 s52, s52, 128
  buffer_load_dwordx4 v8, s[44:47], s52 offen lds
  s_add_u32 m0, s15, 51200
  s_add_u32 s52, s52, 128
  buffer_load_dwordx4 v8, s[44:47], s52 offen lds
  s_waitcnt vmcnt(23)
  s_barrier
  s_lshl_b32 s52, s70, 7
  s_add_u32 m0, s14, 49152
  s_add_u32 s70, s70, 1
  buffer_load_dwordx4 v44, s[40:43], s52 offen offset:0 lds
  buffer_load_dwordx4 v45, s[40:43], s52 offen offset:1024 lds
  buffer_load_dwordx4 v46, s[40:43], s52 offen offset:2048 lds
  buffer_load_dwordx4 v47, s[40:43], s52 offen offset:3072 lds
  s_cmp_ge_u32 s70, 10
  s_cselect_b32 s70, 0, s70
  s_mul_i32 s52, s68, 98304
  s_add_u32 m0, s15, 61440
  s_add_u32 s68, s68, 1
  s_cmp_ge_u32 s68, 20
  s_cselect_b32 s68, 0, s68
  buffer_load_dwordx4 v8, s[44:47], s52 offen lds
  s_add_u32 m0, s15, 62464
  s_add_u32 s52, s52, 128
  buffer_load_dwordx4 v8, s[44:47], s52 offen lds
  s_add_u32 m0, s15, 63488
  s_add_u32 s52, s52, 128
  buffer_load_dwordx4 v8, s[44:47], s52 offen lds
  s_waitcnt vmcnt(17)
  s_barrier
  s_waitcnt vmcnt(10)
  s_barrier
  s_waitcnt vmcnt(7)
  s_barrier
  s_mul_i32 s52, s68, 98304
  s_add_u32 m0, s15, 73728
  s_add_u32 s68, s68, 1
  s_cmp_ge_u32 s68, 20
  s_cselect_b32 s68, 0, s68
  buffer_load_dwordx4 v8, s[44:47], s52 offen lds
  s_add_u32 m0, s15, 74752
  s_add_u32 s52, s52, 128
  buffer_load_dwordx4 v8, s[44:47], s52 offen lds
  s_add_u32 m0, s15, 75776
  s_add_u32 s52, s52, 128
  buffer_load_dwordx4 v8, s[44:47], s52 offen lds
  s_lshl_b32 s52, s70, 7
  s_add_u32 m0, s14, 0
  s_add_u32 s70, s70, 1
  buffer_load_dwordx4 v44, s[40:43], s52 offen offset:0 lds
  buffer_load_dwordx4 v45, s[40:43], s52 offen offset:1024 lds
  buffer_load_dwordx4 v46, s[40:43], s52 offen offset:2048 lds
  buffer_load_dwordx4 v47, s[40:43], s52 offen offset:3072 lds
  s_cmp_ge_u32 s70, 10
  s_cselect_b32 s70, 0, s70
  s_mul_i32 s52, s68, 98304
  s_add_u32 m0, s15, 86016
  s_add_u32 s68, s68, 1
  s_cmp_ge_u32 s68, 20
  s_cselect_b32 s68, 0, s68
  buffer_load_dwordx4 v8, s[44:47], s52 offen lds
  s_add_u32 m0, s15, 87040
  s_add_u32 s52, s52, 128
  buffer_load_dwordx4 v8, s[44:47], s52 offen lds
  s_add_u32 m0, s15, 88064
  s_add_u32 s52, s52, 128
  buffer_load_dwordx4 v8, s[44:47], s52 offen lds
  s_waitcnt vmcnt(10)
  s_barrier
  s_mul_i32 s52, s68, 98304
  s_add_u32 m0, s15, 0
  s_add_u32 s68, s68, 1
  s_cmp_ge_u32 s68, 20
  s_cselect_b32 s68, 0, s68
  buffer_load_dwordx4 v8, s[44:47], s52 offen lds
  s_add_u32 m0, s15, 1024
  s_add_u32 s52, s52, 128
  buffer_load_dwordx4 v8, s[44:47], s52 offen lds
  s_add_u32 m0, s15, 2048
  s_add_u32 s52, s52, 128
  buffer_load_dwordx4 v8, s[44:47], s52 offen lds
  s_lshl_b32 s52, s70, 7
  s_add_u32 m0, s14, 16384
  s_add_u32 s70, s70, 1
  buffer_load_dwordx4 v44, s[40:43], s52 offen offset:0 lds
  buffer_load_dwordx4 v45, s[40:43], s52 offen offset:1024 lds
  buffer_load_dwordx4 v46, s[40:43], s52 offen offset:2048 lds
  buffer_load_dwordx4 v47, s[40:43], s52 offen offset:3072 lds
  s_cmp_ge_u32 s70, 10
  s_cselect_b32 s70, 0, s70
  s_mul_i32 s52, s68, 98304
  s_add_u32 m0, s15, 12288
  s_add_u32 s68, s68, 1
  s_cmp_ge_u32 s68, 20
  s_cselect_b32 s68, 0, s68
  buffer_load_dwordx4 v8, s[44:47], s52 offen lds
  s_add_u32 m0, s15, 13312
  s_add_u32 s52, s52, 128
  buffer_load_dwordx4 v8, s[44:47], s52 offen lds
  s_add_u32 m0, s15, 14336
  s_add_u32 s52, s52, 128
  buffer_load_dwordx4 v8, s[44:47], s52 offen lds
  s_waitcnt vmcnt(17)
  s_barrier
  s_mul_i32 s52, s68, 98304
  s_add_u32 m0, s15, 24576
  s_add_u32 s68, s68, 1
  s_cmp_ge_u32 s68, 20
  s_cselect_b32 s68, 0, s68
  buffer_load_dwordx4 v8, s[44:47], s52 offen lds
  s_add_u32 m0, s15, 25600
  s_add_u32 s52, s52, 128
  buffer_load_dwordx4 v8, s[44:47], s52 offen lds
  s_add_u32 m0, s15, 26624
  s_add_u32 s52, s52, 128
  buffer_load_dwordx4 v8, s[44:47], s52 offen lds
  s_mul_i32 s52, s68, 98304
  s_add_u32 m0, s15, 36864
  s_add_u32 s68, s68, 1
  s_cmp_ge_u32 s68, 20
  s_cselect_b32 s68, 0, s68
  buffer_load_dwordx4 v8, s[44:47], s52 offen lds
  s_add_u32 m0, s15, 37888
  s_add_u32 s52, s52, 128
  buffer_load_dwordx4 v8, s[44:47], s52 offen lds
  s_add_u32 m0, s15, 38912
  s_add_u32 s52, s52, 128
  buffer_load_dwordx4 v8, s[44:47], s52 offen lds
  s_waitcnt vmcnt(16)
  s_barrier
  s_lshl_b32 s52, s70, 7
  s_add_u32 m0, s14, 32768
  s_add_u32 s70, s70, 1
  buffer_load_dwordx4 v44, s[40:43], s52 offen offset:0 lds
  buffer_load_dwordx4 v45, s[40:43], s52 offen offset:1024 lds
  buffer_load_dwordx4 v46, s[40:43], s52 offen offset:2048 lds
  buffer_load_dwordx4 v47, s[40:43], s52 offen offset:3072 lds
  s_cmp_ge_u32 s70, 10
  s_cselect_b32 s70, 0, s70
  s_mul_i32 s52, s68, 98304
  s_add_u32 m0, s15, 49152
  s_add_u32 s68, s68, 1
  s_cmp_ge_u32 s68, 20
  s_cselect_b32 s68, 0, s68
  buffer_load_dwordx4 v8, s[44:47], s52 offen lds
  s_add_u32 m0, s15, 50176
  s_add_u32 s52, s52, 128
  buffer_load_dwordx4 v8, s[44:47], s52 offen lds
  s_add_u32 m0, s15, 51200
  s_add_u32 s52, s52, 128
  buffer_load_dwordx4 v8, s[44:47], s52 offen lds
  s_mul_i32 s52, s68, 98304
  s_add_u32 m0, s15, 61440
  s_add_u32 s68, s68, 1
  s_cmp_ge_u32 s68, 20
  s_cselect_b32 s68, 0, s68
  buffer_load_dwordx4 v8, s[44:47], s52 offen lds
  s_add_u32 m0, s15, 62464
  s_add_u32 s52, s52, 128
  buffer_load_dwordx4 v8, s[44:47], s52 offen lds
  s_add_u32 m0, s15, 63488
  s_add_u32 s52, s52, 128
  buffer_load_dwordx4 v8, s[44:47], s52 offen lds
  s_waitcnt vmcnt(23)
  s_barrier
  s_mul_i32 s52, s68, 98304
  s_add_u32 m0, s15, 73728
  s_add_u32 s68, s68, 1
  s_cmp_ge_u32 s68, 20
  s_cselect_b32 s68, 0, s68
  buffer_load_dwordx4 v8, s[44:47], s52 offen lds
  s_add_u32 m0, s15, 74752
  s_add_u32 s52, s52, 128
  buffer_load_dwordx4 v8, s[44:47], s52 offen lds
  s_add_u32 m0, s15, 75776
  s_add_u32 s52, s52, 128
  buffer_load_dwordx4 v8, s[44:47], s52 offen lds
  s_waitcnt vmcnt(19)
  s_barrier
  s_lshl_b32 s52, s70, 7
  s_add_u32 m0, s14, 49152
  s_add_u32 s70, s70, 1
  buffer_load_dwordx4 v44, s[40:43], s52 offen offset:0 lds
  buffer_load_dwordx4 v45, s[40:43], s52 offen offset:1024 lds
  buffer_load_dwordx4 v46, s[40:43], s52 offen offset:2048 lds
  buffer_load_dwordx4 v47, s[40:43], s52 offen offset:3072 lds
  s_cmp_ge_u32 s70, 10
  s_cselect_b32 s70, 0, s70
  s_mul_i32 s52, s68, 98304
  s_add_u32 m0, s15, 86016
  s_add_u32 s68, s68, 1
  s_cmp_ge_u32 s68, 20
  s_cselect_b32 s68, 0, s68
  buffer_load_dwordx4 v8, s[44:47], s52 offen lds
  s_add_u32 m0, s15, 87040
  s_add_u32 s52, s52, 128
  buffer_load_dwordx4 v8, s[44:47], s52 offen lds
  s_add_u32 m0, s15, 88064
  s_add_u32 s52, s52, 128
  buffer_load_dwordx4 v8, s[44:47], s52 offen lds
  s_lshl_b32 s10, s75, 7
  s_add_u32 s10, s10, 0x11f0000
  v_mov_b32 v40, s10
  s_mov_b32 s77, 0
  s_waitcnt vmcnt(23)
  s_barrier
  s_mul_i32 s52, s68, 98304
  s_add_u32 m0, s15, 0
  s_add_u32 s68, s68, 1
  s_cmp_ge_u32 s68, 20
  s_cselect_b32 s68, 0, s68
  buffer_load_dwordx4 v8, s[44:47], s52 offen lds
  s_add_u32 m0, s15, 1024
  s_add_u32 s52, s52, 128
  buffer_load_dwordx4 v8, s[44:47], s52 offen lds
  s_add_u32 m0, s15, 2048
  s_add_u32 s52, s52, 128
  buffer_load_dwordx4 v8, s[44:47], s52 offen lds
  s_waitcnt vmcnt(23)
  s_barrier
  s_lshl_b32 s52, s70, 7
  s_add_u32 m0, s14, 0
  s_add_u32 s70, s70, 1
  buffer_load_dwordx4 v44, s[40:43], s52 offen offset:0 lds
  buffer_load_dwordx4 v45, s[40:43], s52 offen offset:1024 lds
  buffer_load_dwordx4 v46, s[40:43], s52 offen offset:2048 lds
  buffer_load_dwordx4 v47, s[40:43], s52 offen offset:3072 lds
  s_cmp_ge_u32 s70, 10
  s_cselect_b32 s70, 0, s70
  s_mul_i32 s52, s68, 98304
  s_add_u32 m0, s15, 12288
  s_add_u32 s68, s68, 1
  s_cmp_ge_u32 s68, 20
  s_cselect_b32 s68, 0, s68
  buffer_load_dwordx4 v8, s[44:47], s52 offen lds
  s_add_u32 m0, s15, 13312
  s_add_u32 s52, s52, 128
  buffer_load_dwordx4 v8, s[44:47], s52 offen lds
  s_add_u32 m0, s15, 14336
  s_add_u32 s52, s52, 128
  buffer_load_dwordx4 v8, s[44:47], s52 offen lds
  s_waitcnt vmcnt(23)
  s_barrier
  s_mul_i32 s52, s68, 98304
  s_add_u32 m0, s15, 24576
  s_add_u32 s68, s68, 1
  s_cmp_ge_u32 s68, 20
  s_cselect_b32 s68, 0, s68
  buffer_load_dwordx4 v8, s[44:47], s52 offen lds
  s_add_u32 m0, s15, 25600
  s_add_u32 s52, s52, 128
  buffer_load_dwordx4 v8, s[44:47], s52 offen lds
  s_add_u32 m0, s15, 26624
  s_add_u32 s52, s52, 128
  buffer_load_dwordx4 v8, s[44:47], s52 offen lds
  s_waitcnt vmcnt(23)
  s_barrier
  s_lshl_b32 s52, s70, 7
  s_add_u32 m0, s14, 16384
  s_add_u32 s70, s70, 1
  buffer_load_dwordx4 v44, s[40:43], s52 offen offset:0 lds
  buffer_load_dwordx4 v45, s[40:43], s52 offen offset:1024 lds
  buffer_load_dwordx4 v46, s[40:43], s52 offen offset:2048 lds
  buffer_load_dwordx4 v47, s[40:43], s52 offen offset:3072 lds
  s_cmp_ge_u32 s70, 10
  s_cselect_b32 s70, 0, s70
  s_mul_i32 s52, s68, 98304
  s_add_u32 m0, s15, 36864
  s_add_u32 s68, s68, 1
  s_cmp_ge_u32 s68, 20
  s_cselect_b32 s68, 0, s68
  buffer_load_dwordx4 v8, s[44:47], s52 offen lds
  s_add_u32 m0, s15, 37888
  s_add_u32 s52, s52, 128
  buffer_load_dwordx4 v8, s[44:47], s52 offen lds
  s_add_u32 m0, s15, 38912
  s_add_u32 s52, s52, 128
  buffer_load_dwordx4 v8, s[44:47], s52 offen lds
  s_waitcnt vmcnt(23)
  s_barrier
  s_waitcnt vmcnt(20)
  s_barrier
  s_waitcnt vmcnt(13)
  s_barrier
  s_waitcnt vmcnt(10)
  s_barrier
  s_waitcnt vmcnt(3)
  s_barrier
  buffer_load_dword v42, v40, s[48:51], 0 offen sc1
  s_waitcnt vmcnt(1)
  s_barrier
fp_tail:
  s_barrier
  s_cmp_eq_u32 s9, 3
  s_cbranch_scc1 fp_helper
  s_cmp_eq_u32 s9, 1
  s_cbranch_scc1 fp_p1
  s_cmp_eq_u32 s9, 2
  s_cbranch_scc1 fp_p2
  s_waitcnt vmcnt(0)
  v_readfirstlane_b32 s72, v42
  s_cmp_ge_u32 s72, 32
  s_cbranch_scc1 fp0_rw_done
fp0_rw:
  buffer_load_dword v21, v40, s[48:51], 0 offen sc1
  s_waitcnt vmcnt(0)
  v_readfirstlane_b32 s72, v21
  s_cmp_ge_u32 s72, 32
  s_cbranch_scc1 fp0_rw_done
  s_sleep 8
  s_branch fp0_rw
fp0_rw_done:
  s_mul_i32 s69, s73, 10
  s_lshr_b32 s69, s69, 5
  s_mul_i32 s60, s75, 102400
  s_add_u32 s60, s60, 0xe00000
  s_lshl_b32 s61, s74, 6
  v_lshrrev_b32 v14, 3, v0
  v_add_u32 v15, s61, v14
  v_mul_u32_u24 v15, 1280, v15
  v_lshrrev_b32 v14, 1, v14
  v_and_b32 v16, 7, v0
  v_xor_b32 v16, v16, v14
  v_lshl_add_u32 v17, v16, 4, v15
  v_xor_b32 v16, 4, v16
  v_lshl_add_u32 v18, v16, 4, v15
  s_add_u32 s10, s60, 0x0
  v_add_u32 v8, s10, v7
  s_add_u32 s10, s60, 0x0
  v_add_u32 v9, s10, v7
  s_add_u32 s10, s60, 0x0
  v_add_u32 v10, s10, v7
  s_add_u32 s10, s60, 0x0
  v_add_u32 v11, s10, v7
  s_add_u32 s10, s60, 0x1000
  v_add_u32 v12, s10, v7
  s_add_u32 s10, s60, 0x1000
  v_add_u32 v13, s10, v7
  s_mul_i32 s62, s69, 10240
  s_mov_b32 m0, 0
  s_nop 0
  buffer_load_dwordx4 v8, s[48:51], s62 offen offset:0 sc1 lds
  buffer_load_dwordx4 v9, s[48:51], s62 offen offset:1024 sc1 lds
  buffer_load_dwordx4 v10, s[48:51], s62 offen offset:2048 sc1 lds
  buffer_load_dwordx4 v11, s[48:51], s62 offen offset:3072 sc1 lds
  s_mov_b32 m0, 4096
  s_nop 0
  buffer_load_dwordx4 v12, s[48:51], s62 offen offset:0 sc1 lds
  buffer_load_dwordx4 v13, s[48:51], s62 offen offset:1024 sc1 lds
  s_add_u32 s69, s69, 1
  s_cmp_ge_u32 s69, 10
  s_cselect_b32 s69, 0, s69
  s_mul_i32 s62, s69, 10240
  s_mov_b32 m0, 18432
  s_nop 0
  buffer_load_dwordx4 v8, s[48:51], s62 offen offset:0 sc1 lds
  buffer_load_dwordx4 v9, s[48:51], s62 offen offset:1024 sc1 lds
  buffer_load_dwordx4 v10, s[48:51], s62 offen offset:2048 sc1 lds
  buffer_load_dwordx4 v11, s[48:51], s62 offen offset:3072 sc1 lds
  s_mov_b32 m0, 22528
  s_nop 0
  buffer_load_dwordx4 v12, s[48:51], s62 offen offset:0 sc1 lds
  buffer_load_dwordx4 v13, s[48:51], s62 offen offset:1024 sc1 lds
  s_add_u32 s69, s69, 1
  s_cmp_ge_u32 s69, 10
  s_cselect_b32 s69, 0, s69
  s_mul_i32 s62, s69, 10240
  s_mov_b32 m0, 36864
  s_nop 0
  buffer_load_dwordx4 v8, s[48:51], s62 offen offset:0 sc1 lds
  buffer_load_dwordx4 v9, s[48:51], s62 offen offset:1024 sc1 lds
  buffer_load_dwordx4 v10, s[48:51], s62 offen offset:2048 sc1 lds
  buffer_load_dwordx4 v11, s[48:51], s62 offen offset:3072 sc1 lds
  s_mov_b32 m0, 40960
  s_nop 0
  buffer_load_dwordx4 v12, s[48:51], s62 offen offset:0 sc1 lds
  buffer_load_dwordx4 v13, s[48:51], s62 offen offset:1024 sc1 lds
  s_add_u32 s69, s69, 1
  s_cmp_ge_u32 s69, 10
  s_cselect_b32 s69, 0, s69
  s_mul_i32 s62, s69, 10240
  s_mov_b32 m0, 55296
  s_nop 0
  buffer_load_dwordx4 v8, s[48:51], s62 offen offset:0 sc1 lds
  buffer_load_dwordx4 v9, s[48:51], s62 offen offset:1024 sc1 lds
  buffer_load_dwordx4 v10, s[48:51], s62 offen offset:2048 sc1 lds
  buffer_load_dwordx4 v11, s[48:51], s62 offen offset:3072 sc1 lds
  s_mov_b32 m0, 59392
  s_nop 0
  buffer_load_dwordx4 v12, s[48:51], s62 offen offset:0 sc1 lds
  buffer_load_dwordx4 v13, s[48:51], s62 offen offset:1024 sc1 lds
  s_add_u32 s69, s69, 1
  s_cmp_ge_u32 s69, 10
  s_cselect_b32 s69, 0, s69
  s_cmp_ge_u32 s6, 2
  s_cbranch_scc1 fp0_noe
  s_barrier
  s_barrier
fp0_noe:
  s_mul_i32 s62, s69, 10240
  s_mov_b32 m0, 73728
  s_nop 0
  buffer_load_dwordx4 v8, s[48:51], s62 offen offset:0 sc1 lds
  buffer_load_dwordx4 v9, s[48:51], s62 offen offset:1024 sc1 lds
  buffer_load_dwordx4 v10, s[48:51], s62 offen offset:2048 sc1 lds
  buffer_load_dwordx4 v11, s[48:51], s62 offen offset:3072 sc1 lds
  s_mov_b32 m0, 77824
  s_nop 0
  buffer_load_dwordx4 v12, s[48:51], s62 offen offset:0 sc1 lds
  buffer_load_dwordx4 v13, s[48:51], s62 offen offset:1024 sc1 lds
  s_add_u32 s69, s69, 1
  s_cmp_ge_u32 s69, 10
  s_cselect_b32 s69, 0, s69
  s_mul_i32 s62, s69, 10240
  s_mov_b32 m0, 92160
  s_nop 0
  buffer_load_dwordx4 v8, s[48:51], s62 offen offset:0 sc1 lds
  buffer_load_dwordx4 v9, s[48:51], s62 offen offset:1024 sc1 lds
  buffer_load_dwordx4 v10, s[48:51], s62 offen offset:2048 sc1 lds
  buffer_load_dwordx4 v11, s[48:51], s62 offen offset:3072 sc1 lds
  s_mov_b32 m0, 96256
  s_nop 0
  buffer_load_dwordx4 v12, s[48:51], s62 offen offset:0 sc1 lds
  buffer_load_dwordx4 v13, s[48:51], s62 offen offset:1024 sc1 lds
  s_add_u32 s69, s69, 1
  s_cmp_ge_u32 s69, 10
  s_cselect_b32 s69, 0, s69
  s_waitcnt vmcnt(30)
  s_barrier
  s_mul_i32 s62, s69, 10240
  s_mov_b32 m0, 110592
  s_nop 0
  buffer_load_dwordx4 v8, s[48:51], s62 offen offset:0 sc1 lds
  buffer_load_dwordx4 v9, s[48:51], s62 offen offset:1024 sc1 lds
  buffer_load_dwordx4 v10, s[48:51], s62 offen offset:2048 sc1 lds
  buffer_load_dwordx4 v11, s[48:51], s62 offen offset:3072 sc1 lds
  s_mov_b32 m0, 114688
  s_nop 0
  buffer_load_dwordx4 v12, s[48:51], s62 offen offset:0 sc1 lds
  buffer_load_dwordx4 v13, s[48:51], s62 offen offset:1024 sc1 lds
  s_add_u32 s69, s69, 1
  s_cmp_ge_u32 s69, 10
  s_cselect_b32 s69, 0, s69
  s_waitcnt vmcnt(30)
  s_barrier
  s_waitcnt vmcnt(24)
  s_barrier
  s_mul_i32 s62, s69, 10240
  s_mov_b32 m0, 0
  s_nop 0
  buffer_load_dwordx4 v8, s[48:51], s62 offen offset:0 sc1 lds
  buffer_load_dwordx4 v9, s[48:51], s62 offen offset:1024 sc1 lds
  buffer_load_dwordx4 v10, s[48:51], s62 offen offset:2048 sc1 lds
  buffer_load_dwordx4 v11, s[48:51], s62 offen offset:3072 sc1 lds
  s_mov_b32 m0, 4096
  s_nop 0
  buffer_load_dwordx4 v12, s[48:51], s62 offen offset:0 sc1 lds
  buffer_load_dwordx4 v13, s[48:51], s62 offen offset:1024 sc1 lds
  s_add_u32 s69, s69, 1
  s_cmp_ge_u32 s69, 10
  s_cselect_b32 s69, 0, s69
  s_waitcnt vmcnt(24)
  s_barrier
  s_mul_i32 s62, s69, 10240
  s_mov_b32 m0, 18432
  s_nop 0
  buffer_load_dwordx4 v8, s[48:51], s62 offen offset:0 sc1 lds
  buffer_load_dwordx4 v9, s[48:51], s62 offen offset:1024 sc1 lds
  buffer_load_dwordx4 v10, s[48:51], s62 offen offset:2048 sc1 lds
  buffer_load_dwordx4 v11, s[48:51], s62 offen offset:3072 sc1 lds
  s_mov_b32 m0, 22528
  s_nop 0
  buffer_load_dwordx4 v12, s[48:51], s62 offen offset:0 sc1 lds
  buffer_load_dwordx4 v13, s[48:51], s62 offen offset:1024 sc1 lds
  s_add_u32 s69, s69, 1
  s_cmp_ge_u32 s69, 10
  s_cselect_b32 s69, 0, s69
  s_waitcnt vmcnt(24)
  s_barrier
  s_mul_i32 s62, s69, 10240
  s_mov_b32 m0, 36864
  s_nop 0
  buffer_load_dwordx4 v8, s[48:51], s62 offen offset:0 sc1 lds
  buffer_load_dwordx4 v9, s[48:51], s62 offen offset:1024 sc1 lds
  buffer_load_dwordx4 v10, s[48:51], s62 offen offset:2048 sc1 lds
  buffer_load_dwordx4 v11, s[48:51], s62 offen offset:3072 sc1 lds
  s_mov_b32 m0, 40960
  s_nop 0
  buffer_load_dwordx4 v12, s[48:51], s62 offen offset:0 sc1 lds
  buffer_load_dwordx4 v13, s[48:51], s62 offen offset:1024 sc1 lds
  s_add_u32 s69, s69, 1
  s_cmp_ge_u32 s69, 10
  s_cselect_b32 s69, 0, s69
  s_waitcnt vmcnt(24)
  s_barrier
  s_lshr_b32 s69, s73, 2
  s_mul_i32 s69, s69, 3
  s_mul_i32 s60, s75, 348160
  s_add_u32 s60, s60, 0xf19000
  s_lshl_b32 s61, s74, 2
  s_mul_i32 s61, s61, 69760
  s_add_u32 s61, s61, 0x6000
  s_add_u32 s10, s60, 0x0
  v_add_u32 v8, s10, v7
  s_add_u32 s10, s60, 0x0
  v_add_u32 v9, s10, v7
  s_add_u32 s10, s60, 0x0
  v_add_u32 v10, s10, v7
  s_add_u32 s10, s60, 0x0
  v_add_u32 v11, s10, v7
  s_add_u32 s10, s60, 0x1000
  v_add_u32 v12, s10, v7
  s_add_u32 s10, s60, 0x1000
  v_add_u32 v13, s10, v7
  s_mul_i32 s62, s69, 10240
  s_mov_b32 m0, 55296
  s_nop 0
  buffer_load_dwordx4 v8, s[48:51], s62 offen offset:0 sc1 lds
  buffer_load_dwordx4 v9, s[48:51], s62 offen offset:1024 sc1 lds
  buffer_load_dwordx4 v10, s[48:51], s62 offen offset:2048 sc1 lds
  buffer_load_dwordx4 v11, s[48:51], s62 offen offset:3072 sc1 lds
  s_mov_b32 m0, 59392
  s_nop 0
  buffer_load_dwordx4 v12, s[48:51], s62 offen offset:0 sc1 lds
  buffer_load_dwordx4 v13, s[48:51], s62 offen offset:1024 sc1 lds
  s_add_u32 s69, s69, 1
  s_cmp_ge_u32 s69, 24
  s_cselect_b32 s69, 0, s69
  s_waitcnt vmcnt(24)
  s_barrier
  s_mul_i32 s62, s69, 10240
  s_mov_b32 m0, 73728
  s_nop 0
  buffer_load_dwordx4 v8, s[48:51], s62 offen offset:0 sc1 lds
  buffer_load_dwordx4 v9, s[48:51], s62 offen offset:1024 sc1 lds
  buffer_load_dwordx4 v10, s[48:51], s62 offen offset:2048 sc1 lds
  buffer_load_dwordx4 v11, s[48:51], s62 offen offset:3072 sc1 lds
  s_mov_b32 m0, 77824
  s_nop 0
  buffer_load_dwordx4 v12, s[48:51], s62 offen offset:0 sc1 lds
  buffer_load_dwordx4 v13, s[48:51], s62 offen offset:1024 sc1 lds
  s_add_u32 s69, s69, 1
  s_cmp_ge_u32 s69, 24
  s_cselect_b32 s69, 0, s69
  s_waitcnt vmcnt(24)
  s_barrier
  s_mul_i32 s62, s69, 10240
  s_mov_b32 m0, 92160
  s_nop 0
  buffer_load_dwordx4 v8, s[48:51], s62 offen offset:0 sc1 lds
  buffer_load_dwordx4 v9, s[48:51], s62 offen offset:1024 sc1 lds
  buffer_load_dwordx4 v10, s[48:51], s62 offen offset:2048 sc1 lds
  buffer_load_dwordx4 v11, s[48:51], s62 offen offset:3072 sc1 lds
  s_mov_b32 m0, 96256
  s_nop 0
  buffer_load_dwordx4 v12, s[48:51], s62 offen offset:0 sc1 lds
  buffer_load_dwordx4 v13, s[48:51], s62 offen offset:1024 sc1 lds
  s_add_u32 s69, s69, 1
  s_cmp_ge_u32 s69, 24
  s_cselect_b32 s69, 0, s69
  s_waitcnt vmcnt(24)
  s_barrier
  s_mul_i32 s62, s69, 10240
  s_mov_b32 m0, 110592
  s_nop 0
  buffer_load_dwordx4 v8, s[48:51], s62 offen offset:0 sc1 lds
  buffer_load_dwordx4 v9, s[48:51], s62 offen offset:1024 sc1 lds
  buffer_load_dwordx4 v10, s[48:51], s62 offen offset:2048 sc1 lds
  buffer_load_dwordx4 v11, s[48:51], s62 offen offset:3072 sc1 lds
  s_mov_b32 m0, 114688
  s_nop 0
  buffer_load_dwordx4 v12, s[48:51], s62 offen offset:0 sc1 lds
  buffer_load_dwordx4 v13, s[48:51], s62 offen offset:1024 sc1 lds
  s_add_u32 s69, s69, 1
  s_cmp_ge_u32 s69, 24
  s_cselect_b32 s69, 0, s69
  s_waitcnt vmcnt(24)
  s_barrier
  s_mul_i32 s62, s69, 10240
  s_mov_b32 m0, 0
  s_nop 0
  buffer_load_dwordx4 v8, s[48:51], s62 offen offset:0 sc1 lds
  buffer_load_dwordx4 v9, s[48:51], s62 offen offset:1024 sc1 lds
  buffer_load_dwordx4 v10, s[48:51], s62 offen offset:2048 sc1 lds
  buffer_load_dwordx4 v11, s[48:51], s62 offen offset:3072 sc1 lds
  s_mov_b32 m0, 4096
  s_nop 0
  buffer_load_dwordx4 v12, s[48:51], s62 offen offset:0 sc1 lds
  buffer_load_dwordx4 v13, s[48:51], s62 offen offset:1024 sc1 lds
  s_add_u32 s69, s69, 1
  s_cmp_ge_u32 s69, 24
  s_cselect_b32 s69, 0, s69
  s_waitcnt vmcnt(24)
  s_barrier
  s_mul_i32 s62, s69, 10240
  s_mov_b32 m0, 18432
  s_nop 0
  buffer_load_dwordx4 v8, s[48:51], s62 offen offset:0 sc1 lds
  buffer_load_dwordx4 v9, s[48:51], s62 offen offset:1024 sc1 lds
  buffer_load_dwordx4 v10, s[48:51], s62 offen offset:2048 sc1 lds
  buffer_load_dwordx4 v11, s[48:51], s62 offen offset:3072 sc1 lds
  s_mov_b32 m0, 22528
  s_nop 0
  buffer_load_dwordx4 v12, s[48:51], s62 offen offset:0 sc1 lds
  buffer_load_dwordx4 v13, s[48:51], s62 offen offset:1024 sc1 lds
  s_add_u32 s69, s69, 1
  s_cmp_ge_u32 s69, 24
  s_cselect_b32 s69, 0, s69
  s_waitcnt vmcnt(24)
  s_barrier
  s_mul_i32 s62, s69, 10240
  s_mov_b32 m0, 36864
  s_nop 0
  buffer_load_dwordx4 v8, s[48:51], s62 offen offset:0 sc1 lds
  buffer_load_dwordx4 v9, s[48:51], s62 offen offset:1024 sc1 lds
  buffer_load_dwordx4 v10, s[48:51], s62 offen offset:2048 sc1 lds
  buffer_load_dwordx4 v11, s[48:51], s62 offen offset:3072 sc1 lds
  s_mov_b32 m0, 40960
  s_nop 0
  buffer_load_dwordx4 v12, s[48:51], s62 offen offset:0 sc1 lds
  buffer_load_dwordx4 v13, s[48:51], s62 offen offset:1024 sc1 lds
  s_add_u32 s69, s69, 1
  s_cmp_ge_u32 s69, 24
  s_cselect_b32 s69, 0, s69
  s_waitcnt vmcnt(24)
  s_barrier
  s_mul_i32 s62, s69, 10240
  s_mov_b32 m0, 55296
  s_nop 0
  buffer_load_dwordx4 v8, s[48:51], s62 offen offset:0 sc1 lds
  buffer_load_dwordx4 v9, s[48:51], s62 offen offset:1024 sc1 lds
  buffer_load_dwordx4 v10, s[48:51], s62 offen offset:2048 sc1 lds
  buffer_load_dwordx4 v11, s[48:51], s62 offen offset:3072 sc1 lds
  s_mov_b32 m0, 59392
  s_nop 0
  buffer_load_dwordx4 v12, s[48:51], s62 offen offset:0 sc1 lds
  buffer_load_dwordx4 v13, s[48:51], s62 offen offset:1024 sc1 lds
  s_add_u32 s69, s69, 1
  s_cmp_ge_u32 s69, 24
  s_cselect_b32 s69, 0, s69
  s_waitcnt vmcnt(24)
  s_barrier
  s_mul_i32 s62, s69, 10240
  s_mov_b32 m0, 73728
  s_nop 0
  buffer_load_dwordx4 v8, s[48:51], s62 offen offset:0 sc1 lds
  buffer_load_dwordx4 v9, s[48:51], s62 offen offset:1024 sc1 lds
  buffer_load_dwordx4 v10, s[48:51], s62 offen offset:2048 sc1 lds
  buffer_load_dwordx4 v11, s[48:51], s62 offen offset:3072 sc1 lds
  s_mov_b32 m0, 77824
  s_nop 0
  buffer_load_dwordx4 v12, s[48:51], s62 offen offset:0 sc1 lds
  buffer_load_dwordx4 v13, s[48:51], s62 offen offset:1024 sc1 lds
  s_add_u32 s69, s69, 1
  s_cmp_ge_u32 s69, 24
  s_cselect_b32 s69, 0, s69
  s_waitcnt vmcnt(24)
  s_barrier
  s_mul_i32 s62, s69, 10240
  s_mov_b32 m0, 92160
  s_nop 0
  buffer_load_dwordx4 v8, s[48:51], s62 offen offset:0 sc1 lds
  buffer_load_dwordx4 v9, s[48:51], s62 offen offset:1024 sc1 lds
  buffer_load_dwordx4 v10, s[48:51], s62 offen offset:2048 sc1 lds
  buffer_load_dwordx4 v11, s[48:51], s62 offen offset:3072 sc1 lds
  s_mov_b32 m0, 96256
  s_nop 0
  buffer_load_dwordx4 v12, s[48:51], s62 offen offset:0 sc1 lds
  buffer_load_dwordx4 v13, s[48:51], s62 offen offset:1024 sc1 lds
  s_add_u32 s69, s69, 1
  s_cmp_ge_u32 s69, 24
  s_cselect_b32 s69, 0, s69
  s_waitcnt vmcnt(24)
  s_barrier
  s_mul_i32 s62, s69, 10240
  s_mov_b32 m0, 110592
  s_nop 0
  buffer_load_dwordx4 v8, s[48:51], s62 offen offset:0 sc1 lds
  buffer_load_dwordx4 v9, s[48:51], s62 offen offset:1024 sc1 lds
  buffer_load_dwordx4 v10, s[48:51], s62 offen offset:2048 sc1 lds
  buffer_load_dwordx4 v11, s[48:51], s62 offen offset:3072 sc1 lds
  s_mov_b32 m0, 114688
  s_nop 0
  buffer_load_dwordx4 v12, s[48:51], s62 offen offset:0 sc1 lds
  buffer_load_dwordx4 v13, s[48:51], s62 offen offset:1024 sc1 lds
  s_add_u32 s69, s69, 1
  s_cmp_ge_u32 s69, 24
  s_cselect_b32 s69, 0, s69
  s_waitcnt vmcnt(24)
  s_barrier
  s_mul_i32 s62, s69, 10240
  s_mov_b32 m0, 0
  s_nop 0
  buffer_load_dwordx4 v8, s[48:51], s62 offen offset:0 sc1 lds
  buffer_load_dwordx4 v9, s[48:51], s62 offen offset:1024 sc1 lds
  buffer_load_dwordx4 v10, s[48:51], s62 offen offset:2048 sc1 lds
  buffer_load_dwordx4 v11, s[48:51], s62 offen offset:3072 sc1 lds
  s_mov_b32 m0, 4096
  s_nop 0
  buffer_load_dwordx4 v12, s[48:51], s62 offen offset:0 sc1 lds
  buffer_load_dwordx4 v13, s[48:51], s62 offen offset:1024 sc1 lds
  s_add_u32 s69, s69, 1
  s_cmp_ge_u32 s69, 24
  s_cselect_b32 s69, 0, s69
  s_waitcnt vmcnt(24)
  s_barrier
  s_mul_i32 s62, s69, 10240
  s_mov_b32 m0, 18432
  s_nop 0
  buffer_load_dwordx4 v8, s[48:51], s62 offen offset:0 sc1 lds
  buffer_load_dwordx4 v9, s[48:51], s62 offen offset:1024 sc1 lds
  buffer_load_dwordx4 v10, s[48:51], s62 offen offset:2048 sc1 lds
  buffer_load_dwordx4 v11, s[48:51], s62 offen offset:3072 sc1 lds
  s_mov_b32 m0, 22528
  s_nop 0
  buffer_load_dwordx4 v12, s[48:51], s62 offen offset:0 sc1 lds
  buffer_load_dwordx4 v13, s[48:51], s62 offen offset:1024 sc1 lds
  s_add_u32 s69, s69, 1
  s_cmp_ge_u32 s69, 24
  s_cselect_b32 s69, 0, s69
  s_waitcnt vmcnt(24)
  s_barrier
  s_mul_i32 s62, s69, 10240
  s_mov_b32 m0, 36864
  s_nop 0
  buffer_load_dwordx4 v8, s[48:51], s62 offen offset:0 sc1 lds
  buffer_load_dwordx4 v9, s[48:51], s62 offen offset:1024 sc1 lds
  buffer_load_dwordx4 v10, s[48:51], s62 offen offset:2048 sc1 lds
  buffer_load_dwordx4 v11, s[48:51], s62 offen offset:3072 sc1 lds
  s_mov_b32 m0, 40960
  s_nop 0
  buffer_load_dwordx4 v12, s[48:51], s62 offen offset:0 sc1 lds
  buffer_load_dwordx4 v13, s[48:51], s62 offen offset:1024 sc1 lds
  s_add_u32 s69, s69, 1
  s_cmp_ge_u32 s69, 24
  s_cselect_b32 s69, 0, s69
  s_waitcnt vmcnt(24)
  s_barrier
  s_mul_i32 s62, s69, 10240
  s_mov_b32 m0, 55296
  s_nop 0
  buffer_load_dwordx4 v8, s[48:51], s62 offen offset:0 sc1 lds
  buffer_load_dwordx4 v9, s[48:51], s62 offen offset:1024 sc1 lds
  buffer_load_dwordx4 v10, s[48:51], s62 offen offset:2048 sc1 lds
  buffer_load_dwordx4 v11, s[48:51], s62 offen offset:3072 sc1 lds
  s_mov_b32 m0, 59392
  s_nop 0
  buffer_load_dwordx4 v12, s[48:51], s62 offen offset:0 sc1 lds
  buffer_load_dwordx4 v13, s[48:51], s62 offen offset:1024 sc1 lds
  s_add_u32 s69, s69, 1
  s_cmp_ge_u32 s69, 24
  s_cselect_b32 s69, 0, s69
  s_barrier
  s_waitcnt vmcnt(24)
  s_barrier
  s_mul_i32 s62, s69, 10240
  s_mov_b32 m0, 73728
  s_nop 0
  buffer_load_dwordx4 v8, s[48:51], s62 offen offset:0 sc1 lds
  buffer_load_dwordx4 v9, s[48:51], s62 offen offset:1024 sc1 lds
  buffer_load_dwordx4 v10, s[48:51], s62 offen offset:2048 sc1 lds
  buffer_load_dwordx4 v11, s[48:51], s62 offen offset:3072 sc1 lds
  s_mov_b32 m0, 77824
  s_nop 0
  buffer_load_dwordx4 v12, s[48:51], s62 offen offset:0 sc1 lds
  buffer_load_dwordx4 v13, s[48:51], s62 offen offset:1024 sc1 lds
  s_add_u32 s69, s69, 1
  s_cmp_ge_u32 s69, 24
  s_cselect_b32 s69, 0, s69
  s_waitcnt vmcnt(24)
  s_barrier
  s_mul_i32 s62, s69, 10240
  s_mov_b32 m0, 92160
  s_nop 0
  buffer_load_dwordx4 v8, s[48:51], s62 offen offset:0 sc1 lds
  buffer_load_dwordx4 v9, s[48:51], s62 offen offset:1024 sc1 lds
  buffer_load_dwordx4 v10, s[48:51], s62 offen offset:2048 sc1 lds
  buffer_load_dwordx4 v11, s[48:51], s62 offen offset:3072 sc1 lds
  s_mov_b32 m0, 96256
  s_nop 0
  buffer_load_dwordx4 v12, s[48:51], s62 offen offset:0 sc1 lds
  buffer_load_dwordx4 v13, s[48:51], s62 offen offset:1024 sc1 lds
  s_add_u32 s69, s69, 1
  s_cmp_ge_u32 s69, 24
  s_cselect_b32 s69, 0, s69
  s_waitcnt vmcnt(24)
  s_barrier
  s_mul_i32 s62, s69, 10240
  s_mov_b32 m0, 110592
  s_nop 0
  buffer_load_dwordx4 v8, s[48:51], s62 offen offset:0 sc1 lds
  buffer_load_dwordx4 v9, s[48:51], s62 offen offset:1024 sc1 lds
  buffer_load_dwordx4 v10, s[48:51], s62 offen offset:2048 sc1 lds
  buffer_load_dwordx4 v11, s[48:51], s62 offen offset:3072 sc1 lds
  s_mov_b32 m0, 114688
  s_nop 0
  buffer_load_dwordx4 v12, s[48:51], s62 offen offset:0 sc1 lds
  buffer_load_dwordx4 v13, s[48:51], s62 offen offset:1024 sc1 lds
  s_add_u32 s69, s69, 1
  s_cmp_ge_u32 s69, 24
  s_cselect_b32 s69, 0, s69
  s_waitcnt vmcnt(24)
  s_barrier
  s_mul_i32 s62, s69, 10240
  s_mov_b32 m0, 0
  s_nop 0
  buffer_load_dwordx4 v8, s[48:51], s62 offen offset:0 sc1 lds
  buffer_load_dwordx4 v9, s[48:51], s62 offen offset:1024 sc1 lds
  buffer_load_dwordx4 v10, s[48:51], s62 offen offset:2048 sc1 lds
  buffer_load_dwordx4 v11, s[48:51], s62 offen offset:3072 sc1 lds
  s_mov_b32 m0, 4096
  s_nop 0
  buffer_load_dwordx4 v12, s[48:51], s62 offen offset:0 sc1 lds
  buffer_load_dwordx4 v13, s[48:51], s62 offen offset:1024 sc1 lds
  s_add_u32 s69, s69, 1
  s_cmp_ge_u32 s69, 24
  s_cselect_b32 s69, 0, s69
  s_waitcnt vmcnt(24)
  s_barrier
  s_mul_i32 s62, s69, 10240
  s_mov_b32 m0, 18432
  s_nop 0
  buffer_load_dwordx4 v8, s[48:51], s62 offen offset:0 sc1 lds
  buffer_load_dwordx4 v9, s[48:51], s62 offen offset:1024 sc1 lds
  buffer_load_dwordx4 v10, s[48:51], s62 offen offset:2048 sc1 lds
  buffer_load_dwordx4 v11, s[48:51], s62 offen offset:3072 sc1 lds
  s_mov_b32 m0, 22528
  s_nop 0
  buffer_load_dwordx4 v12, s[48:51], s62 offen offset:0 sc1 lds
  buffer_load_dwordx4 v13, s[48:51], s62 offen offset:1024 sc1 lds
  s_add_u32 s69, s69, 1
  s_cmp_ge_u32 s69, 24
  s_cselect_b32 s69, 0, s69
  s_waitcnt vmcnt(24)
  s_barrier
  s_mul_i32 s62, s69, 10240
  s_mov_b32 m0, 36864
  s_nop 0
  buffer_load_dwordx4 v8, s[48:51], s62 offen offset:0 sc1 lds
  buffer_load_dwordx4 v9, s[48:51], s62 offen offset:1024 sc1 lds
  buffer_load_dwordx4 v10, s[48:51], s62 offen offset:2048 sc1 lds
  buffer_load_dwordx4 v11, s[48:51], s62 offen offset:3072 sc1 lds
  s_mov_b32 m0, 40960
  s_nop 0
  buffer_load_dwordx4 v12, s[48:51], s62 offen offset:0 sc1 lds
  buffer_load_dwordx4 v13, s[48:51], s62 offen offset:1024 sc1 lds
  s_add_u32 s69, s69, 1
  s_cmp_ge_u32 s69, 24
  s_cselect_b32 s69, 0, s69
  s_waitcnt vmcnt(24)
  s_barrier
  s_mul_i32 s62, s69, 10240
  s_mov_b32 m0, 55296
  s_nop 0
  buffer_load_dwordx4 v8, s[48:51], s62 offen offset:0 sc1 lds
  buffer_load_dwordx4 v9, s[48:51], s62 offen offset:1024 sc1 lds
  buffer_load_dwordx4 v10, s[48:51], s62 offen offset:2048 sc1 lds
  buffer_load_dwordx4 v11, s[48:51], s62 offen offset:3072 sc1 lds
  s_mov_b32 m0, 59392
  s_nop 0
  buffer_load_dwordx4 v12, s[48:51], s62 offen offset:0 sc1 lds
  buffer_load_dwordx4 v13, s[48:51], s62 offen offset:1024 sc1 lds
  s_add_u32 s69, s69, 1
  s_cmp_ge_u32 s69, 24
  s_cselect_b32 s69, 0, s69
  s_waitcnt vmcnt(24)
  s_barrier
  s_mul_i32 s62, s69, 10240
  s_mov_b32 m0, 73728
  s_nop 0
  buffer_load_dwordx4 v8, s[48:51], s62 offen offset:0 sc1 lds
  buffer_load_dwordx4 v9, s[48:51], s62 offen offset:1024 sc1 lds
  buffer_load_dwordx4 v10, s[48:51], s62 offen offset:2048 sc1 lds
  buffer_load_dwordx4 v11, s[48:51], s62 offen offset:3072 sc1 lds
  s_mov_b32 m0, 77824
  s_nop 0
  buffer_load_dwordx4 v12, s[48:51], s62 offen offset:0 sc1 lds
  buffer_load_dwordx4 v13, s[48:51], s62 offen offset:1024 sc1 lds
  s_add_u32 s69, s69, 1
  s_cmp_ge_u32 s69, 24
  s_cselect_b32 s69, 0, s69
  s_waitcnt vmcnt(24)
  s_barrier
  s_mul_i32 s62, s69, 10240
  s_mov_b32 m0, 92160
  s_nop 0
  buffer_load_dwordx4 v8, s[48:51], s62 offen offset:0 sc1 lds
  buffer_load_dwordx4 v9, s[48:51], s62 offen offset:1024 sc1 lds
  buffer_load_dwordx4 v10, s[48:51], s62 offen offset:2048 sc1 lds
  buffer_load_dwordx4 v11, s[48:51], s62 offen offset:3072 sc1 lds
  s_mov_b32 m0, 96256
  s_nop 0
  buffer_load_dwordx4 v12, s[48:51], s62 offen offset:0 sc1 lds
  buffer_load_dwordx4 v13, s[48:51], s62 offen offset:1024 sc1 lds
  s_add_u32 s69, s69, 1
  s_cmp_ge_u32 s69, 24
  s_cselect_b32 s69, 0, s69
  s_waitcnt vmcnt(24)
  s_barrier
  s_mul_i32 s69, s73, 10
  s_lshr_b32 s69, s69, 5
  s_mul_i32 s60, s75, 348160
  s_add_u32 s60, s60, 0xf00000
  s_lshl_b32 s61, s74, 2
  s_mul_i32 s61, s61, 69760
  s_add_u32 s61, s61, 0x1000
  s_add_u32 s10, s60, 0x0
  v_add_u32 v8, s10, v7
  s_add_u32 s10, s60, 0x0
  v_add_u32 v9, s10, v7
  s_add_u32 s10, s60, 0x0
  v_add_u32 v10, s10, v7
  s_add_u32 s10, s60, 0x0
  v_add_u32 v11, s10, v7
  s_add_u32 s10, s60, 0x1000
  v_add_u32 v12, s10, v7
  s_add_u32 s10, s60, 0x1000
  v_add_u32 v13, s10, v7
  s_mul_i32 s62, s69, 10240
  s_mov_b32 m0, 110592
  s_nop 0
  buffer_load_dwordx4 v8, s[48:51], s62 offen offset:0 sc1 lds
  buffer_load_dwordx4 v9, s[48:51], s62 offen offset:1024 sc1 lds
  buffer_load_dwordx4 v10, s[48:51], s62 offen offset:2048 sc1 lds
  buffer_load_dwordx4 v11, s[48:51], s62 offen offset:3072 sc1 lds
  s_mov_b32 m0, 114688
  s_nop 0
  buffer_load_dwordx4 v12, s[48:51], s62 offen offset:0 sc1 lds
  buffer_load_dwordx4 v13, s[48:51], s62 offen offset:1024 sc1 lds
  s_add_u32 s69, s69, 1
  s_cmp_ge_u32 s69, 10
  s_cselect_b32 s69, 0, s69
  s_waitcnt vmcnt(24)
  s_barrier
  s_mul_i32 s62, s69, 10240
  s_mov_b32 m0, 0
  s_nop 0
  buffer_load_dwordx4 v8, s[48:51], s62 offen offset:0 sc1 lds
  buffer_load_dwordx4 v9, s[48:51], s62 offen offset:1024 sc1 lds
  buffer_load_dwordx4 v10, s[48:51], s62 offen offset:2048 sc1 lds
  buffer_load_dwordx4 v11, s[48:51], s62 offen offset:3072 sc1 lds
  s_mov_b32 m0, 4096
  s_nop 0
  buffer_load_dwordx4 v12, s[48:51], s62 offen offset:0 sc1 lds
  buffer_load_dwordx4 v13, s[48:51], s62 offen offset:1024 sc1 lds
  s_add_u32 s69, s69, 1
  s_cmp_ge_u32 s69, 10
  s_cselect_b32 s69, 0, s69
  s_waitcnt vmcnt(24)
  s_barrier
  s_mul_i32 s62, s69, 10240
  s_mov_b32 m0, 18432
  s_nop 0
  buffer_load_dwordx4 v8, s[48:51], s62 offen offset:0 sc1 lds
  buffer_load_dwordx4 v9, s[48:51], s62 offen offset:1024 sc1 lds
  buffer_load_dwordx4 v10, s[48:51], s62 offen offset:2048 sc1 lds
  buffer_load_dwordx4 v11, s[48:51], s62 offen offset:3072 sc1 lds
  s_mov_b32 m0, 22528
  s_nop 0
  buffer_load_dwordx4 v12, s[48:51], s62 offen offset:0 sc1 lds
  buffer_load_dwordx4 v13, s[48:51], s62 offen offset:1024 sc1 lds
  s_add_u32 s69, s69, 1
  s_cmp_ge_u32 s69, 10
  s_cselect_b32 s69, 0, s69
  s_waitcnt vmcnt(24)
  s_barrier
  s_mul_i32 s62, s69, 10240
  s_mov_b32 m0, 36864
  s_nop 0
  buffer_load_dwordx4 v8, s[48:51], s62 offen offset:0 sc1 lds
  buffer_load_dwordx4 v9, s[48:51], s62 offen offset:1024 sc1 lds
  buffer_load_dwordx4 v10, s[48:51], s62 offen offset:2048 sc1 lds
  buffer_load_dwordx4 v11, s[48:51], s62 offen offset:3072 sc1 lds
  s_mov_b32 m0, 40960
  s_nop 0
  buffer_load_dwordx4 v12, s[48:51], s62 offen offset:0 sc1 lds
  buffer_load_dwordx4 v13, s[48:51], s62 offen offset:1024 sc1 lds
  s_add_u32 s69, s69, 1
  s_cmp_ge_u32 s69, 10
  s_cselect_b32 s69, 0, s69
  s_waitcnt vmcnt(24)
  s_barrier
  s_mul_i32 s62, s69, 10240
  s_mov_b32 m0, 55296
  s_nop 0
  buffer_load_dwordx4 v8, s[48:51], s62 offen offset:0 sc1 lds
  buffer_load_dwordx4 v9, s[48:51], s62 offen offset:1024 sc1 lds
  buffer_load_dwordx4 v10, s[48:51], s62 offen offset:2048 sc1 lds
  buffer_load_dwordx4 v11, s[48:51], s62 offen offset:3072 sc1 lds
  s_mov_b32 m0, 59392
  s_nop 0
  buffer_load_dwordx4 v12, s[48:51], s62 offen offset:0 sc1 lds
  buffer_load_dwordx4 v13, s[48:51], s62 offen offset:1024 sc1 lds
  s_add_u32 s69, s69, 1
  s_cmp_ge_u32 s69, 10
  s_cselect_b32 s69, 0, s69
  s_waitcnt vmcnt(24)
  s_barrier
  s_mul_i32 s62, s69, 10240
  s_mov_b32 m0, 73728
  s_nop 0
  buffer_load_dwordx4 v8, s[48:51], s62 offen offset:0 sc1 lds
  buffer_load_dwordx4 v9, s[48:51], s62 offen offset:1024 sc1 lds
  buffer_load_dwordx4 v10, s[48:51], s62 offen offset:2048 sc1 lds
  buffer_load_dwordx4 v11, s[48:51], s62 offen offset:3072 sc1 lds
  s_mov_b32 m0, 77824
  s_nop 0
  buffer_load_dwordx4 v12, s[48:51], s62 offen offset:0 sc1 lds
  buffer_load_dwordx4 v13, s[48:51], s62 offen offset:1024 sc1 lds
  s_add_u32 s69, s69, 1
  s_cmp_ge_u32 s69, 10
  s_cselect_b32 s69, 0, s69
  s_waitcnt vmcnt(24)
  s_barrier
  s_mul_i32 s62, s69, 10240
  s_mov_b32 m0, 92160
  s_nop 0
  buffer_load_dwordx4 v8, s[48:51], s62 offen offset:0 sc1 lds
  buffer_load_dwordx4 v9, s[48:51], s62 offen offset:1024 sc1 lds
  buffer_load_dwordx4 v10, s[48:51], s62 offen offset:2048 sc1 lds
  buffer_load_dwordx4 v11, s[48:51], s62 offen offset:3072 sc1 lds
  s_mov_b32 m0, 96256
  s_nop 0
  buffer_load_dwordx4 v12, s[48:51], s62 offen offset:0 sc1 lds
  buffer_load_dwordx4 v13, s[48:51], s62 offen offset:1024 sc1 lds
  s_add_u32 s69, s69, 1
  s_cmp_ge_u32 s69, 10
  s_cselect_b32 s69, 0, s69
  s_waitcnt vmcnt(24)
  s_barrier
  s_mul_i32 s62, s69, 10240
  s_mov_b32 m0, 110592
  s_nop 0
  buffer_load_dwordx4 v8, s[48:51], s62 offen offset:0 sc1 lds
  buffer_load_dwordx4 v9, s[48:51], s62 offen offset:1024 sc1 lds
  buffer_load_dwordx4 v10, s[48:51], s62 offen offset:2048 sc1 lds
  buffer_load_dwordx4 v11, s[48:51], s62 offen offset:3072 sc1 lds
  s_mov_b32 m0, 114688
  s_nop 0
  buffer_load_dwordx4 v12, s[48:51], s62 offen offset:0 sc1 lds
  buffer_load_dwordx4 v13, s[48:51], s62 offen offset:1024 sc1 lds
  s_add_u32 s69, s69, 1
  s_cmp_ge_u32 s69, 10
  s_cselect_b32 s69, 0, s69
  s_waitcnt vmcnt(24)
  s_barrier
  s_mul_i32 s62, s69, 10240
  s_mov_b32 m0, 0
  s_nop 0
  buffer_load_dwordx4 v8, s[48:51], s62 offen offset:0 sc1 lds
  buffer_load_dwordx4 v9, s[48:51], s62 offen offset:1024 sc1 lds
  buffer_load_dwordx4 v10, s[48:51], s62 offen offset:2048 sc1 lds
  buffer_load_dwordx4 v11, s[48:51], s62 offen offset:3072 sc1 lds
  s_mov_b32 m0, 4096
  s_nop 0
  buffer_load_dwordx4 v12, s[48:51], s62 offen offset:0 sc1 lds
  buffer_load_dwordx4 v13, s[48:51], s62 offen offset:1024 sc1 lds
  s_add_u32 s69, s69, 1
  s_cmp_ge_u32 s69, 10
  s_cselect_b32 s69, 0, s69
  s_waitcnt vmcnt(24)
  s_barrier
  s_mul_i32 s62, s69, 10240
  s_mov_b32 m0, 18432
  s_nop 0
  buffer_load_dwordx4 v8, s[48:51], s62 offen offset:0 sc1 lds
  buffer_load_dwordx4 v9, s[48:51], s62 offen offset:1024 sc1 lds
  buffer_load_dwordx4 v10, s[48:51], s62 offen offset:2048 sc1 lds
  buffer_load_dwordx4 v11, s[48:51], s62 offen offset:3072 sc1 lds
  s_mov_b32 m0, 22528
  s_nop 0
  buffer_load_dwordx4 v12, s[48:51], s62 offen offset:0 sc1 lds
  buffer_load_dwordx4 v13, s[48:51], s62 offen offset:1024 sc1 lds
  s_add_u32 s69, s69, 1
  s_cmp_ge_u32 s69, 10
  s_cselect_b32 s69, 0, s69
  s_waitcnt vmcnt(24)
  s_barrier
  s_waitcnt vmcnt(18)
  s_barrier
  s_waitcnt vmcnt(12)
  s_barrier
  s_waitcnt vmcnt(6)
  s_barrier
  s_waitcnt vmcnt(0)
  s_barrier
  s_endpgm
fp_p1:
  s_waitcnt vmcnt(0)
  v_readfirstlane_b32 s72, v42
  s_cmp_ge_u32 s72, 32
  s_cbranch_scc1 fp1_rw_done
fp1_rw:
  buffer_load_dword v21, v40, s[48:51], 0 offen sc1
  s_waitcnt vmcnt(0)
  v_readfirstlane_b32 s72, v21
  s_cmp_ge_u32 s72, 32
  s_cbranch_scc1 fp1_rw_done
  s_sleep 8
  s_branch fp1_rw
fp1_rw_done:
  s_mul_i32 s69, s73, 10
  s_lshr_b32 s69, s69, 5
  s_mul_i32 s60, s75, 102400
  s_add_u32 s60, s60, 0xe00000
  s_lshl_b32 s61, s74, 6
  v_lshrrev_b32 v14, 3, v0
  v_add_u32 v15, s61, v14
  v_mul_u32_u24 v15, 1280, v15
  v_lshrrev_b32 v14, 1, v14
  v_and_b32 v16, 7, v0
  v_xor_b32 v16, v16, v14
  v_lshl_add_u32 v17, v16, 4, v15
  v_xor_b32 v16, 4, v16
  v_lshl_add_u32 v18, v16, 4, v15
  s_add_u32 s10, s60, 0x1800
  v_add_u32 v8, s10, v7
  s_add_u32 s10, s60, 0x1800
  v_add_u32 v9, s10, v7
  s_add_u32 s10, s60, 0x1800
  v_add_u32 v10, s10, v7
  s_add_u32 s10, s60, 0x1800
  v_add_u32 v11, s10, v7
  v_add_u32 v12, 0, v17
  v_add_u32 v13, 10240, v18
  s_mul_i32 s62, s69, 10240
  s_lshl_b32 s63, s69, 7
  s_mov_b32 m0, 6144
  s_nop 0
  buffer_load_dwordx4 v8, s[48:51], s62 offen offset:0 sc1 lds
  buffer_load_dwordx4 v9, s[48:51], s62 offen offset:1024 sc1 lds
  buffer_load_dwordx4 v10, s[48:51], s62 offen offset:2048 sc1 lds
  buffer_load_dwordx4 v11, s[48:51], s62 offen offset:3072 sc1 lds
  s_mov_b32 m0, 10240
  s_nop 0
  buffer_load_dwordx4 v12, s[40:43], s63 offen offset:0 lds
  s_mov_b32 m0, 11264
  s_nop 0
  buffer_load_dwordx4 v13, s[40:43], s63 offen offset:0 lds
  s_add_u32 s69, s69, 1
  s_cmp_ge_u32 s69, 10
  s_cselect_b32 s69, 0, s69
  s_mul_i32 s62, s69, 10240
  s_lshl_b32 s63, s69, 7
  s_mov_b32 m0, 24576
  s_nop 0
  buffer_load_dwordx4 v8, s[48:51], s62 offen offset:0 sc1 lds
  buffer_load_dwordx4 v9, s[48:51], s62 offen offset:1024 sc1 lds
  buffer_load_dwordx4 v10, s[48:51], s62 offen offset:2048 sc1 lds
  buffer_load_dwordx4 v11, s[48:51], s62 offen offset:3072 sc1 lds
  s_mov_b32 m0, 28672
  s_nop 0
  buffer_load_dwordx4 v12, s[40:43], s63 offen offset:0 lds
  s_mov_b32 m0, 29696
  s_nop 0
  buffer_load_dwordx4 v13, s[40:43], s63 offen offset:0 lds
  s_add_u32 s69, s69, 1
  s_cmp_ge_u32 s69, 10
  s_cselect_b32 s69, 0, s69
  s_mul_i32 s62, s69, 10240
  s_lshl_b32 s63, s69, 7
  s_mov_b32 m0, 43008
  s_nop 0
  buffer_load_dwordx4 v8, s[48:51], s62 offen offset:0 sc1 lds
  buffer_load_dwordx4 v9, s[48:51], s62 offen offset:1024 sc1 lds
  buffer_load_dwordx4 v10, s[48:51], s62 offen offset:2048 sc1 lds
  buffer_load_dwordx4 v11, s[48:51], s62 offen offset:3072 sc1 lds
  s_mov_b32 m0, 47104
  s_nop 0
  buffer_load_dwordx4 v12, s[40:43], s63 offen offset:0 lds
  s_mov_b32 m0, 48128
  s_nop 0
  buffer_load_dwordx4 v13, s[40:43], s63 offen offset:0 lds
  s_add_u32 s69, s69, 1
  s_cmp_ge_u32 s69, 10
  s_cselect_b32 s69, 0, s69
  s_mul_i32 s62, s69, 10240
  s_lshl_b32 s63, s69, 7
  s_mov_b32 m0, 61440
  s_nop 0
  buffer_load_dwordx4 v8, s[48:51], s62 offen offset:0 sc1 lds
  buffer_load_dwordx4 v9, s[48:51], s62 offen offset:1024 sc1 lds
  buffer_load_dwordx4 v10, s[48:51], s62 offen offset:2048 sc1 lds
  buffer_load_dwordx4 v11, s[48:51], s62 offen offset:3072 sc1 lds
  s_mov_b32 m0, 65536
  s_nop 0
  buffer_load_dwordx4 v12, s[40:43], s63 offen offset:0 lds
  s_mov_b32 m0, 66560
  s_nop 0
  buffer_load_dwordx4 v13, s[40:43], s63 offen offset:0 lds
  s_add_u32 s69, s69, 1
  s_cmp_ge_u32 s69, 10
  s_cselect_b32 s69, 0, s69
  s_cmp_ge_u32 s6, 2
  s_cbranch_scc1 fp1_noe
  s_barrier
  s_barrier
fp1_noe:
  s_mul_i32 s62, s69, 10240
  s_lshl_b32 s63, s69, 7
  s_mov_b32 m0, 79872
  s_nop 0
  buffer_load_dwordx4 v8, s[48:51], s62 offen offset:0 sc1 lds
  buffer_load_dwordx4 v9, s[48:51], s62 offen offset:1024 sc1 lds
  buffer_load_dwordx4 v10, s[48:51], s62 offen offset:2048 sc1 lds
  buffer_load_dwordx4 v11, s[48:51], s62 offen offset:3072 sc1 lds
  s_mov_b32 m0, 83968
  s_nop 0
  buffer_load_dwordx4 v12, s[40:43], s63 offen offset:0 lds
  s_mov_b32 m0, 84992
  s_nop 0
  buffer_load_dwordx4 v13, s[40:43], s63 offen offset:0 lds
  s_add_u32 s69, s69, 1
  s_cmp_ge_u32 s69, 10
  s_cselect_b32 s69, 0, s69
  s_mul_i32 s62, s69, 10240
  s_lshl_b32 s63, s69, 7
  s_mov_b32 m0, 98304
  s_nop 0
  buffer_load_dwordx4 v8, s[48:51], s62 offen offset:0 sc1 lds
  buffer_load_dwordx4 v9, s[48:51], s62 offen offset:1024 sc1 lds
  buffer_load_dwordx4 v10, s[48:51], s62 offen offset:2048 sc1 lds
  buffer_load_dwordx4 v11, s[48:51], s62 offen offset:3072 sc1 lds
  s_mov_b32 m0, 102400
  s_nop 0
  buffer_load_dwordx4 v12, s[40:43], s63 offen offset:0 lds
  s_mov_b32 m0, 103424
  s_nop 0
  buffer_load_dwordx4 v13, s[40:43], s63 offen offset:0 lds
  s_add_u32 s69, s69, 1
  s_cmp_ge_u32 s69, 10
  s_cselect_b32 s69, 0, s69
  s_waitcnt vmcnt(30)
  s_barrier
  s_mul_i32 s62, s69, 10240
  s_lshl_b32 s63, s69, 7
  s_mov_b32 m0, 116736
  s_nop 0
  buffer_load_dwordx4 v8, s[48:51], s62 offen offset:0 sc1 lds
  buffer_load_dwordx4 v9, s[48:51], s62 offen offset:1024 sc1 lds
  buffer_load_dwordx4 v10, s[48:51], s62 offen offset:2048 sc1 lds
  buffer_load_dwordx4 v11, s[48:51], s62 offen offset:3072 sc1 lds
  s_mov_b32 m0, 120832
  s_nop 0
  buffer_load_dwordx4 v12, s[40:43], s63 offen offset:0 lds
  s_mov_b32 m0, 121856
  s_nop 0
  buffer_load_dwordx4 v13, s[40:43], s63 offen offset:0 lds
  s_add_u32 s69, s69, 1
  s_cmp_ge_u32 s69, 10
  s_cselect_b32 s69, 0, s69
  s_waitcnt vmcnt(30)
  s_barrier
  s_waitcnt vmcnt(24)
  s_barrier
  s_mul_i32 s62, s69, 10240
  s_lshl_b32 s63, s69, 7
  s_mov_b32 m0, 6144
  s_nop 0
  buffer_load_dwordx4 v8, s[48:51], s62 offen offset:0 sc1 lds
  buffer_load_dwordx4 v9, s[48:51], s62 offen offset:1024 sc1 lds
  buffer_load_dwordx4 v10, s[48:51], s62 offen offset:2048 sc1 lds
  buffer_load_dwordx4 v11, s[48:51], s62 offen offset:3072 sc1 lds
  s_mov_b32 m0, 10240
  s_nop 0
  buffer_load_dwordx4 v12, s[40:43], s63 offen offset:0 lds
  s_mov_b32 m0, 11264
  s_nop 0
  buffer_load_dwordx4 v13, s[40:43], s63 offen offset:0 lds
  s_add_u32 s69, s69, 1
  s_cmp_ge_u32 s69, 10
  s_cselect_b32 s69, 0, s69
  s_waitcnt vmcnt(24)
  s_barrier
  s_lshr_b32 s10, s73, 2
  s_add_u32 s10, s10, 0
  s_and_b32 s10, s10, 7
  s_lshr_b32 s11, s74, 1
  s_lshl_b32 s11, s11, 3
  s_add_u32 s10, s10, s11
  s_lshl_b32 s10, s10, 7
  s_add_u32 s10, s10, 0x11f2000
  v_mov_b32 v40, s10
  buffer_load_dword v42, v40, s[48:51], 0 offen sc1
  s_mul_i32 s62, s69, 10240
  s_lshl_b32 s63, s69, 7
  s_mov_b32 m0, 24576
  s_nop 0
  buffer_load_dwordx4 v8, s[48:51], s62 offen offset:0 sc1 lds
  buffer_load_dwordx4 v9, s[48:51], s62 offen offset:1024 sc1 lds
  buffer_load_dwordx4 v10, s[48:51], s62 offen offset:2048 sc1 lds
  buffer_load_dwordx4 v11, s[48:51], s62 offen offset:3072 sc1 lds
  s_mov_b32 m0, 28672
  s_nop 0
  buffer_load_dwordx4 v12, s[40:43], s63 offen offset:0 lds
  s_mov_b32 m0, 29696
  s_nop 0
  buffer_load_dwordx4 v13, s[40:43], s63 offen offset:0 lds
  s_add_u32 s69, s69, 1
  s_cmp_ge_u32 s69, 10
  s_cselect_b32 s69, 0, s69
  s_waitcnt vmcnt(25)
  s_barrier
  s_mul_i32 s62, s69, 10240
  s_lshl_b32 s63, s69, 7
  s_mov_b32 m0, 43008
  s_nop 0
  buffer_load_dwordx4 v8, s[48:51], s62 offen offset:0 sc1 lds
  buffer_load_dwordx4 v9, s[48:51], s62 offen offset:1024 sc1 lds
  buffer_load_dwordx4 v10, s[48:51], s62 offen offset:2048 sc1 lds
  buffer_load_dwordx4 v11, s[48:51], s62 offen offset:3072 sc1 lds
  s_mov_b32 m0, 47104
  s_nop 0
  buffer_load_dwordx4 v12, s[40:43], s63 offen offset:0 lds
  s_mov_b32 m0, 48128
  s_nop 0
  buffer_load_dwordx4 v13, s[40:43], s63 offen offset:0 lds
  s_add_u32 s69, s69, 1
  s_cmp_ge_u32 s69, 10
  s_cselect_b32 s69, 0, s69
  s_waitcnt vmcnt(25)
  s_barrier
  s_waitcnt vmcnt(12)
  v_readfirstlane_b32 s72, v42
  s_cmp_ge_u32 s72, 4
  s_cbranch_scc1 fp1_h0_done
fp1_h0:
  buffer_load_dword v21, v40, s[48:51], 0 offen sc1
  s_waitcnt vmcnt(0)
  v_readfirstlane_b32 s72, v21
  s_cmp_ge_u32 s72, 4
  s_cbranch_scc1 fp1_h0_done
  s_sleep 8
  s_branch fp1_h0
fp1_h0_done:
  s_lshr_b32 s69, s73, 2
  s_mul_i32 s69, s69, 3
  s_mul_i32 s60, s75, 348160
  s_add_u32 s60, s60, 0xf19000
  s_lshl_b32 s61, s74, 2
  s_mul_i32 s61, s61, 69760
  s_add_u32 s61, s61, 0x6000
  s_add_u32 s10, s60, 0x1800
  v_add_u32 v8, s10, v7
  s_add_u32 s10, s60, 0x1800
  v_add_u32 v9, s10, v7
  s_add_u32 s10, s60, 0x1800
  v_add_u32 v10, s10, v7
  s_add_u32 s10, s60, 0x1800
  v_add_u32 v11, s10, v7
  s_add_u32 s10, s61, 0x0
  v_add_u32 v12, s10, v7
  s_add_u32 s10, s61, 0x10c80
  v_add_u32 v13, s10, v7
  s_mul_i32 s62, s69, 10240
  s_lshl_b32 s63, s69, 11
  s_mov_b32 m0, 61440
  s_nop 0
  buffer_load_dwordx4 v8, s[48:51], s62 offen offset:0 sc1 lds
  buffer_load_dwordx4 v9, s[48:51], s62 offen offset:1024 sc1 lds
  buffer_load_dwordx4 v10, s[48:51], s62 offen offset:2048 sc1 lds
  buffer_load_dwordx4 v11, s[48:51], s62 offen offset:3072 sc1 lds
  s_mov_b32 m0, 65536
  s_nop 0
  buffer_load_dwordx4 v12, s[48:51], s63 offen offset:0 sc1 lds
  buffer_load_dwordx4 v13, s[48:51], s63 offen offset:1024 sc1 lds
  s_add_u32 s69, s69, 1
  s_cmp_ge_u32 s69, 24
  s_cselect_b32 s69, 0, s69
  s_barrier
  s_lshr_b32 s10, s73, 2
  s_add_u32 s10, s10, 1
  s_and_b32 s10, s10, 7
  s_lshr_b32 s11, s74, 1
  s_lshl_b32 s11, s11, 3
  s_add_u32 s10, s10, s11
  s_lshl_b32 s10, s10, 7
  s_add_u32 s10, s10, 0x11f2000
  v_mov_b32 v40, s10
  buffer_load_dword v42, v40, s[48:51], 0 offen sc1
  s_mul_i32 s62, s69, 10240
  s_lshl_b32 s63, s69, 11
  s_mov_b32 m0, 79872
  s_nop 0
  buffer_load_dwordx4 v8, s[48:51], s62 offen offset:0 sc1 lds
  buffer_load_dwordx4 v9, s[48:51], s62 offen offset:1024 sc1 lds
  buffer_load_dwordx4 v10, s[48:51], s62 offen offset:2048 sc1 lds
  buffer_load_dwordx4 v11, s[48:51], s62 offen offset:3072 sc1 lds
  s_mov_b32 m0, 83968
  s_nop 0
  buffer_load_dwordx4 v12, s[48:51], s63 offen offset:0 sc1 lds
  buffer_load_dwordx4 v13, s[48:51], s63 offen offset:1024 sc1 lds
  s_add_u32 s69, s69, 1
  s_cmp_ge_u32 s69, 24
  s_cselect_b32 s69, 0, s69
  s_barrier
  s_mul_i32 s62, s69, 10240
  s_lshl_b32 s63, s69, 11
  s_mov_b32 m0, 98304
  s_nop 0
  buffer_load_dwordx4 v8, s[48:51], s62 offen offset:0 sc1 lds
  buffer_load_dwordx4 v9, s[48:51], s62 offen offset:1024 sc1 lds
  buffer_load_dwordx4 v10, s[48:51], s62 offen offset:2048 sc1 lds
  buffer_load_dwordx4 v11, s[48:51], s62 offen offset:3072 sc1 lds
  s_mov_b32 m0, 102400
  s_nop 0
  buffer_load_dwordx4 v12, s[48:51], s63 offen offset:0 sc1 lds
  buffer_load_dwordx4 v13, s[48:51], s63 offen offset:1024 sc1 lds
  s_add_u32 s69, s69, 1
  s_cmp_ge_u32 s69, 24
  s_cselect_b32 s69, 0, s69
  s_waitcnt vmcnt(25)
  s_barrier
  s_waitcnt vmcnt(12)
  v_readfirstlane_b32 s72, v42
  s_cmp_ge_u32 s72, 4
  s_cbranch_scc1 fp1_h1_done
fp1_h1:
  buffer_load_dword v21, v40, s[48:51], 0 offen sc1
  s_waitcnt vmcnt(0)
  v_readfirstlane_b32 s72, v21
  s_cmp_ge_u32 s72, 4
  s_cbranch_scc1 fp1_h1_done
  s_sleep 8
  s_branch fp1_h1
fp1_h1_done:
  s_mul_i32 s62, s69, 10240
  s_lshl_b32 s63, s69, 11
  s_mov_b32 m0, 116736
  s_nop 0
  buffer_load_dwordx4 v8, s[48:51], s62 offen offset:0 sc1 lds
  buffer_load_dwordx4 v9, s[48:51], s62 offen offset:1024 sc1 lds
  buffer_load_dwordx4 v10, s[48:51], s62 offen offset:2048 sc1 lds
  buffer_load_dwordx4 v11, s[48:51], s62 offen offset:3072 sc1 lds
  s_mov_b32 m0, 120832
  s_nop 0
  buffer_load_dwordx4 v12, s[48:51], s63 offen offset:0 sc1 lds
  buffer_load_dwordx4 v13, s[48:51], s63 offen offset:1024 sc1 lds
  s_add_u32 s69, s69, 1
  s_cmp_ge_u32 s69, 24
  s_cselect_b32 s69, 0, s69
  s_barrier
  s_lshr_b32 s10, s73, 2
  s_add_u32 s10, s10, 2
  s_and_b32 s10, s10, 7
  s_lshr_b32 s11, s74, 1
  s_lshl_b32 s11, s11, 3
  s_add_u32 s10, s10, s11
  s_lshl_b32 s10, s10, 7
  s_add_u32 s10, s10, 0x11f2000
  v_mov_b32 v40, s10
  buffer_load_dword v42, v40, s[48:51], 0 offen sc1
  s_mul_i32 s62, s69, 10240
  s_lshl_b32 s63, s69, 11
  s_mov_b32 m0, 6144
  s_nop 0
  buffer_load_dwordx4 v8, s[48:51], s62 offen offset:0 sc1 lds
  buffer_load_dwordx4 v9, s[48:51], s62 offen offset:1024 sc1 lds
  buffer_load_dwordx4 v10, s[48:51], s62 offen offset:2048 sc1 lds
  buffer_load_dwordx4 v11, s[48:51], s62 offen offset:3072 sc1 lds
  s_mov_b32 m0, 10240
  s_nop 0
  buffer_load_dwordx4 v12, s[48:51], s63 offen offset:0 sc1 lds
  buffer_load_dwordx4 v13, s[48:51], s63 offen offset:1024 sc1 lds
  s_add_u32 s69, s69, 1
  s_cmp_ge_u32 s69, 24
  s_cselect_b32 s69, 0, s69
  s_barrier
  s_mul_i32 s62, s69, 10240
  s_lshl_b32 s63, s69, 11
  s_mov_b32 m0, 24576
  s_nop 0
  buffer_load_dwordx4 v8, s[48:51], s62 offen offset:0 sc1 lds
  buffer_load_dwordx4 v9, s[48:51], s62 offen offset:1024 sc1 lds
  buffer_load_dwordx4 v10, s[48:51], s62 offen offset:2048 sc1 lds
  buffer_load_dwordx4 v11, s[48:51], s62 offen offset:3072 sc1 lds
  s_mov_b32 m0, 28672
  s_nop 0
  buffer_load_dwordx4 v12, s[48:51], s63 offen offset:0 sc1 lds
  buffer_load_dwordx4 v13, s[48:51], s63 offen offset:1024 sc1 lds
  s_add_u32 s69, s69, 1
  s_cmp_ge_u32 s69, 24
  s_cselect_b32 s69, 0, s69
  s_waitcnt vmcnt(25)
  s_barrier
  s_waitcnt vmcnt(12)
  v_readfirstlane_b32 s72, v42
  s_cmp_ge_u32 s72, 4
  s_cbranch_scc1 fp1_h2_done
fp1_h2:
  buffer_load_dword v21, v40, s[48:51], 0 offen sc1
  s_waitcnt vmcnt(0)
  v_readfirstlane_b32 s72, v21
  s_cmp_ge_u32 s72, 4
  s_cbranch_scc1 fp1_h2_done
  s_sleep 8
  s_branch fp1_h2
fp1_h2_done:
  s_mul_i32 s62, s69, 10240
  s_lshl_b32 s63, s69, 11
  s_mov_b32 m0, 43008
  s_nop 0
  buffer_load_dwordx4 v8, s[48:51], s62 offen offset:0 sc1 lds
  buffer_load_dwordx4 v9, s[48:51], s62 offen offset:1024 sc1 lds
  buffer_load_dwordx4 v10, s[48:51], s62 offen offset:2048 sc1 lds
  buffer_load_dwordx4 v11, s[48:51], s62 offen offset:3072 sc1 lds
  s_mov_b32 m0, 47104
  s_nop 0
  buffer_load_dwordx4 v12, s[48:51], s63 offen offset:0 sc1 lds
  buffer_load_dwordx4 v13, s[48:51], s63 offen offset:1024 sc1 lds
  s_add_u32 s69, s69, 1
  s_cmp_ge_u32 s69, 24
  s_cselect_b32 s69, 0, s69
  s_barrier
  s_lshr_b32 s10, s73, 2
  s_add_u32 s10, s10, 3
  s_and_b32 s10, s10, 7
  s_lshr_b32 s11, s74, 1
  s_lshl_b32 s11, s11, 3
  s_add_u32 s10, s10, s11
  s_lshl_b32 s10, s10, 7
  s_add_u32 s10, s10, 0x11f2000
  v_mov_b32 v40, s10
  buffer_load_dword v42, v40, s[48:51], 0 offen sc1
  s_mul_i32 s62, s69, 10240
  s_lshl_b32 s63, s69, 11
  s_mov_b32 m0, 61440
  s_nop 0
  buffer_load_dwordx4 v8, s[48:51], s62 offen offset:0 sc1 lds
  buffer_load_dwordx4 v9, s[48:51], s62 offen offset:1024 sc1 lds
  buffer_load_dwordx4 v10, s[48:51], s62 offen offset:2048 sc1 lds
  buffer_load_dwordx4 v11, s[48:51], s62 offen offset:3072 sc1 lds
  s_mov_b32 m0, 65536
  s_nop 0
  buffer_load_dwordx4 v12, s[48:51], s63 offen offset:0 sc1 lds
  buffer_load_dwordx4 v13, s[48:51], s63 offen offset:1024 sc1 lds
  s_add_u32 s69, s69, 1
  s_cmp_ge_u32 s69, 24
  s_cselect_b32 s69, 0, s69
  s_barrier
  s_mul_i32 s62, s69, 10240
  s_lshl_b32 s63, s69, 11
  s_mov_b32 m0, 79872
  s_nop 0
  buffer_load_dwordx4 v8, s[48:51], s62 offen offset:0 sc1 lds
  buffer_load_dwordx4 v9, s[48:51], s62 offen offset:1024 sc1 lds
  buffer_load_dwordx4 v10, s[48:51], s62 offen offset:2048 sc1 lds
  buffer_load_dwordx4 v11, s[48:51], s62 offen offset:3072 sc1 lds
  s_mov_b32 m0, 83968
  s_nop 0
  buffer_load_dwordx4 v12, s[48:51], s63 offen offset:0 sc1 lds
  buffer_load_dwordx4 v13, s[48:51], s63 offen offset:1024 sc1 lds
  s_add_u32 s69, s69, 1
  s_cmp_ge_u32 s69, 24
  s_cselect_b32 s69, 0, s69
  s_waitcnt vmcnt(25)
  s_barrier
  s_waitcnt vmcnt(12)
  v_readfirstlane_b32 s72, v42
  s_cmp_ge_u32 s72, 4
  s_cbranch_scc1 fp1_h3_done
fp1_h3:
  buffer_load_dword v21, v40, s[48:51], 0 offen sc1
  s_waitcnt vmcnt(0)
  v_readfirstlane_b32 s72, v21
  s_cmp_ge_u32 s72, 4
  s_cbranch_scc1 fp1_h3_done
  s_sleep 8
  s_branch fp1_h3
fp1_h3_done:
  s_mul_i32 s62, s69, 10240
  s_lshl_b32 s63, s69, 11
  s_mov_b32 m0, 98304
  s_nop 0
  buffer_load_dwordx4 v8, s[48:51], s62 offen offset:0 sc1 lds
  buffer_load_dwordx4 v9, s[48:51], s62 offen offset:1024 sc1 lds
  buffer_load_dwordx4 v10, s[48:51], s62 offen offset:2048 sc1 lds
  buffer_load_dwordx4 v11, s[48:51], s62 offen offset:3072 sc1 lds
  s_mov_b32 m0, 102400
  s_nop 0
  buffer_load_dwordx4 v12, s[48:51], s63 offen offset:0 sc1 lds
  buffer_load_dwordx4 v13, s[48:51], s63 offen offset:1024 sc1 lds
  s_add_u32 s69, s69, 1
  s_cmp_ge_u32 s69, 24
  s_cselect_b32 s69, 0, s69
  s_barrier
  s_lshr_b32 s10, s73, 2
  s_add_u32 s10, s10, 4
  s_and_b32 s10, s10, 7
  s_lshr_b32 s11, s74, 1
  s_lshl_b32 s11, s11, 3
  s_add_u32 s10, s10, s11
  s_lshl_b32 s10, s10, 7
  s_add_u32 s10, s10, 0x11f2000
  v_mov_b32 v40, s10
  buffer_load_dword v42, v40, s[48:51], 0 offen sc1
  s_mul_i32 s62, s69, 10240
  s_lshl_b32 s63, s69, 11
  s_mov_b32 m0, 116736
  s_nop 0
  buffer_load_dwordx4 v8, s[48:51], s62 offen offset:0 sc1 lds
  buffer_load_dwordx4 v9, s[48:51], s62 offen offset:1024 sc1 lds
  buffer_load_dwordx4 v10, s[48:51], s62 offen offset:2048 sc1 lds
  buffer_load_dwordx4 v11, s[48:51], s62 offen offset:3072 sc1 lds
  s_mov_b32 m0, 120832
  s_nop 0
  buffer_load_dwordx4 v12, s[48:51], s63 offen offset:0 sc1 lds
  buffer_load_dwordx4 v13, s[48:51], s63 offen offset:1024 sc1 lds
  s_add_u32 s69, s69, 1
  s_cmp_ge_u32 s69, 24
  s_cselect_b32 s69, 0, s69
  s_barrier
  s_mul_i32 s62, s69, 10240
  s_lshl_b32 s63, s69, 11
  s_mov_b32 m0, 6144
  s_nop 0
  buffer_load_dwordx4 v8, s[48:51], s62 offen offset:0 sc1 lds
  buffer_load_dwordx4 v9, s[48:51], s62 offen offset:1024 sc1 lds
  buffer_load_dwordx4 v10, s[48:51], s62 offen offset:2048 sc1 lds
  buffer_load_dwordx4 v11, s[48:51], s62 offen offset:3072 sc1 lds
  s_mov_b32 m0, 10240
  s_nop 0
  buffer_load_dwordx4 v12, s[48:51], s63 offen offset:0 sc1 lds
  buffer_load_dwordx4 v13, s[48:51], s63 offen offset:1024 sc1 lds
  s_add_u32 s69, s69, 1
  s_cmp_ge_u32 s69, 24
  s_cselect_b32 s69, 0, s69
  s_waitcnt vmcnt(25)
  s_barrier
  s_waitcnt vmcnt(12)
  v_readfirstlane_b32 s72, v42
  s_cmp_ge_u32 s72, 4
  s_cbranch_scc1 fp1_h4_done
fp1_h4:
  buffer_load_dword v21, v40, s[48:51], 0 offen sc1
  s_waitcnt vmcnt(0)
  v_readfirstlane_b32 s72, v21
  s_cmp_ge_u32 s72, 4
  s_cbranch_scc1 fp1_h4_done
  s_sleep 8
  s_branch fp1_h4
fp1_h4_done:
  s_mul_i32 s62, s69, 10240
  s_lshl_b32 s63, s69, 11
  s_mov_b32 m0, 24576
  s_nop 0
  buffer_load_dwordx4 v8, s[48:51], s62 offen offset:0 sc1 lds
  buffer_load_dwordx4 v9, s[48:51], s62 offen offset:1024 sc1 lds
  buffer_load_dwordx4 v10, s[48:51], s62 offen offset:2048 sc1 lds
  buffer_load_dwordx4 v11, s[48:51], s62 offen offset:3072 sc1 lds
  s_mov_b32 m0, 28672
  s_nop 0
  buffer_load_dwordx4 v12, s[48:51], s63 offen offset:0 sc1 lds
  buffer_load_dwordx4 v13, s[48:51], s63 offen offset:1024 sc1 lds
  s_add_u32 s69, s69, 1
  s_cmp_ge_u32 s69, 24
  s_cselect_b32 s69, 0, s69
  s_barrier
  s_lshr_b32 s10, s73, 2
  s_add_u32 s10, s10, 5
  s_and_b32 s10, s10, 7
  s_lshr_b32 s11, s74, 1
  s_lshl_b32 s11, s11, 3
  s_add_u32 s10, s10, s11
  s_lshl_b32 s10, s10, 7
  s_add_u32 s10, s10, 0x11f2000
  v_mov_b32 v40, s10
  buffer_load_dword v42, v40, s[48:51], 0 offen sc1
  s_mul_i32 s62, s69, 10240
  s_lshl_b32 s63, s69, 11
  s_mov_b32 m0, 43008
  s_nop 0
  buffer_load_dwordx4 v8, s[48:51], s62 offen offset:0 sc1 lds
  buffer_load_dwordx4 v9, s[48:51], s62 offen offset:1024 sc1 lds
  buffer_load_dwordx4 v10, s[48:51], s62 offen offset:2048 sc1 lds
  buffer_load_dwordx4 v11, s[48:51], s62 offen offset:3072 sc1 lds
  s_mov_b32 m0, 47104
  s_nop 0
  buffer_load_dwordx4 v12, s[48:51], s63 offen offset:0 sc1 lds
  buffer_load_dwordx4 v13, s[48:51], s63 offen offset:1024 sc1 lds
  s_add_u32 s69, s69, 1
  s_cmp_ge_u32 s69, 24
  s_cselect_b32 s69, 0, s69
  s_barrier
  s_mul_i32 s62, s69, 10240
  s_lshl_b32 s63, s69, 11
  s_mov_b32 m0, 61440
  s_nop 0
  buffer_load_dwordx4 v8, s[48:51], s62 offen offset:0 sc1 lds
  buffer_load_dwordx4 v9, s[48:51], s62 offen offset:1024 sc1 lds
  buffer_load_dwordx4 v10, s[48:51], s62 offen offset:2048 sc1 lds
  buffer_load_dwordx4 v11, s[48:51], s62 offen offset:3072 sc1 lds
  s_mov_b32 m0, 65536
  s_nop 0
  buffer_load_dwordx4 v12, s[48:51], s63 offen offset:0 sc1 lds
  buffer_load_dwordx4 v13, s[48:51], s63 offen offset:1024 sc1 lds
  s_add_u32 s69, s69, 1
  s_cmp_ge_u32 s69, 24
  s_cselect_b32 s69, 0, s69
  s_barrier
  s_waitcnt vmcnt(25)
  s_barrier
  s_waitcnt vmcnt(12)
  v_readfirstlane_b32 s72, v42
  s_cmp_ge_u32 s72, 4
  s_cbranch_scc1 fp1_h5_done
fp1_h5:
  buffer_load_dword v21, v40, s[48:51], 0 offen sc1
  s_waitcnt vmcnt(0)
  v_readfirstlane_b32 s72, v21
  s_cmp_ge_u32 s72, 4
  s_cbranch_scc1 fp1_h5_done
  s_sleep 8
  s_branch fp1_h5
fp1_h5_done:
  s_mul_i32 s62, s69, 10240
  s_lshl_b32 s63, s69, 11
  s_mov_b32 m0, 79872
  s_nop 0
  buffer_load_dwordx4 v8, s[48:51], s62 offen offset:0 sc1 lds
  buffer_load_dwordx4 v9, s[48:51], s62 offen offset:1024 sc1 lds
  buffer_load_dwordx4 v10, s[48:51], s62 offen offset:2048 sc1 lds
  buffer_load_dwordx4 v11, s[48:51], s62 offen offset:3072 sc1 lds
  s_mov_b32 m0, 83968
  s_nop 0
  buffer_load_dwordx4 v12, s[48:51], s63 offen offset:0 sc1 lds
  buffer_load_dwordx4 v13, s[48:51], s63 offen offset:1024 sc1 lds
  s_add_u32 s69, s69, 1
  s_cmp_ge_u32 s69, 24
  s_cselect_b32 s69, 0, s69
  s_barrier
  s_lshr_b32 s10, s73, 2
  s_add_u32 s10, s10, 6
  s_and_b32 s10, s10, 7
  s_lshr_b32 s11, s74, 1
  s_lshl_b32 s11, s11, 3
  s_add_u32 s10, s10, s11
  s_lshl_b32 s10, s10, 7
  s_add_u32 s10, s10, 0x11f2000
  v_mov_b32 v40, s10
  buffer_load_dword v42, v40, s[48:51], 0 offen sc1
  s_mul_i32 s62, s69, 10240
  s_lshl_b32 s63, s69, 11
  s_mov_b32 m0, 98304
  s_nop 0
  buffer_load_dwordx4 v8, s[48:51], s62 offen offset:0 sc1 lds
  buffer_load_dwordx4 v9, s[48:51], s62 offen offset:1024 sc1 lds
  buffer_load_dwordx4 v10, s[48:51], s62 offen offset:2048 sc1 lds
  buffer_load_dwordx4 v11, s[48:51], s62 offen offset:3072 sc1 lds
  s_mov_b32 m0, 102400
  s_nop 0
  buffer_load_dwordx4 v12, s[48:51], s63 offen offset:0 sc1 lds
  buffer_load_dwordx4 v13, s[48:51], s63 offen offset:1024 sc1 lds
  s_add_u32 s69, s69, 1
  s_cmp_ge_u32 s69, 24
  s_cselect_b32 s69, 0, s69
  s_barrier
  s_mul_i32 s62, s69, 10240
  s_lshl_b32 s63, s69, 11
  s_mov_b32 m0, 116736
  s_nop 0
  buffer_load_dwordx4 v8, s[48:51], s62 offen offset:0 sc1 lds
  buffer_load_dwordx4 v9, s[48:51], s62 offen offset:1024 sc1 lds
  buffer_load_dwordx4 v10, s[48:51], s62 offen offset:2048 sc1 lds
  buffer_load_dwordx4 v11, s[48:51], s62 offen offset:3072 sc1 lds
  s_mov_b32 m0, 120832
  s_nop 0
  buffer_load_dwordx4 v12, s[48:51], s63 offen offset:0 sc1 lds
  buffer_load_dwordx4 v13, s[48:51], s63 offen offset:1024 sc1 lds
  s_add_u32 s69, s69, 1
  s_cmp_ge_u32 s69, 24
  s_cselect_b32 s69, 0, s69
  s_waitcnt vmcnt(25)
  s_barrier
  s_waitcnt vmcnt(12)
  v_readfirstlane_b32 s72, v42
  s_cmp_ge_u32 s72, 4
  s_cbranch_scc1 fp1_h6_done
fp1_h6:
  buffer_load_dword v21, v40, s[48:51], 0 offen sc1
  s_waitcnt vmcnt(0)
  v_readfirstlane_b32 s72, v21
  s_cmp_ge_u32 s72, 4
  s_cbranch_scc1 fp1_h6_done
  s_sleep 8
  s_branch fp1_h6
fp1_h6_done:
  s_mul_i32 s62, s69, 10240
  s_lshl_b32 s63, s69, 11
  s_mov_b32 m0, 6144
  s_nop 0
  buffer_load_dwordx4 v8, s[48:51], s62 offen offset:0 sc1 lds
  buffer_load_dwordx4 v9, s[48:51], s62 offen offset:1024 sc1 lds
  buffer_load_dwordx4 v10, s[48:51], s62 offen offset:2048 sc1 lds
  buffer_load_dwordx4 v11, s[48:51], s62 offen offset:3072 sc1 lds
  s_mov_b32 m0, 10240
  s_nop 0
  buffer_load_dwordx4 v12, s[48:51], s63 offen offset:0 sc1 lds
  buffer_load_dwordx4 v13, s[48:51], s63 offen offset:1024 sc1 lds
  s_add_u32 s69, s69, 1
  s_cmp_ge_u32 s69, 24
  s_cselect_b32 s69, 0, s69
  s_barrier
  s_lshr_b32 s10, s73, 2
  s_add_u32 s10, s10, 7
  s_and_b32 s10, s10, 7
  s_lshr_b32 s11, s74, 1
  s_lshl_b32 s11, s11, 3
  s_add_u32 s10, s10, s11
  s_lshl_b32 s10, s10, 7
  s_add_u32 s10, s10, 0x11f2000
  v_mov_b32 v40, s10
  buffer_load_dword v42, v40, s[48:51], 0 offen sc1
  s_mul_i32 s62, s69, 10240
  s_lshl_b32 s63, s69, 11
  s_mov_b32 m0, 24576
  s_nop 0
  buffer_load_dwordx4 v8, s[48:51], s62 offen offset:0 sc1 lds
  buffer_load_dwordx4 v9, s[48:51], s62 offen offset:1024 sc1 lds
  buffer_load_dwordx4 v10, s[48:51], s62 offen offset:2048 sc1 lds
  buffer_load_dwordx4 v11, s[48:51], s62 offen offset:3072 sc1 lds
  s_mov_b32 m0, 28672
  s_nop 0
  buffer_load_dwordx4 v12, s[48:51], s63 offen offset:0 sc1 lds
  buffer_load_dwordx4 v13, s[48:51], s63 offen offset:1024 sc1 lds
  s_add_u32 s69, s69, 1
  s_cmp_ge_u32 s69, 24
  s_cselect_b32 s69, 0, s69
  s_barrier
  s_mul_i32 s62, s69, 10240
  s_lshl_b32 s63, s69, 11
  s_mov_b32 m0, 43008
  s_nop 0
  buffer_load_dwordx4 v8, s[48:51], s62 offen offset:0 sc1 lds
  buffer_load_dwordx4 v9, s[48:51], s62 offen offset:1024 sc1 lds
  buffer_load_dwordx4 v10, s[48:51], s62 offen offset:2048 sc1 lds
  buffer_load_dwordx4 v11, s[48:51], s62 offen offset:3072 sc1 lds
  s_mov_b32 m0, 47104
  s_nop 0
  buffer_load_dwordx4 v12, s[48:51], s63 offen offset:0 sc1 lds
  buffer_load_dwordx4 v13, s[48:51], s63 offen offset:1024 sc1 lds
  s_add_u32 s69, s69, 1
  s_cmp_ge_u32 s69, 24
  s_cselect_b32 s69, 0, s69
  s_waitcnt vmcnt(25)
  s_barrier
  s_waitcnt vmcnt(12)
  v_readfirstlane_b32 s72, v42
  s_cmp_ge_u32 s72, 4
  s_cbranch_scc1 fp1_h7_done
fp1_h7:
  buffer_load_dword v21, v40, s[48:51], 0 offen sc1
  s_waitcnt vmcnt(0)
  v_readfirstlane_b32 s72, v21
  s_cmp_ge_u32 s72, 4
  s_cbranch_scc1 fp1_h7_done
  s_sleep 8
  s_branch fp1_h7
fp1_h7_done:
  s_mul_i32 s62, s69, 10240
  s_lshl_b32 s63, s69, 11
  s_mov_b32 m0, 61440
  s_nop 0
  buffer_load_dwordx4 v8, s[48:51], s62 offen offset:0 sc1 lds
  buffer_load_dwordx4 v9, s[48:51], s62 offen offset:1024 sc1 lds
  buffer_load_dwordx4 v10, s[48:51], s62 offen offset:2048 sc1 lds
  buffer_load_dwordx4 v11, s[48:51], s62 offen offset:3072 sc1 lds
  s_mov_b32 m0, 65536
  s_nop 0
  buffer_load_dwordx4 v12, s[48:51], s63 offen offset:0 sc1 lds
  buffer_load_dwordx4 v13, s[48:51], s63 offen offset:1024 sc1 lds
  s_add_u32 s69, s69, 1
  s_cmp_ge_u32 s69, 24
  s_cselect_b32 s69, 0, s69
  s_barrier
  s_lshl_b32 s10, s74, 7
  s_add_u32 s10, s10, 0x11f1000
  v_mov_b32 v40, s10
  buffer_load_dword v42, v40, s[48:51], 0 offen sc1
  s_mul_i32 s62, s69, 10240
  s_lshl_b32 s63, s69, 11
  s_mov_b32 m0, 79872
  s_nop 0
  buffer_load_dwordx4 v8, s[48:51], s62 offen offset:0 sc1 lds
  buffer_load_dwordx4 v9, s[48:51], s62 offen offset:1024 sc1 lds
  buffer_load_dwordx4 v10, s[48:51], s62 offen offset:2048 sc1 lds
  buffer_load_dwordx4 v11, s[48:51], s62 offen offset:3072 sc1 lds
  s_mov_b32 m0, 83968
  s_nop 0
  buffer_load_dwordx4 v12, s[48:51], s63 offen offset:0 sc1 lds
  buffer_load_dwordx4 v13, s[48:51], s63 offen offset:1024 sc1 lds
  s_add_u32 s69, s69, 1
  s_cmp_ge_u32 s69, 24
  s_cselect_b32 s69, 0, s69
  s_barrier
  s_mul_i32 s62, s69, 10240
  s_lshl_b32 s63, s69, 11
  s_mov_b32 m0, 98304
  s_nop 0
  buffer_load_dwordx4 v8, s[48:51], s62 offen offset:0 sc1 lds
  buffer_load_dwordx4 v9, s[48:51], s62 offen offset:1024 sc1 lds
  buffer_load_dwordx4 v10, s[48:51], s62 offen offset:2048 sc1 lds
  buffer_load_dwordx4 v11, s[48:51], s62 offen offset:3072 sc1 lds
  s_mov_b32 m0, 102400
  s_nop 0
  buffer_load_dwordx4 v12, s[48:51], s63 offen offset:0 sc1 lds
  buffer_load_dwordx4 v13, s[48:51], s63 offen offset:1024 sc1 lds
  s_add_u32 s69, s69, 1
  s_cmp_ge_u32 s69, 24
  s_cselect_b32 s69, 0, s69
  s_waitcnt vmcnt(25)
  s_barrier
  s_waitcnt vmcnt(12)
  v_readfirstlane_b32 s72, v42
  s_cmp_ge_u32 s72, 32
  s_cbranch_scc1 fp1_o_done
fp1_o:
  buffer_load_dword v21, v40, s[48:51], 0 offen sc1
  s_waitcnt vmcnt(0)
  v_readfirstlane_b32 s72, v21
  s_cmp_ge_u32 s72, 32
  s_cbranch_scc1 fp1_o_done
  s_sleep 8
  s_branch fp1_o
fp1_o_done:
  s_mul_i32 s69, s73, 10
  s_lshr_b32 s69, s69, 5
  s_mul_i32 s60, s75, 348160
  s_add_u32 s60, s60, 0xf00000
  s_lshl_b32 s61, s74, 2
  s_mul_i32 s61, s61, 69760
  s_add_u32 s61, s61, 0x1000
  s_add_u32 s10, s60, 0x1800
  v_add_u32 v8, s10, v7
  s_add_u32 s10, s60, 0x1800
  v_add_u32 v9, s10, v7
  s_add_u32 s10, s60, 0x1800
  v_add_u32 v10, s10, v7
  s_add_u32 s10, s60, 0x1800
  v_add_u32 v11, s10, v7
  s_add_u32 s10, s61, 0x0
  v_add_u32 v12, s10, v7
  s_add_u32 s10, s61, 0x10c80
  v_add_u32 v13, s10, v7
  s_mul_i32 s62, s69, 10240
  s_lshl_b32 s63, s69, 11
  s_mov_b32 m0, 116736
  s_nop 0
  buffer_load_dwordx4 v8, s[48:51], s62 offen offset:0 sc1 lds
  buffer_load_dwordx4 v9, s[48:51], s62 offen offset:1024 sc1 lds
  buffer_load_dwordx4 v10, s[48:51], s62 offen offset:2048 sc1 lds
  buffer_load_dwordx4 v11, s[48:51], s62 offen offset:3072 sc1 lds
  s_mov_b32 m0, 120832
  s_nop 0
  buffer_load_dwordx4 v12, s[48:51], s63 offen offset:0 sc1 lds
  buffer_load_dwordx4 v13, s[48:51], s63 offen offset:1024 sc1 lds
  s_add_u32 s69, s69, 1
  s_cmp_ge_u32 s69, 10
  s_cselect_b32 s69, 0, s69
  s_barrier
  s_mul_i32 s62, s69, 10240
  s_lshl_b32 s63, s69, 11
  s_mov_b32 m0, 6144
  s_nop 0
  buffer_load_dwordx4 v8, s[48:51], s62 offen offset:0 sc1 lds
  buffer_load_dwordx4 v9, s[48:51], s62 offen offset:1024 sc1 lds
  buffer_load_dwordx4 v10, s[48:51], s62 offen offset:2048 sc1 lds
  buffer_load_dwordx4 v11, s[48:51], s62 offen offset:3072 sc1 lds
  s_mov_b32 m0, 10240
  s_nop 0
  buffer_load_dwordx4 v12, s[48:51], s63 offen offset:0 sc1 lds
  buffer_load_dwordx4 v13, s[48:51], s63 offen offset:1024 sc1 lds
  s_add_u32 s69, s69, 1
  s_cmp_ge_u32 s69, 10
  s_cselect_b32 s69, 0, s69
  s_barrier
  s_mul_i32 s62, s69, 10240
  s_lshl_b32 s63, s69, 11
  s_mov_b32 m0, 24576
  s_nop 0
  buffer_load_dwordx4 v8, s[48:51], s62 offen offset:0 sc1 lds
  buffer_load_dwordx4 v9, s[48:51], s62 offen offset:1024 sc1 lds
  buffer_load_dwordx4 v10, s[48:51], s62 offen offset:2048 sc1 lds
  buffer_load_dwordx4 v11, s[48:51], s62 offen offset:3072 sc1 lds
  s_mov_b32 m0, 28672
  s_nop 0
  buffer_load_dwordx4 v12, s[48:51], s63 offen offset:0 sc1 lds
  buffer_load_dwordx4 v13, s[48:51], s63 offen offset:1024 sc1 lds
  s_add_u32 s69, s69, 1
  s_cmp_ge_u32 s69, 10
  s_cselect_b32 s69, 0, s69
  s_waitcnt vmcnt(24)
  s_barrier
  s_mul_i32 s62, s69, 10240
  s_lshl_b32 s63, s69, 11
  s_mov_b32 m0, 43008
  s_nop 0
  buffer_load_dwordx4 v8, s[48:51], s62 offen offset:0 sc1 lds
  buffer_load_dwordx4 v9, s[48:51], s62 offen offset:1024 sc1 lds
  buffer_load_dwordx4 v10, s[48:51], s62 offen offset:2048 sc1 lds
  buffer_load_dwordx4 v11, s[48:51], s62 offen offset:3072 sc1 lds
  s_mov_b32 m0, 47104
  s_nop 0
  buffer_load_dwordx4 v12, s[48:51], s63 offen offset:0 sc1 lds
  buffer_load_dwordx4 v13, s[48:51], s63 offen offset:1024 sc1 lds
  s_add_u32 s69, s69, 1
  s_cmp_ge_u32 s69, 10
  s_cselect_b32 s69, 0, s69
  s_waitcnt vmcnt(24)
  s_barrier
  s_mul_i32 s62, s69, 10240
  s_lshl_b32 s63, s69, 11
  s_mov_b32 m0, 61440
  s_nop 0
  buffer_load_dwordx4 v8, s[48:51], s62 offen offset:0 sc1 lds
  buffer_load_dwordx4 v9, s[48:51], s62 offen offset:1024 sc1 lds
  buffer_load_dwordx4 v10, s[48:51], s62 offen offset:2048 sc1 lds
  buffer_load_dwordx4 v11, s[48:51], s62 offen offset:3072 sc1 lds
  s_mov_b32 m0, 65536
  s_nop 0
  buffer_load_dwordx4 v12, s[48:51], s63 offen offset:0 sc1 lds
  buffer_load_dwordx4 v13, s[48:51], s63 offen offset:1024 sc1 lds
  s_add_u32 s69, s69, 1
  s_cmp_ge_u32 s69, 10
  s_cselect_b32 s69, 0, s69
  s_waitcnt vmcnt(24)
  s_barrier
  s_mul_i32 s62, s69, 10240
  s_lshl_b32 s63, s69, 11
  s_mov_b32 m0, 79872
  s_nop 0
  buffer_load_dwordx4 v8, s[48:51], s62 offen offset:0 sc1 lds
  buffer_load_dwordx4 v9, s[48:51], s62 offen offset:1024 sc1 lds
  buffer_load_dwordx4 v10, s[48:51], s62 offen offset:2048 sc1 lds
  buffer_load_dwordx4 v11, s[48:51], s62 offen offset:3072 sc1 lds
  s_mov_b32 m0, 83968
  s_nop 0
  buffer_load_dwordx4 v12, s[48:51], s63 offen offset:0 sc1 lds
  buffer_load_dwordx4 v13, s[48:51], s63 offen offset:1024 sc1 lds
  s_add_u32 s69, s69, 1
  s_cmp_ge_u32 s69, 10
  s_cselect_b32 s69, 0, s69
  s_waitcnt vmcnt(24)
  s_barrier
  s_mul_i32 s62, s69, 10240
  s_lshl_b32 s63, s69, 11
  s_mov_b32 m0, 98304
  s_nop 0
  buffer_load_dwordx4 v8, s[48:51], s62 offen offset:0 sc1 lds
  buffer_load_dwordx4 v9, s[48:51], s62 offen offset:1024 sc1 lds
  buffer_load_dwordx4 v10, s[48:51], s62 offen offset:2048 sc1 lds
  buffer_load_dwordx4 v11, s[48:51], s62 offen offset:3072 sc1 lds
  s_mov_b32 m0, 102400
  s_nop 0
  buffer_load_dwordx4 v12, s[48:51], s63 offen offset:0 sc1 lds
  buffer_load_dwordx4 v13, s[48:51], s63 offen offset:1024 sc1 lds
  s_add_u32 s69, s69, 1
  s_cmp_ge_u32 s69, 10
  s_cselect_b32 s69, 0, s69
  s_waitcnt vmcnt(24)
  s_barrier
  s_mul_i32 s62, s69, 10240
  s_lshl_b32 s63, s69, 11
  s_mov_b32 m0, 116736
  s_nop 0
  buffer_load_dwordx4 v8, s[48:51], s62 offen offset:0 sc1 lds
  buffer_load_dwordx4 v9, s[48:51], s62 offen offset:1024 sc1 lds
  buffer_load_dwordx4 v10, s[48:51], s62 offen offset:2048 sc1 lds
  buffer_load_dwordx4 v11, s[48:51], s62 offen offset:3072 sc1 lds
  s_mov_b32 m0, 120832
  s_nop 0
  buffer_load_dwordx4 v12, s[48:51], s63 offen offset:0 sc1 lds
  buffer_load_dwordx4 v13, s[48:51], s63 offen offset:1024 sc1 lds
  s_add_u32 s69, s69, 1
  s_cmp_ge_u32 s69, 10
  s_cselect_b32 s69, 0, s69
  s_waitcnt vmcnt(24)
  s_barrier
  s_mul_i32 s62, s69, 10240
  s_lshl_b32 s63, s69, 11
  s_mov_b32 m0, 6144
  s_nop 0
  buffer_load_dwordx4 v8, s[48:51], s62 offen offset:0 sc1 lds
  buffer_load_dwordx4 v9, s[48:51], s62 offen offset:1024 sc1 lds
  buffer_load_dwordx4 v10, s[48:51], s62 offen offset:2048 sc1 lds
  buffer_load_dwordx4 v11, s[48:51], s62 offen offset:3072 sc1 lds
  s_mov_b32 m0, 10240
  s_nop 0
  buffer_load_dwordx4 v12, s[48:51], s63 offen offset:0 sc1 lds
  buffer_load_dwordx4 v13, s[48:51], s63 offen offset:1024 sc1 lds
  s_add_u32 s69, s69, 1
  s_cmp_ge_u32 s69, 10
  s_cselect_b32 s69, 0, s69
  s_waitcnt vmcnt(24)
  s_barrier
  s_mul_i32 s62, s69, 10240
  s_lshl_b32 s63, s69, 11
  s_mov_b32 m0, 24576
  s_nop 0
  buffer_load_dwordx4 v8, s[48:51], s62 offen offset:0 sc1 lds
  buffer_load_dwordx4 v9, s[48:51], s62 offen offset:1024 sc1 lds
  buffer_load_dwordx4 v10, s[48:51], s62 offen offset:2048 sc1 lds
  buffer_load_dwordx4 v11, s[48:51], s62 offen offset:3072 sc1 lds
  s_mov_b32 m0, 28672
  s_nop 0
  buffer_load_dwordx4 v12, s[48:51], s63 offen offset:0 sc1 lds
  buffer_load_dwordx4 v13, s[48:51], s63 offen offset:1024 sc1 lds
  s_add_u32 s69, s69, 1
  s_cmp_ge_u32 s69, 10
  s_cselect_b32 s69, 0, s69
  s_waitcnt vmcnt(24)
  s_barrier
  s_waitcnt vmcnt(18)
  s_barrier
  s_waitcnt vmcnt(12)
  s_barrier
  s_waitcnt vmcnt(6)
  s_barrier
  s_waitcnt vmcnt(0)
  s_barrier
  s_endpgm
fp_p2:
  s_mul_i32 s69, s73, 10
  s_lshr_b32 s69, s69, 5
  s_mul_i32 s60, s75, 102400
  s_add_u32 s60, s60, 0xe00000
  s_lshl_b32 s61, s74, 6
  v_lshrrev_b32 v14, 3, v0
  v_add_u32 v15, s61, v14
  v_mul_u32_u24 v15, 1280, v15
  v_lshrrev_b32 v14, 1, v14
  v_and_b32 v16, 7, v0
  v_xor_b32 v16, v16, v14
  v_lshl_add_u32 v17, v16, 4, v15
  v_xor_b32 v16, 4, v16
  v_lshl_add_u32 v18, v16, 4, v15
  v_add_u32 v8, 20480, v17
  v_add_u32 v9, 30720, v18
  v_add_u32 v10, 40960, v17
  v_add_u32 v11, 51200, v18
  v_add_u32 v12, 61440, v17
  v_add_u32 v13, 71680, v18
  s_lshl_b32 s63, s69, 7
  s_mov_b32 m0, 12288
  s_nop 0
  buffer_load_dwordx4 v8, s[40:43], s63 offen offset:0 lds
  s_mov_b32 m0, 13312
  s_nop 0
  buffer_load_dwordx4 v9, s[40:43], s63 offen offset:0 lds
  s_mov_b32 m0, 14336
  s_nop 0
  buffer_load_dwordx4 v10, s[40:43], s63 offen offset:0 lds
  s_mov_b32 m0, 15360
  s_nop 0
  buffer_load_dwordx4 v11, s[40:43], s63 offen offset:0 lds
  s_mov_b32 m0, 16384
  s_nop 0
  buffer_load_dwordx4 v12, s[40:43], s63 offen offset:0 lds
  s_mov_b32 m0, 17408
  s_nop 0
  buffer_load_dwordx4 v13, s[40:43], s63 offen offset:0 lds
  s_add_u32 s69, s69, 1
  s_cmp_ge_u32 s69, 10
  s_cselect_b32 s69, 0, s69
  s_lshl_b32 s63, s69, 7
  s_mov_b32 m0, 30720
  s_nop 0
  buffer_load_dwordx4 v8, s[40:43], s63 offen offset:0 lds
  s_mov_b32 m0, 31744
  s_nop 0
  buffer_load_dwordx4 v9, s[40:43], s63 offen offset:0 lds
  s_mov_b32 m0, 32768
  s_nop 0
  buffer_load_dwordx4 v10, s[40:43], s63 offen offset:0 lds
  s_mov_b32 m0, 33792
  s_nop 0
  buffer_load_dwordx4 v11, s[40:43], s63 offen offset:0 lds
  s_mov_b32 m0, 34816
  s_nop 0
  buffer_load_dwordx4 v12, s[40:43], s63 offen offset:0 lds
  s_mov_b32 m0, 35840
  s_nop 0
  buffer_load_dwordx4 v13, s[40:43], s63 offen offset:0 lds
  s_add_u32 s69, s69, 1
  s_cmp_ge_u32 s69, 10
  s_cselect_b32 s69, 0, s69
  s_lshl_b32 s63, s69, 7
  s_mov_b32 m0, 49152
  s_nop 0
  buffer_load_dwordx4 v8, s[40:43], s63 offen offset:0 lds
  s_mov_b32 m0, 50176
  s_nop 0
  buffer_load_dwordx4 v9, s[40:43], s63 offen offset:0 lds
  s_mov_b32 m0, 51200
  s_nop 0
  buffer_load_dwordx4 v10, s[40:43], s63 offen offset:0 lds
  s_mov_b32 m0, 52224
  s_nop 0
  buffer_load_dwordx4 v11, s[40:43], s63 offen offset:0 lds
  s_mov_b32 m0, 53248
  s_nop 0
  buffer_load_dwordx4 v12, s[40:43], s63 offen offset:0 lds
  s_mov_b32 m0, 54272
  s_nop 0
  buffer_load_dwordx4 v13, s[40:43], s63 offen offset:0 lds
  s_add_u32 s69, s69, 1
  s_cmp_ge_u32 s69, 10
  s_cselect_b32 s69, 0, s69
  s_lshl_b32 s63, s69, 7
  s_mov_b32 m0, 67584
  s_nop 0
  buffer_load_dwordx4 v8, s[40:43], s63 offen offset:0 lds
  s_mov_b32 m0, 68608
  s_nop 0
  buffer_load_dwordx4 v9, s[40:43], s63 offen offset:0 lds
  s_mov_b32 m0, 69632
  s_nop 0
  buffer_load_dwordx4 v10, s[40:43], s63 offen offset:0 lds
  s_mov_b32 m0, 70656
  s_nop 0
  buffer_load_dwordx4 v11, s[40:43], s63 offen offset:0 lds
  s_mov_b32 m0, 71680
  s_nop 0
  buffer_load_dwordx4 v12, s[40:43], s63 offen offset:0 lds
  s_mov_b32 m0, 72704
  s_nop 0
  buffer_load_dwordx4 v13, s[40:43], s63 offen offset:0 lds
  s_add_u32 s69, s69, 1
  s_cmp_ge_u32 s69, 10
  s_cselect_b32 s69, 0, s69
  s_cmp_ge_u32 s6, 2
  s_cbranch_scc1 fp2_noe
  s_barrier
  s_barrier
fp2_noe:
  s_lshl_b32 s63, s69, 7
  s_mov_b32 m0, 86016
  s_nop 0
  buffer_load_dwordx4 v8, s[40:43], s63 offen offset:0 lds
  s_mov_b32 m0, 87040
  s_nop 0
  buffer_load_dwordx4 v9, s[40:43], s63 offen offset:0 lds
  s_mov_b32 m0, 88064
  s_nop 0
  buffer_load_dwordx4 v10, s[40:43], s63 offen offset:0 lds
  s_mov_b32 m0, 89088
  s_nop 0
  buffer_load_dwordx4 v11, s[40:43], s63 offen offset:0 lds
  s_mov_b32 m0, 90112
  s_nop 0
  buffer_load_dwordx4 v12, s[40:43], s63 offen offset:0 lds
  s_mov_b32 m0, 91136
  s_nop 0
  buffer_load_dwordx4 v13, s[40:43], s63 offen offset:0 lds
  s_add_u32 s69, s69, 1
  s_cmp_ge_u32 s69, 10
  s_cselect_b32 s69, 0, s69
  s_lshl_b32 s63, s69, 7
  s_mov_b32 m0, 104448
  s_nop 0
  buffer_load_dwordx4 v8, s[40:43], s63 offen offset:0 lds
  s_mov_b32 m0, 105472
  s_nop 0
  buffer_load_dwordx4 v9, s[40:43], s63 offen offset:0 lds
  s_mov_b32 m0, 106496
  s_nop 0
  buffer_load_dwordx4 v10, s[40:43], s63 offen offset:0 lds
  s_mov_b32 m0, 107520
  s_nop 0
  buffer_load_dwordx4 v11, s[40:43], s63 offen offset:0 lds
  s_mov_b32 m0, 108544
  s_nop 0
  buffer_load_dwordx4 v12, s[40:43], s63 offen offset:0 lds
  s_mov_b32 m0, 109568
  s_nop 0
  buffer_load_dwordx4 v13, s[40:43], s63 offen offset:0 lds
  s_add_u32 s69, s69, 1
  s_cmp_ge_u32 s69, 10
  s_cselect_b32 s69, 0, s69
  s_waitcnt vmcnt(30)
  s_barrier
  s_lshl_b32 s63, s69, 7
  s_mov_b32 m0, 122880
  s_nop 0
  buffer_load_dwordx4 v8, s[40:43], s63 offen offset:0 lds
  s_mov_b32 m0, 123904
  s_nop 0
  buffer_load_dwordx4 v9, s[40:43], s63 offen offset:0 lds
  s_mov_b32 m0, 124928
  s_nop 0
  buffer_load_dwordx4 v10, s[40:43], s63 offen offset:0 lds
  s_mov_b32 m0, 125952
  s_nop 0
  buffer_load_dwordx4 v11, s[40:43], s63 offen offset:0 lds
  s_mov_b32 m0, 126976
  s_nop 0
  buffer_load_dwordx4 v12, s[40:43], s63 offen offset:0 lds
  s_mov_b32 m0, 128000
  s_nop 0
  buffer_load_dwordx4 v13, s[40:43], s63 offen offset:0 lds
  s_add_u32 s69, s69, 1
  s_cmp_ge_u32 s69, 10
  s_cselect_b32 s69, 0, s69
  s_waitcnt vmcnt(30)
  s_barrier
  s_waitcnt vmcnt(24)
  s_barrier
  s_lshl_b32 s63, s69, 7
  s_mov_b32 m0, 12288
  s_nop 0
  buffer_load_dwordx4 v8, s[40:43], s63 offen offset:0 lds
  s_mov_b32 m0, 13312
  s_nop 0
  buffer_load_dwordx4 v9, s[40:43], s63 offen offset:0 lds
  s_mov_b32 m0, 14336
  s_nop 0
  buffer_load_dwordx4 v10, s[40:43], s63 offen offset:0 lds
  s_mov_b32 m0, 15360
  s_nop 0
  buffer_load_dwordx4 v11, s[40:43], s63 offen offset:0 lds
  s_mov_b32 m0, 16384
  s_nop 0
  buffer_load_dwordx4 v12, s[40:43], s63 offen offset:0 lds
  s_mov_b32 m0, 17408
  s_nop 0
  buffer_load_dwordx4 v13, s[40:43], s63 offen offset:0 lds
  s_add_u32 s69, s69, 1
  s_cmp_ge_u32 s69, 10
  s_cselect_b32 s69, 0, s69
  s_waitcnt vmcnt(24)
  s_barrier
  s_lshr_b32 s10, s73, 2
  s_add_u32 s10, s10, 0
  s_and_b32 s10, s10, 7
  s_lshr_b32 s11, s74, 1
  s_lshl_b32 s11, s11, 3
  s_add_u32 s10, s10, s11
  s_lshl_b32 s10, s10, 7
  s_add_u32 s10, s10, 0x11f2000
  v_mov_b32 v40, s10
  buffer_load_dword v42, v40, s[48:51], 0 offen sc1
  s_lshl_b32 s63, s69, 7
  s_mov_b32 m0, 30720
  s_nop 0
  buffer_load_dwordx4 v8, s[40:43], s63 offen offset:0 lds
  s_mov_b32 m0, 31744
  s_nop 0
  buffer_load_dwordx4 v9, s[40:43], s63 offen offset:0 lds
  s_mov_b32 m0, 32768
  s_nop 0
  buffer_load_dwordx4 v10, s[40:43], s63 offen offset:0 lds
  s_mov_b32 m0, 33792
  s_nop 0
  buffer_load_dwordx4 v11, s[40:43], s63 offen offset:0 lds
  s_mov_b32 m0, 34816
  s_nop 0
  buffer_load_dwordx4 v12, s[40:43], s63 offen offset:0 lds
  s_mov_b32 m0, 35840
  s_nop 0
  buffer_load_dwordx4 v13, s[40:43], s63 offen offset:0 lds
  s_add_u32 s69, s69, 1
  s_cmp_ge_u32 s69, 10
  s_cselect_b32 s69, 0, s69
  s_waitcnt vmcnt(25)
  s_barrier
  s_lshl_b32 s63, s69, 7
  s_mov_b32 m0, 49152
  s_nop 0
  buffer_load_dwordx4 v8, s[40:43], s63 offen offset:0 lds
  s_mov_b32 m0, 50176
  s_nop 0
  buffer_load_dwordx4 v9, s[40:43], s63 offen offset:0 lds
  s_mov_b32 m0, 51200
  s_nop 0
  buffer_load_dwordx4 v10, s[40:43], s63 offen offset:0 lds
  s_mov_b32 m0, 52224
  s_nop 0
  buffer_load_dwordx4 v11, s[40:43], s63 offen offset:0 lds
  s_mov_b32 m0, 53248
  s_nop 0
  buffer_load_dwordx4 v12, s[40:43], s63 offen offset:0 lds
  s_mov_b32 m0, 54272
  s_nop 0
  buffer_load_dwordx4 v13, s[40:43], s63 offen offset:0 lds
  s_add_u32 s69, s69, 1
  s_cmp_ge_u32 s69, 10
  s_cselect_b32 s69, 0, s69
  s_waitcnt vmcnt(25)
  s_barrier
  s_waitcnt vmcnt(12)
  v_readfirstlane_b32 s72, v42
  s_cmp_ge_u32 s72, 4
  s_cbranch_scc1 fp2_h0_done
fp2_h0:
  buffer_load_dword v21, v40, s[48:51], 0 offen sc1
  s_waitcnt vmcnt(0)
  v_readfirstlane_b32 s72, v21
  s_cmp_ge_u32 s72, 4
  s_cbranch_scc1 fp2_h0_done
  s_sleep 8
  s_branch fp2_h0
fp2_h0_done:
  s_lshr_b32 s69, s73, 2
  s_mul_i32 s69, s69, 3
  s_mul_i32 s60, s75, 348160
  s_add_u32 s60, s60, 0xf19000
  s_lshl_b32 s61, s74, 2
  s_mul_i32 s61, s61, 69760
  s_add_u32 s61, s61, 0x6000
  s_add_u32 s10, s61, 0x22100
  v_add_u32 v8, s10, v7
  s_add_u32 s10, s61, 0x32d80
  v_add_u32 v9, s10, v7
  s_add_u32 s10, s61, 0xfffffc00
  v_add_u32 v10, s10, v7
  s_add_u32 s10, s61, 0x10880
  v_add_u32 v11, s10, v7
  s_add_u32 s10, s61, 0x22500
  v_add_u32 v12, s10, v7
  s_add_u32 s10, s61, 0x33180
  v_add_u32 v13, s10, v7
  s_lshl_b32 s63, s69, 11
  s_mov_b32 m0, 67584
  s_nop 0
  buffer_load_dwordx4 v8, s[48:51], s63 offen offset:0 sc1 lds
  buffer_load_dwordx4 v9, s[48:51], s63 offen offset:1024 sc1 lds
  buffer_load_dwordx4 v10, s[48:51], s63 offen offset:2048 sc1 lds
  buffer_load_dwordx4 v11, s[48:51], s63 offen offset:3072 sc1 lds
  s_mov_b32 m0, 71680
  s_nop 0
  buffer_load_dwordx4 v12, s[48:51], s63 offen offset:0 sc1 lds
  buffer_load_dwordx4 v13, s[48:51], s63 offen offset:1024 sc1 lds
  s_add_u32 s69, s69, 1
  s_cmp_ge_u32 s69, 24
  s_cselect_b32 s69, 0, s69
  s_barrier
  s_lshr_b32 s10, s73, 2
  s_add_u32 s10, s10, 1
  s_and_b32 s10, s10, 7
  s_lshr_b32 s11, s74, 1
  s_lshl_b32 s11, s11, 3
  s_add_u32 s10, s10, s11
  s_lshl_b32 s10, s10, 7
  s_add_u32 s10, s10, 0x11f2000
  v_mov_b32 v40, s10
  buffer_load_dword v42, v40, s[48:51], 0 offen sc1
  s_lshl_b32 s63, s69, 11
  s_mov_b32 m0, 86016
  s_nop 0
  buffer_load_dwordx4 v8, s[48:51], s63 offen offset:0 sc1 lds
  buffer_load_dwordx4 v9, s[48:51], s63 offen offset:1024 sc1 lds
  buffer_load_dwordx4 v10, s[48:51], s63 offen offset:2048 sc1 lds
  buffer_load_dwordx4 v11, s[48:51], s63 offen offset:3072 sc1 lds
  s_mov_b32 m0, 90112
  s_nop 0
  buffer_load_dwordx4 v12, s[48:51], s63 offen offset:0 sc1 lds
  buffer_load_dwordx4 v13, s[48:51], s63 offen offset:1024 sc1 lds
  s_add_u32 s69, s69, 1
  s_cmp_ge_u32 s69, 24
  s_cselect_b32 s69, 0, s69
  s_barrier
  s_lshl_b32 s63, s69, 11
  s_mov_b32 m0, 104448
  s_nop 0
  buffer_load_dwordx4 v8, s[48:51], s63 offen offset:0 sc1 lds
  buffer_load_dwordx4 v9, s[48:51], s63 offen offset:1024 sc1 lds
  buffer_load_dwordx4 v10, s[48:51], s63 offen offset:2048 sc1 lds
  buffer_load_dwordx4 v11, s[48:51], s63 offen offset:3072 sc1 lds
  s_mov_b32 m0, 108544
  s_nop 0
  buffer_load_dwordx4 v12, s[48:51], s63 offen offset:0 sc1 lds
  buffer_load_dwordx4 v13, s[48:51], s63 offen offset:1024 sc1 lds
  s_add_u32 s69, s69, 1
  s_cmp_ge_u32 s69, 24
  s_cselect_b32 s69, 0, s69
  s_waitcnt vmcnt(25)
  s_barrier
  s_waitcnt vmcnt(12)
  v_readfirstlane_b32 s72, v42
  s_cmp_ge_u32 s72, 4
  s_cbranch_scc1 fp2_h1_done
fp2_h1:
  buffer_load_dword v21, v40, s[48:51], 0 offen sc1
  s_waitcnt vmcnt(0)
  v_readfirstlane_b32 s72, v21
  s_cmp_ge_u32 s72, 4
  s_cbranch_scc1 fp2_h1_done
  s_sleep 8
  s_branch fp2_h1
fp2_h1_done:
  s_lshl_b32 s63, s69, 11
  s_mov_b32 m0, 122880
  s_nop 0
  buffer_load_dwordx4 v8, s[48:51], s63 offen offset:0 sc1 lds
  buffer_load_dwordx4 v9, s[48:51], s63 offen offset:1024 sc1 lds
  buffer_load_dwordx4 v10, s[48:51], s63 offen offset:2048 sc1 lds
  buffer_load_dwordx4 v11, s[48:51], s63 offen offset:3072 sc1 lds
  s_mov_b32 m0, 126976
  s_nop 0
  buffer_load_dwordx4 v12, s[48:51], s63 offen offset:0 sc1 lds
  buffer_load_dwordx4 v13, s[48:51], s63 offen offset:1024 sc1 lds
  s_add_u32 s69, s69, 1
  s_cmp_ge_u32 s69, 24
  s_cselect_b32 s69, 0, s69
  s_barrier
  s_lshr_b32 s10, s73, 2
  s_add_u32 s10, s10, 2
  s_and_b32 s10, s10, 7
  s_lshr_b32 s11, s74, 1
  s_lshl_b32 s11, s11, 3
  s_add_u32 s10, s10, s11
  s_lshl_b32 s10, s10, 7
  s_add_u32 s10, s10, 0x11f2000
  v_mov_b32 v40, s10
  buffer_load_dword v42, v40, s[48:51], 0 offen sc1
  s_lshl_b32 s63, s69, 11
  s_mov_b32 m0, 12288
  s_nop 0
  buffer_load_dwordx4 v8, s[48:51], s63 offen offset:0 sc1 lds
  buffer_load_dwordx4 v9, s[48:51], s63 offen offset:1024 sc1 lds
  buffer_load_dwordx4 v10, s[48:51], s63 offen offset:2048 sc1 lds
  buffer_load_dwordx4 v11, s[48:51], s63 offen offset:3072 sc1 lds
  s_mov_b32 m0, 16384
  s_nop 0
  buffer_load_dwordx4 v12, s[48:51], s63 offen offset:0 sc1 lds
  buffer_load_dwordx4 v13, s[48:51], s63 offen offset:1024 sc1 lds
  s_add_u32 s69, s69, 1
  s_cmp_ge_u32 s69, 24
  s_cselect_b32 s69, 0, s69
  s_barrier
  s_lshl_b32 s63, s69, 11
  s_mov_b32 m0, 30720
  s_nop 0
  buffer_load_dwordx4 v8, s[48:51], s63 offen offset:0 sc1 lds
  buffer_load_dwordx4 v9, s[48:51], s63 offen offset:1024 sc1 lds
  buffer_load_dwordx4 v10, s[48:51], s63 offen offset:2048 sc1 lds
  buffer_load_dwordx4 v11, s[48:51], s63 offen offset:3072 sc1 lds
  s_mov_b32 m0, 34816
  s_nop 0
  buffer_load_dwordx4 v12, s[48:51], s63 offen offset:0 sc1 lds
  buffer_load_dwordx4 v13, s[48:51], s63 offen offset:1024 sc1 lds
  s_add_u32 s69, s69, 1
  s_cmp_ge_u32 s69, 24
  s_cselect_b32 s69, 0, s69
  s_waitcnt vmcnt(25)
  s_barrier
  s_waitcnt vmcnt(12)
  v_readfirstlane_b32 s72, v42
  s_cmp_ge_u32 s72, 4
  s_cbranch_scc1 fp2_h2_done
fp2_h2:
  buffer_load_dword v21, v40, s[48:51], 0 offen sc1
  s_waitcnt vmcnt(0)
  v_readfirstlane_b32 s72, v21
  s_cmp_ge_u32 s72, 4
  s_cbranch_scc1 fp2_h2_done
  s_sleep 8
  s_branch fp2_h2
fp2_h2_done:
  s_lshl_b32 s63, s69, 11
  s_mov_b32 m0, 49152
  s_nop 0
  buffer_load_dwordx4 v8, s[48:51], s63 offen offset:0 sc1 lds
  buffer_load_dwordx4 v9, s[48:51], s63 offen offset:1024 sc1 lds
  buffer_load_dwordx4 v10, s[48:51], s63 offen offset:2048 sc1 lds
  buffer_load_dwordx4 v11, s[48:51], s63 offen offset:3072 sc1 lds
  s_mov_b32 m0, 53248
  s_nop 0
  buffer_load_dwordx4 v12, s[48:51], s63 offen offset:0 sc1 lds
  buffer_load_dwordx4 v13, s[48:51], s63 offen offset:1024 sc1 lds
  s_add_u32 s69, s69, 1
  s_cmp_ge_u32 s69, 24
  s_cselect_b32 s69, 0, s69
  s_barrier
  s_lshr_b32 s10, s73, 2
  s_add_u32 s10, s10, 3
  s_and_b32 s10, s10, 7
  s_lshr_b32 s11, s74, 1
  s_lshl_b32 s11, s11, 3
  s_add_u32 s10, s10, s11
  s_lshl_b32 s10, s10, 7
  s_add_u32 s10, s10, 0x11f2000
  v_mov_b32 v40, s10
  buffer_load_dword v42, v40, s[48:51], 0 offen sc1
  s_lshl_b32 s63, s69, 11
  s_mov_b32 m0, 67584
  s_nop 0
  buffer_load_dwordx4 v8, s[48:51], s63 offen offset:0 sc1 lds
  buffer_load_dwordx4 v9, s[48:51], s63 offen offset:1024 sc1 lds
  buffer_load_dwordx4 v10, s[48:51], s63 offen offset:2048 sc1 lds
  buffer_load_dwordx4 v11, s[48:51], s63 offen offset:3072 sc1 lds
  s_mov_b32 m0, 71680
  s_nop 0
  buffer_load_dwordx4 v12, s[48:51], s63 offen offset:0 sc1 lds
  buffer_load_dwordx4 v13, s[48:51], s63 offen offset:1024 sc1 lds
  s_add_u32 s69, s69, 1
  s_cmp_ge_u32 s69, 24
  s_cselect_b32 s69, 0, s69
  s_barrier
  s_lshl_b32 s63, s69, 11
  s_mov_b32 m0, 86016
  s_nop 0
  buffer_load_dwordx4 v8, s[48:51], s63 offen offset:0 sc1 lds
  buffer_load_dwordx4 v9, s[48:51], s63 offen offset:1024 sc1 lds
  buffer_load_dwordx4 v10, s[48:51], s63 offen offset:2048 sc1 lds
  buffer_load_dwordx4 v11, s[48:51], s63 offen offset:3072 sc1 lds
  s_mov_b32 m0, 90112
  s_nop 0
  buffer_load_dwordx4 v12, s[48:51], s63 offen offset:0 sc1 lds
  buffer_load_dwordx4 v13, s[48:51], s63 offen offset:1024 sc1 lds
  s_add_u32 s69, s69, 1
  s_cmp_ge_u32 s69, 24
  s_cselect_b32 s69, 0, s69
  s_waitcnt vmcnt(25)
  s_barrier
  s_waitcnt vmcnt(12)
  v_readfirstlane_b32 s72, v42
  s_cmp_ge_u32 s72, 4
  s_cbranch_scc1 fp2_h3_done
fp2_h3:
  buffer_load_dword v21, v40, s[48:51], 0 offen sc1
  s_waitcnt vmcnt(0)
  v_readfirstlane_b32 s72, v21
  s_cmp_ge_u32 s72, 4
  s_cbranch_scc1 fp2_h3_done
  s_sleep 8
  s_branch fp2_h3
fp2_h3_done:
  s_lshl_b32 s63, s69, 11
  s_mov_b32 m0, 104448
  s_nop 0
  buffer_load_dwordx4 v8, s[48:51], s63 offen offset:0 sc1 lds
  buffer_load_dwordx4 v9, s[48:51], s63 offen offset:1024 sc1 lds
  buffer_load_dwordx4 v10, s[48:51], s63 offen offset:2048 sc1 lds
  buffer_load_dwordx4 v11, s[48:51], s63 offen offset:3072 sc1 lds
  s_mov_b32 m0, 108544
  s_nop 0
  buffer_load_dwordx4 v12, s[48:51], s63 offen offset:0 sc1 lds
  buffer_load_dwordx4 v13, s[48:51], s63 offen offset:1024 sc1 lds
  s_add_u32 s69, s69, 1
  s_cmp_ge_u32 s69, 24
  s_cselect_b32 s69, 0, s69
  s_barrier
  s_lshr_b32 s10, s73, 2
  s_add_u32 s10, s10, 4
  s_and_b32 s10, s10, 7
  s_lshr_b32 s11, s74, 1
  s_lshl_b32 s11, s11, 3
  s_add_u32 s10, s10, s11
  s_lshl_b32 s10, s10, 7
  s_add_u32 s10, s10, 0x11f2000
  v_mov_b32 v40, s10
  buffer_load_dword v42, v40, s[48:51], 0 offen sc1
  s_lshl_b32 s63, s69, 11
  s_mov_b32 m0, 122880
  s_nop 0
  buffer_load_dwordx4 v8, s[48:51], s63 offen offset:0 sc1 lds
  buffer_load_dwordx4 v9, s[48:51], s63 offen offset:1024 sc1 lds
  buffer_load_dwordx4 v10, s[48:51], s63 offen offset:2048 sc1 lds
  buffer_load_dwordx4 v11, s[48:51], s63 offen offset:3072 sc1 lds
  s_mov_b32 m0, 126976
  s_nop 0
  buffer_load_dwordx4 v12, s[48:51], s63 offen offset:0 sc1 lds
  buffer_load_dwordx4 v13, s[48:51], s63 offen offset:1024 sc1 lds
  s_add_u32 s69, s69, 1
  s_cmp_ge_u32 s69, 24
  s_cselect_b32 s69, 0, s69
  s_barrier
  s_lshl_b32 s63, s69, 11
  s_mov_b32 m0, 12288
  s_nop 0
  buffer_load_dwordx4 v8, s[48:51], s63 offen offset:0 sc1 lds
  buffer_load_dwordx4 v9, s[48:51], s63 offen offset:1024 sc1 lds
  buffer_load_dwordx4 v10, s[48:51], s63 offen offset:2048 sc1 lds
  buffer_load_dwordx4 v11, s[48:51], s63 offen offset:3072 sc1 lds
  s_mov_b32 m0, 16384
  s_nop 0
  buffer_load_dwordx4 v12, s[48:51], s63 offen offset:0 sc1 lds
  buffer_load_dwordx4 v13, s[48:51], s63 offen offset:1024 sc1 lds
  s_add_u32 s69, s69, 1
  s_cmp_ge_u32 s69, 24
  s_cselect_b32 s69, 0, s69
  s_waitcnt vmcnt(25)
  s_barrier
  s_waitcnt vmcnt(12)
  v_readfirstlane_b32 s72, v42
  s_cmp_ge_u32 s72, 4
  s_cbranch_scc1 fp2_h4_done
fp2_h4:
  buffer_load_dword v21, v40, s[48:51], 0 offen sc1
  s_waitcnt vmcnt(0)
  v_readfirstlane_b32 s72, v21
  s_cmp_ge_u32 s72, 4
  s_cbranch_scc1 fp2_h4_done
  s_sleep 8
  s_branch fp2_h4
fp2_h4_done:
  s_lshl_b32 s63, s69, 11
  s_mov_b32 m0, 30720
  s_nop 0
  buffer_load_dwordx4 v8, s[48:51], s63 offen offset:0 sc1 lds
  buffer_load_dwordx4 v9, s[48:51], s63 offen offset:1024 sc1 lds
  buffer_load_dwordx4 v10, s[48:51], s63 offen offset:2048 sc1 lds
  buffer_load_dwordx4 v11, s[48:51], s63 offen offset:3072 sc1 lds
  s_mov_b32 m0, 34816
  s_nop 0
  buffer_load_dwordx4 v12, s[48:51], s63 offen offset:0 sc1 lds
  buffer_load_dwordx4 v13, s[48:51], s63 offen offset:1024 sc1 lds
  s_add_u32 s69, s69, 1
  s_cmp_ge_u32 s69, 24
  s_cselect_b32 s69, 0, s69
  s_barrier
  s_lshr_b32 s10, s73, 2
  s_add_u32 s10, s10, 5
  s_and_b32 s10, s10, 7
  s_lshr_b32 s11, s74, 1
  s_lshl_b32 s11, s11, 3
  s_add_u32 s10, s10, s11
  s_lshl_b32 s10, s10, 7
  s_add_u32 s10, s10, 0x11f2000
  v_mov_b32 v40, s10
  buffer_load_dword v42, v40, s[48:51], 0 offen sc1
  s_lshl_b32 s63, s69, 11
  s_mov_b32 m0, 49152
  s_nop 0
  buffer_load_dwordx4 v8, s[48:51], s63 offen offset:0 sc1 lds
  buffer_load_dwordx4 v9, s[48:51], s63 offen offset:1024 sc1 lds
  buffer_load_dwordx4 v10, s[48:51], s63 offen offset:2048 sc1 lds
  buffer_load_dwordx4 v11, s[48:51], s63 offen offset:3072 sc1 lds
  s_mov_b32 m0, 53248
  s_nop 0
  buffer_load_dwordx4 v12, s[48:51], s63 offen offset:0 sc1 lds
  buffer_load_dwordx4 v13, s[48:51], s63 offen offset:1024 sc1 lds
  s_add_u32 s69, s69, 1
  s_cmp_ge_u32 s69, 24
  s_cselect_b32 s69, 0, s69
  s_barrier
  s_lshl_b32 s63, s69, 11
  s_mov_b32 m0, 67584
  s_nop 0
  buffer_load_dwordx4 v8, s[48:51], s63 offen offset:0 sc1 lds
  buffer_load_dwordx4 v9, s[48:51], s63 offen offset:1024 sc1 lds
  buffer_load_dwordx4 v10, s[48:51], s63 offen offset:2048 sc1 lds
  buffer_load_dwordx4 v11, s[48:51], s63 offen offset:3072 sc1 lds
  s_mov_b32 m0, 71680
  s_nop 0
  buffer_load_dwordx4 v12, s[48:51], s63 offen offset:0 sc1 lds
  buffer_load_dwordx4 v13, s[48:51], s63 offen offset:1024 sc1 lds
  s_add_u32 s69, s69, 1
  s_cmp_ge_u32 s69, 24
  s_cselect_b32 s69, 0, s69
  s_barrier
  s_waitcnt vmcnt(25)
  s_barrier
  s_waitcnt vmcnt(12)
  v_readfirstlane_b32 s72, v42
  s_cmp_ge_u32 s72, 4
  s_cbranch_scc1 fp2_h5_done
fp2_h5:
  buffer_load_dword v21, v40, s[48:51], 0 offen sc1
  s_waitcnt vmcnt(0)
  v_readfirstlane_b32 s72, v21
  s_cmp_ge_u32 s72, 4
  s_cbranch_scc1 fp2_h5_done
  s_sleep 8
  s_branch fp2_h5
fp2_h5_done:
  s_lshl_b32 s63, s69, 11
  s_mov_b32 m0, 86016
  s_nop 0
  buffer_load_dwordx4 v8, s[48:51], s63 offen offset:0 sc1 lds
  buffer_load_dwordx4 v9, s[48:51], s63 offen offset:1024 sc1 lds
  buffer_load_dwordx4 v10, s[48:51], s63 offen offset:2048 sc1 lds
  buffer_load_dwordx4 v11, s[48:51], s63 offen offset:3072 sc1 lds
  s_mov_b32 m0, 90112
  s_nop 0
  buffer_load_dwordx4 v12, s[48:51], s63 offen offset:0 sc1 lds
  buffer_load_dwordx4 v13, s[48:51], s63 offen offset:1024 sc1 lds
  s_add_u32 s69, s69, 1
  s_cmp_ge_u32 s69, 24
  s_cselect_b32 s69, 0, s69
  s_barrier
  s_lshr_b32 s10, s73, 2
  s_add_u32 s10, s10, 6
  s_and_b32 s10, s10, 7
  s_lshr_b32 s11, s74, 1
  s_lshl_b32 s11, s11, 3
  s_add_u32 s10, s10, s11
  s_lshl_b32 s10, s10, 7
  s_add_u32 s10, s10, 0x11f2000
  v_mov_b32 v40, s10
  buffer_load_dword v42, v40, s[48:51], 0 offen sc1
  s_lshl_b32 s63, s69, 11
  s_mov_b32 m0, 104448
  s_nop 0
  buffer_load_dwordx4 v8, s[48:51], s63 offen offset:0 sc1 lds
  buffer_load_dwordx4 v9, s[48:51], s63 offen offset:1024 sc1 lds
  buffer_load_dwordx4 v10, s[48:51], s63 offen offset:2048 sc1 lds
  buffer_load_dwordx4 v11, s[48:51], s63 offen offset:3072 sc1 lds
  s_mov_b32 m0, 108544
  s_nop 0
  buffer_load_dwordx4 v12, s[48:51], s63 offen offset:0 sc1 lds
  buffer_load_dwordx4 v13, s[48:51], s63 offen offset:1024 sc1 lds
  s_add_u32 s69, s69, 1
  s_cmp_ge_u32 s69, 24
  s_cselect_b32 s69, 0, s69
  s_barrier
  s_lshl_b32 s63, s69, 11
  s_mov_b32 m0, 122880
  s_nop 0
  buffer_load_dwordx4 v8, s[48:51], s63 offen offset:0 sc1 lds
  buffer_load_dwordx4 v9, s[48:51], s63 offen offset:1024 sc1 lds
  buffer_load_dwordx4 v10, s[48:51], s63 offen offset:2048 sc1 lds
  buffer_load_dwordx4 v11, s[48:51], s63 offen offset:3072 sc1 lds
  s_mov_b32 m0, 126976
  s_nop 0
  buffer_load_dwordx4 v12, s[48:51], s63 offen offset:0 sc1 lds
  buffer_load_dwordx4 v13, s[48:51], s63 offen offset:1024 sc1 lds
  s_add_u32 s69, s69, 1
  s_cmp_ge_u32 s69, 24
  s_cselect_b32 s69, 0, s69
  s_waitcnt vmcnt(25)
  s_barrier
  s_waitcnt vmcnt(12)
  v_readfirstlane_b32 s72, v42
  s_cmp_ge_u32 s72, 4
  s_cbranch_scc1 fp2_h6_done
fp2_h6:
  buffer_load_dword v21, v40, s[48:51], 0 offen sc1
  s_waitcnt vmcnt(0)
  v_readfirstlane_b32 s72, v21
  s_cmp_ge_u32 s72, 4
  s_cbranch_scc1 fp2_h6_done
  s_sleep 8
  s_branch fp2_h6
fp2_h6_done:
  s_lshl_b32 s63, s69, 11
  s_mov_b32 m0, 12288
  s_nop 0
  buffer_load_dwordx4 v8, s[48:51], s63 offen offset:0 sc1 lds
  buffer_load_dwordx4 v9, s[48:51], s63 offen offset:1024 sc1 lds
  buffer_load_dwordx4 v10, s[48:51], s63 offen offset:2048 sc1 lds
  buffer_load_dwordx4 v11, s[48:51], s63 offen offset:3072 sc1 lds
  s_mov_b32 m0, 16384
  s_nop 0
  buffer_load_dwordx4 v12, s[48:51], s63 offen offset:0 sc1 lds
  buffer_load_dwordx4 v13, s[48:51], s63 offen offset:1024 sc1 lds
  s_add_u32 s69, s69, 1
  s_cmp_ge_u32 s69, 24
  s_cselect_b32 s69, 0, s69
  s_barrier
  s_lshr_b32 s10, s73, 2
  s_add_u32 s10, s10, 7
  s_and_b32 s10, s10, 7
  s_lshr_b32 s11, s74, 1
  s_lshl_b32 s11, s11, 3
  s_add_u32 s10, s10, s11
  s_lshl_b32 s10, s10, 7
  s_add_u32 s10, s10, 0x11f2000
  v_mov_b32 v40, s10
  buffer_load_dword v42, v40, s[48:51], 0 offen sc1
  s_lshl_b32 s63, s69, 11
  s_mov_b32 m0, 30720
  s_nop 0
  buffer_load_dwordx4 v8, s[48:51], s63 offen offset:0 sc1 lds
  buffer_load_dwordx4 v9, s[48:51], s63 offen offset:1024 sc1 lds
  buffer_load_dwordx4 v10, s[48:51], s63 offen offset:2048 sc1 lds
  buffer_load_dwordx4 v11, s[48:51], s63 offen offset:3072 sc1 lds
  s_mov_b32 m0, 34816
  s_nop 0
  buffer_load_dwordx4 v12, s[48:51], s63 offen offset:0 sc1 lds
  buffer_load_dwordx4 v13, s[48:51], s63 offen offset:1024 sc1 lds
  s_add_u32 s69, s69, 1
  s_cmp_ge_u32 s69, 24
  s_cselect_b32 s69, 0, s69
  s_barrier
  s_lshl_b32 s63, s69, 11
  s_mov_b32 m0, 49152
  s_nop 0
  buffer_load_dwordx4 v8, s[48:51], s63 offen offset:0 sc1 lds
  buffer_load_dwordx4 v9, s[48:51], s63 offen offset:1024 sc1 lds
  buffer_load_dwordx4 v10, s[48:51], s63 offen offset:2048 sc1 lds
  buffer_load_dwordx4 v11, s[48:51], s63 offen offset:3072 sc1 lds
  s_mov_b32 m0, 53248
  s_nop 0
  buffer_load_dwordx4 v12, s[48:51], s63 offen offset:0 sc1 lds
  buffer_load_dwordx4 v13, s[48:51], s63 offen offset:1024 sc1 lds
  s_add_u32 s69, s69, 1
  s_cmp_ge_u32 s69, 24
  s_cselect_b32 s69, 0, s69
  s_waitcnt vmcnt(25)
  s_barrier
  s_waitcnt vmcnt(12)
  v_readfirstlane_b32 s72, v42
  s_cmp_ge_u32 s72, 4
  s_cbranch_scc1 fp2_h7_done
fp2_h7:
  buffer_load_dword v21, v40, s[48:51], 0 offen sc1
  s_waitcnt vmcnt(0)
  v_readfirstlane_b32 s72, v21
  s_cmp_ge_u32 s72, 4
  s_cbranch_scc1 fp2_h7_done
  s_sleep 8
  s_branch fp2_h7
fp2_h7_done:
  s_lshl_b32 s63, s69, 11
  s_mov_b32 m0, 67584
  s_nop 0
  buffer_load_dwordx4 v8, s[48:51], s63 offen offset:0 sc1 lds
  buffer_load_dwordx4 v9, s[48:51], s63 offen offset:1024 sc1 lds
  buffer_load_dwordx4 v10, s[48:51], s63 offen offset:2048 sc1 lds
  buffer_load_dwordx4 v11, s[48:51], s63 offen offset:3072 sc1 lds
  s_mov_b32 m0, 71680
  s_nop 0
  buffer_load_dwordx4 v12, s[48:51], s63 offen offset:0 sc1 lds
  buffer_load_dwordx4 v13, s[48:51], s63 offen offset:1024 sc1 lds
  s_add_u32 s69, s69, 1
  s_cmp_ge_u32 s69, 24
  s_cselect_b32 s69, 0, s69
  s_barrier
  s_lshl_b32 s10, s74, 7
  s_add_u32 s10, s10, 0x11f1000
  v_mov_b32 v40, s10
  buffer_load_dword v42, v40, s[48:51], 0 offen sc1
  s_lshl_b32 s63, s69, 11
  s_mov_b32 m0, 86016
  s_nop 0
  buffer_load_dwordx4 v8, s[48:51], s63 offen offset:0 sc1 lds
  buffer_load_dwordx4 v9, s[48:51], s63 offen offset:1024 sc1 lds
  buffer_load_dwordx4 v10, s[48:51], s63 offen offset:2048 sc1 lds
  buffer_load_dwordx4 v11, s[48:51], s63 offen offset:3072 sc1 lds
  s_mov_b32 m0, 90112
  s_nop 0
  buffer_load_dwordx4 v12, s[48:51], s63 offen offset:0 sc1 lds
  buffer_load_dwordx4 v13, s[48:51], s63 offen offset:1024 sc1 lds
  s_add_u32 s69, s69, 1
  s_cmp_ge_u32 s69, 24
  s_cselect_b32 s69, 0, s69
  s_barrier
  s_lshl_b32 s63, s69, 11
  s_mov_b32 m0, 104448
  s_nop 0
  buffer_load_dwordx4 v8, s[48:51], s63 offen offset:0 sc1 lds
  buffer_load_dwordx4 v9, s[48:51], s63 offen offset:1024 sc1 lds
  buffer_load_dwordx4 v10, s[48:51], s63 offen offset:2048 sc1 lds
  buffer_load_dwordx4 v11, s[48:51], s63 offen offset:3072 sc1 lds
  s_mov_b32 m0, 108544
  s_nop 0
  buffer_load_dwordx4 v12, s[48:51], s63 offen offset:0 sc1 lds
  buffer_load_dwordx4 v13, s[48:51], s63 offen offset:1024 sc1 lds
  s_add_u32 s69, s69, 1
  s_cmp_ge_u32 s69, 24
  s_cselect_b32 s69, 0, s69
  s_waitcnt vmcnt(25)
  s_barrier
  s_waitcnt vmcnt(12)
  v_readfirstlane_b32 s72, v42
  s_cmp_ge_u32 s72, 32
  s_cbranch_scc1 fp2_o_done
fp2_o:
  buffer_load_dword v21, v40, s[48:51], 0 offen sc1
  s_waitcnt vmcnt(0)
  v_readfirstlane_b32 s72, v21
  s_cmp_ge_u32 s72, 32
  s_cbranch_scc1 fp2_o_done
  s_sleep 8
  s_branch fp2_o
fp2_o_done:
  s_mul_i32 s69, s73, 10
  s_lshr_b32 s69, s69, 5
  s_mul_i32 s60, s75, 348160
  s_add_u32 s60, s60, 0xf00000
  s_lshl_b32 s61, s74, 2
  s_mul_i32 s61, s61, 69760
  s_add_u32 s61, s61, 0x1000
  s_add_u32 s10, s61, 0x22100
  v_add_u32 v8, s10, v7
  s_add_u32 s10, s61, 0x32d80
  v_add_u32 v9, s10, v7
  s_add_u32 s10, s61, 0xfffffc00
  v_add_u32 v10, s10, v7
  s_add_u32 s10, s61, 0x10880
  v_add_u32 v11, s10, v7
  s_add_u32 s10, s61, 0x22500
  v_add_u32 v12, s10, v7
  s_add_u32 s10, s61, 0x33180
  v_add_u32 v13, s10, v7
  s_lshl_b32 s63, s69, 11
  s_mov_b32 m0, 122880
  s_nop 0
  buffer_load_dwordx4 v8, s[48:51], s63 offen offset:0 sc1 lds
  buffer_load_dwordx4 v9, s[48:51], s63 offen offset:1024 sc1 lds
  buffer_load_dwordx4 v10, s[48:51], s63 offen offset:2048 sc1 lds
  buffer_load_dwordx4 v11, s[48:51], s63 offen offset:3072 sc1 lds
  s_mov_b32 m0, 126976
  s_nop 0
  buffer_load_dwordx4 v12, s[48:51], s63 offen offset:0 sc1 lds
  buffer_load_dwordx4 v13, s[48:51], s63 offen offset:1024 sc1 lds
  s_add_u32 s69, s69, 1
  s_cmp_ge_u32 s69, 10
  s_cselect_b32 s69, 0, s69
  s_barrier
  s_lshl_b32 s63, s69, 11
  s_mov_b32 m0, 12288
  s_nop 0
  buffer_load_dwordx4 v8, s[48:51], s63 offen offset:0 sc1 lds
  buffer_load_dwordx4 v9, s[48:51], s63 offen offset:1024 sc1 lds
  buffer_load_dwordx4 v10, s[48:51], s63 offen offset:2048 sc1 lds
  buffer_load_dwordx4 v11, s[48:51], s63 offen offset:3072 sc1 lds
  s_mov_b32 m0, 16384
  s_nop 0
  buffer_load_dwordx4 v12, s[48:51], s63 offen offset:0 sc1 lds
  buffer_load_dwordx4 v13, s[48:51], s63 offen offset:1024 sc1 lds
  s_add_u32 s69, s69, 1
  s_cmp_ge_u32 s69, 10
  s_cselect_b32 s69, 0, s69
  s_barrier
  s_lshl_b32 s63, s69, 11
  s_mov_b32 m0, 30720
  s_nop 0
  buffer_load_dwordx4 v8, s[48:51], s63 offen offset:0 sc1 lds
  buffer_load_dwordx4 v9, s[48:51], s63 offen offset:1024 sc1 lds
  buffer_load_dwordx4 v10, s[48:51], s63 offen offset:2048 sc1 lds
  buffer_load_dwordx4 v11, s[48:51], s63 offen offset:3072 sc1 lds
  s_mov_b32 m0, 34816
  s_nop 0
  buffer_load_dwordx4 v12, s[48:51], s63 offen offset:0 sc1 lds
  buffer_load_dwordx4 v13, s[48:51], s63 offen offset:1024 sc1 lds
  s_add_u32 s69, s69, 1
  s_cmp_ge_u32 s69, 10
  s_cselect_b32 s69, 0, s69
  s_waitcnt vmcnt(24)
  s_barrier
  s_lshl_b32 s63, s69, 11
  s_mov_b32 m0, 49152
  s_nop 0
  buffer_load_dwordx4 v8, s[48:51], s63 offen offset:0 sc1 lds
  buffer_load_dwordx4 v9, s[48:51], s63 offen offset:1024 sc1 lds
  buffer_load_dwordx4 v10, s[48:51], s63 offen offset:2048 sc1 lds
  buffer_load_dwordx4 v11, s[48:51], s63 offen offset:3072 sc1 lds
  s_mov_b32 m0, 53248
  s_nop 0
  buffer_load_dwordx4 v12, s[48:51], s63 offen offset:0 sc1 lds
  buffer_load_dwordx4 v13, s[48:51], s63 offen offset:1024 sc1 lds
  s_add_u32 s69, s69, 1
  s_cmp_ge_u32 s69, 10
  s_cselect_b32 s69, 0, s69
  s_waitcnt vmcnt(24)
  s_barrier
  s_lshl_b32 s63, s69, 11
  s_mov_b32 m0, 67584
  s_nop 0
  buffer_load_dwordx4 v8, s[48:51], s63 offen offset:0 sc1 lds
  buffer_load_dwordx4 v9, s[48:51], s63 offen offset:1024 sc1 lds
  buffer_load_dwordx4 v10, s[48:51], s63 offen offset:2048 sc1 lds
  buffer_load_dwordx4 v11, s[48:51], s63 offen offset:3072 sc1 lds
  s_mov_b32 m0, 71680
  s_nop 0
  buffer_load_dwordx4 v12, s[48:51], s63 offen offset:0 sc1 lds
  buffer_load_dwordx4 v13, s[48:51], s63 offen offset:1024 sc1 lds
  s_add_u32 s69, s69, 1
  s_cmp_ge_u32 s69, 10
  s_cselect_b32 s69, 0, s69
  s_waitcnt vmcnt(24)
  s_barrier
  s_lshl_b32 s63, s69, 11
  s_mov_b32 m0, 86016
  s_nop 0
  buffer_load_dwordx4 v8, s[48:51], s63 offen offset:0 sc1 lds
  buffer_load_dwordx4 v9, s[48:51], s63 offen offset:1024 sc1 lds
  buffer_load_dwordx4 v10, s[48:51], s63 offen offset:2048 sc1 lds
  buffer_load_dwordx4 v11, s[48:51], s63 offen offset:3072 sc1 lds
  s_mov_b32 m0, 90112
  s_nop 0
  buffer_load_dwordx4 v12, s[48:51], s63 offen offset:0 sc1 lds
  buffer_load_dwordx4 v13, s[48:51], s63 offen offset:1024 sc1 lds
  s_add_u32 s69, s69, 1
  s_cmp_ge_u32 s69, 10
  s_cselect_b32 s69, 0, s69
  s_waitcnt vmcnt(24)
  s_barrier
  s_lshl_b32 s63, s69, 11
  s_mov_b32 m0, 104448
  s_nop 0
  buffer_load_dwordx4 v8, s[48:51], s63 offen offset:0 sc1 lds
  buffer_load_dwordx4 v9, s[48:51], s63 offen offset:1024 sc1 lds
  buffer_load_dwordx4 v10, s[48:51], s63 offen offset:2048 sc1 lds
  buffer_load_dwordx4 v11, s[48:51], s63 offen offset:3072 sc1 lds
  s_mov_b32 m0, 108544
  s_nop 0
  buffer_load_dwordx4 v12, s[48:51], s63 offen offset:0 sc1 lds
  buffer_load_dwordx4 v13, s[48:51], s63 offen offset:1024 sc1 lds
  s_add_u32 s69, s69, 1
  s_cmp_ge_u32 s69, 10
  s_cselect_b32 s69, 0, s69
  s_waitcnt vmcnt(24)
  s_barrier
  s_lshl_b32 s63, s69, 11
  s_mov_b32 m0, 122880
  s_nop 0
  buffer_load_dwordx4 v8, s[48:51], s63 offen offset:0 sc1 lds
  buffer_load_dwordx4 v9, s[48:51], s63 offen offset:1024 sc1 lds
  buffer_load_dwordx4 v10, s[48:51], s63 offen offset:2048 sc1 lds
  buffer_load_dwordx4 v11, s[48:51], s63 offen offset:3072 sc1 lds
  s_mov_b32 m0, 126976
  s_nop 0
  buffer_load_dwordx4 v12, s[48:51], s63 offen offset:0 sc1 lds
  buffer_load_dwordx4 v13, s[48:51], s63 offen offset:1024 sc1 lds
  s_add_u32 s69, s69, 1
  s_cmp_ge_u32 s69, 10
  s_cselect_b32 s69, 0, s69
  s_waitcnt vmcnt(24)
  s_barrier
  s_lshl_b32 s63, s69, 11
  s_mov_b32 m0, 12288
  s_nop 0
  buffer_load_dwordx4 v8, s[48:51], s63 offen offset:0 sc1 lds
  buffer_load_dwordx4 v9, s[48:51], s63 offen offset:1024 sc1 lds
  buffer_load_dwordx4 v10, s[48:51], s63 offen offset:2048 sc1 lds
  buffer_load_dwordx4 v11, s[48:51], s63 offen offset:3072 sc1 lds
  s_mov_b32 m0, 16384
  s_nop 0
  buffer_load_dwordx4 v12, s[48:51], s63 offen offset:0 sc1 lds
  buffer_load_dwordx4 v13, s[48:51], s63 offen offset:1024 sc1 lds
  s_add_u32 s69, s69, 1
  s_cmp_ge_u32 s69, 10
  s_cselect_b32 s69, 0, s69
  s_waitcnt vmcnt(24)
  s_barrier
  s_lshl_b32 s63, s69, 11
  s_mov_b32 m0, 30720
  s_nop 0
  buffer_load_dwordx4 v8, s[48:51], s63 offen offset:0 sc1 lds
  buffer_load_dwordx4 v9, s[48:51], s63 offen offset:1024 sc1 lds
  buffer_load_dwordx4 v10, s[48:51], s63 offen offset:2048 sc1 lds
  buffer_load_dwordx4 v11, s[48:51], s63 offen offset:3072 sc1 lds
  s_mov_b32 m0, 34816
  s_nop 0
  buffer_load_dwordx4 v12, s[48:51], s63 offen offset:0 sc1 lds
  buffer_load_dwordx4 v13, s[48:51], s63 offen offset:1024 sc1 lds
  s_add_u32 s69, s69, 1
  s_cmp_ge_u32 s69, 10
  s_cselect_b32 s69, 0, s69
  s_waitcnt vmcnt(24)
  s_barrier
  s_waitcnt vmcnt(18)
  s_barrier
  s_waitcnt vmcnt(12)
  s_barrier
  s_waitcnt vmcnt(6)
  s_barrier
  s_waitcnt vmcnt(0)
  s_barrier
  s_endpgm
fp_helper:
  s_cmp_ge_u32 s6, 2
  s_cbranch_scc1 fh_noe
  s_barrier
  s_barrier
fh_noe:
  v_mov_b32 v20, 0
  v_mov_b32 v21, 0
  v_mov_b32 v22, 0
  v_mov_b32 v23, 0
  v_add_u32 v24, 129024, v7
  ds_write_b128 v24, v[20:23] offset:0
  ds_write_b128 v24, v[20:23] offset:1024
  ds_write_b128 v24, v[20:23] offset:2048
  ds_write_b128 v24, v[20:23] offset:3072
  ds_write_b128 v24, v[20:23] offset:4096
  ds_write_b128 v24, v[20:23] offset:5120
  ds_write_b128 v24, v[20:23] offset:6144
  ds_write_b128 v24, v[20:23] offset:7168
  ds_write_b128 v24, v[20:23] offset:8192
  ds_write_b128 v24, v[20:23] offset:9216
  ds_write_b128 v24, v[20:23] offset:10240
  ds_write_b128 v24, v[20:23] offset:11264
  ds_write_b128 v24, v[20:23] offset:12288
  ds_write_b128 v24, v[20:23] offset:13312
  ds_write_b128 v24, v[20:23] offset:14336
  ds_write_b128 v24, v[20:23] offset:15360
  ds_write_b128 v24, v[20:23] offset:16384
  ds_write_b128 v24, v[20:23] offset:17408
  ds_write_b128 v24, v[20:23] offset:18432
  ds_write_b128 v24, v[20:23] offset:19456
  ds_write_b128 v24, v[20:23] offset:20480
  ds_write_b128 v24, v[20:23] offset:21504
  ds_write_b128 v24, v[20:23] offset:22528
  ds_write_b128 v24, v[20:23] offset:23552
  ds_write_b128 v24, v[20:23] offset:24576
  ds_write_b128 v24, v[20:23] offset:25600
  ds_write_b128 v24, v[20:23] offset:26624
  ds_write_b128 v24, v[20:23] offset:27648
  ds_write_b128 v24, v[20:23] offset:28672
  ds_write_b128 v24, v[20:23] offset:29696
  s_lshl_b32 s10, s75, 7
  s_add_u32 s10, s10, 0x11f0400
  v_mov_b32 v26, s10
  s_lshl_b32 s12, s75, 13
  s_add_u32 s12, s12, 0x900000
  v_add_u32 v25, s12, v7
  s_mov_b32 s64, s32
  s_and_b32 s65, s33, 0xffff
  s_mov_b32 s66, 0x500
  s_mov_b32 s67, 0x00020000
  s_mov_b32 m0, 159744
  s_nop 0
  buffer_load_dwordx4 v7, s[64:67], 0 offen lds
  buffer_load_dwordx4 v7, s[64:67], 0 offen offset:1024 lds
  s_mov_b32 s60, 0
  s_mov_b32 s61, 0
  v_mov_b32 v30, v0
  s_waitcnt vmcnt(0) lgkmcnt(0)
  s_barrier
  s_barrier
  s_barrier
  s_barrier
  s_barrier
  s_barrier
  s_barrier
  s_barrier
  s_mov_b32 s60, 8
fh_wait:
  buffer_load_dword v21, v26, s[48:51], 0 offen sc1
  s_cmp_ge_u32 s60, 20
  s_cbranch_scc1 fh_nobar0
  s_barrier
  s_add_u32 s60, s60, 1
fh_nobar0:
  s_cmp_ge_u32 s60, 20
  s_cbranch_scc1 fh_nobar1
  s_barrier
  s_add_u32 s60, s60, 1
fh_nobar1:
  s_waitcnt vmcnt(0)
  v_readfirstlane_b32 s72, v21
  s_cmp_ge_u32 s72, 64
  s_cbranch_scc0 fh_wait
  buffer_load_dwordx4 v[64:67], v25, s[48:51], 0 offen offset:0 sc1
  buffer_load_dwordx4 v[68:71], v25, s[48:51], 0 offen offset:1024 sc1
  buffer_load_dwordx4 v[72:75], v25, s[48:51], 0 offen offset:2048 sc1
  buffer_load_dwordx4 v[76:79], v25, s[48:51], 0 offen offset:3072 sc1
  v_add_u32 v25, 4096, v25
  buffer_load_dwordx4 v[80:83], v25, s[48:51], 0 offen sc1
  v_add_u32 v25, 1024, v25
  buffer_load_dwordx4 v[84:87], v25, s[48:51], 0 offen sc1
  v_add_u32 v25, 1024, v25
  buffer_load_dwordx4 v[88:91], v25, s[48:51], 0 offen sc1
  v_add_u32 v25, 1024, v25
  s_cmp_ge_u32 s60, 20
  s_cbranch_scc1 fh_loop
  s_barrier
  s_add_u32 s60, s60, 1
fh_loop:
  s_cmp_ge_u32 s60, 20
  s_cbranch_scc1 fh_round
  s_barrier
  s_add_u32 s60, s60, 1
fh_round:
  v_mul_u32_u24 v35, 625, v30
  v_lshrrev_b32 v35, 16, v35
  v_mul_u32_u24 v36, 105, v35
  v_sub_u32 v36, v30, v36
  v_mul_u32_u24 v37, 13108, v36
  v_lshrrev_b32 v37, 16, v37
  v_mul_u32_u24 v38, 5, v37
  v_sub_u32 v38, v36, v38
  v_lshlrev_b32 v38, 2, v38
  v_mul_u32_u24 v35, 20, v35
  v_add_u32 v39, v35, v38
  v_mul_u32_u24 v39, 192, v39
  v_add_u32 v40, v35, v37
  v_lshl_add_u32 v39, v40, 1, v39
  v_add_u32 v39, 129024, v39
  v_mul_u32_u24 v43, 192, v35
  v_add_u32 v40, v35, v38
  v_lshl_add_u32 v43, v40, 1, v43
  v_add_u32 v43, 144384, v43
  v_cmp_gt_u32 vcc, 420, v30
  s_mov_b64 s[56:57], vcc
  v_cmp_gt_u32 s[52:53], 20, v37
  v_cmp_eq_u32 s[54:55], 20, v37
  s_and_b64 s[52:53], s[52:53], s[56:57]
  s_and_b64 s[54:55], s[54:55], s[56:57]
  s_waitcnt vmcnt(0)
  v_cvt_pk_bf16_f32 v32, v64, v65
  v_cvt_pk_bf16_f32 v33, v66, v67
  v_mov_b32 v64, v68
  v_mov_b32 v65, v69
  v_mov_b32 v66, v70
  v_mov_b32 v67, v71
  v_mov_b32 v68, v72
  v_mov_b32 v69, v73
  v_mov_b32 v70, v74
  v_mov_b32 v71, v75
  v_mov_b32 v72, v76
  v_mov_b32 v73, v77
  v_mov_b32 v74, v78
  v_mov_b32 v75, v79
  v_mov_b32 v76, v80
  v_mov_b32 v77, v81
  v_mov_b32 v78, v82
  v_mov_b32 v79, v83
  v_mov_b32 v80, v84
  v_mov_b32 v81, v85
  v_mov_b32 v82, v86
  v_mov_b32 v83, v87
  v_mov_b32 v84, v88
  v_mov_b32 v85, v89
  v_mov_b32 v86, v90
  v_mov_b32 v87, v91
  v_lshrrev_b32 v41, 16, v32
  v_lshrrev_b32 v42, 16, v33
  s_mov_b64 s[66:67], exec
  s_mov_b64 exec, s[52:53]
  ds_write_b16 v39, v32
  ds_write_b16 v39, v41 offset:192
  ds_write_b16 v39, v33 offset:384
  ds_write_b16 v39, v42 offset:576
  s_mov_b64 exec, s[54:55]
  s_cbranch_execz fh_noz
  ds_write_b64 v43, v[32:33] offset:0
  ds_write_b64 v43, v[32:33] offset:192
  ds_write_b64 v43, v[32:33] offset:384
  ds_write_b64 v43, v[32:33] offset:576
  ds_write_b64 v43, v[32:33] offset:768
  ds_write_b64 v43, v[32:33] offset:960
  ds_write_b64 v43, v[32:33] offset:1152
  ds_write_b64 v43, v[32:33] offset:1344
  ds_write_b64 v43, v[32:33] offset:1536
  ds_write_b64 v43, v[32:33] offset:1728
  ds_write_b64 v43, v[32:33] offset:1920
  ds_write_b64 v43, v[32:33] offset:2112
  ds_write_b64 v43, v[32:33] offset:2304
  ds_write_b64 v43, v[32:33] offset:2496
  ds_write_b64 v43, v[32:33] offset:2688
  ds_write_b64 v43, v[32:33] offset:2880
  ds_write_b64 v43, v[32:33] offset:3072
  ds_write_b64 v43, v[32:33] offset:3264
  ds_write_b64 v43, v[32:33] offset:3456
  ds_write_b64 v43, v[32:33] offset:3648
fh_noz:
  s_mov_b64 exec, s[66:67]
  v_add_u32 v30, 64, v30
  s_add_u32 s61, s61, 1
  s_cmp_lt_u32 s61, 7
  s_cbranch_scc1 fh_loop
  s_waitcnt lgkmcnt(0)
fh_rest:
  s_cmp_ge_u32 s60, 20
  s_cbranch_scc1 fh_bi
  s_barrier
  s_add_u32 s60, s60, 1
  s_branch fh_rest
fh_bi:
  s_barrier
  s_endpgm
f_cons:
  s_getpc_b64 s[54:55]
fc_pc0:
  s_sub_u32 s54, s54, fc_pc0-fused_kernel
  s_subb_u32 s55, s55, 0
  s_lshl_b32 s56, s4, 2
  s_add_u32 s56, s56, s9
  s_and_b32 s56, s56, 15
  s_lshl_b32 s56, s56, 13
  v_lshlrev_b32 v32, 7, v0
  v_add_u32 v32, s56, v32
  v_min_u32 v32, f_code_end-fused_kernel-4, v32
  v_and_b32 v32, 0xfffffffc, v32
  global_load_dword v11, v32, s[54:55]
  s_waitcnt lgkmcnt(0)
  s_mov_b32 s40, s16
  s_and_b32 s41, s17, 0xffff
  s_mov_b32 s42, 0x280000
  s_mov_b32 s43, 0x00020000
  s_mov_b32 s48, s38
  s_and_b32 s49, s39, 0xffff
  s_mov_b32 s50, 0x1200000
  s_mov_b32 s51, 0x00020000
  s_min_u32 s53, s9, 2
  s_mul_i32 s54, s74, 3
  s_add_u32 s54, s54, s53
  s_min_u32 s54, s54, 87
  s_mov_b32 s59, 0xf00000
  s_cmp_lt_u32 s54, 20
  s_cselect_b32 s59, 0xe00000, s59
  s_cselect_b32 s60, 20, 68
  s_cselect_b32 s61, 0, 20
  s_sub_u32 s54, s54, s61
  s_mul_i32 s60, s60, s75
  s_add_u32 s54, s54, s60
  s_mul_i32 s54, s54, 5120
  s_add_u32 s54, s54, s59
  v_add_u32 v10, s54, v7
  v_lshrrev_b32 v12, 2, v0
  v_mul_u32_u24 v12, 192, v12
  v_and_b32 v13, 3, v0
  v_lshl_add_u32 v12, v13, 3, v12
  s_and_b32 s60, s75, 1
  s_lshl_b32 s61, s60, 5
  s_mul_i32 s59, s53, 6144
  s_add_u32 s61, s61, s59
  s_add_u32 s61, s61, 139264
  v_add_u32 v12, s61, v12
  v_and_b32 v13, 1, v3
  v_lshlrev_b32 v13, 5, v13
  s_cmp_eq_u32 s60, 0
  s_cselect_b32 s61, 1, -1
  v_mul_lo_u32 v13, v13, s61
  v_add_u32 v8, v12, v13
  v_sub_u32 v9, v12, v13
  v_lshrrev_b32 v14, 1, v2
  v_xor_b32 v14, v14, v3
  v_lshlrev_b32 v15, 7, v2
  v_lshl_add_u32 v17, v14, 4, v15
  s_cmp_ge_u32 s6, 2
  s_cbranch_scc1 fc_h
  s_add_u32 s10, s2, s9
  s_cmp_lg_u32 s10, 0
  s_cbranch_scc1 fp_noflag
  s_mov_b32 s64, s36
  s_and_b32 s65, s37, 0xffff
  s_mov_b32 s66, 0x100
  s_mov_b32 s67, 0x00020000
  v_lshlrev_b32 v24, 7, v0
  v_add_u32 v24, 0x11f0000, v24
  v_mov_b32 v25, 0
  buffer_store_dword v25, v24, s[48:51], 0 offen sc1
  v_add_u32 v24, 8192, v24
  buffer_store_dword v25, v24, s[48:51], 0 offen sc1
  v_add_u32 v24, 8192, v24
  buffer_store_dword v25, v24, s[48:51], 0 offen sc1
  v_add_u32 v24, 8192, v24
  s_waitcnt vmcnt(0)
  s_mov_b32 s10, 32
  v_mov_b32 v24, s10
  v_mov_b32 v25, 1
  s_mov_b64 exec, 1
  buffer_atomic_add v25, v24, s[64:67], 0 offen sc1
  s_mov_b64 exec, -1
fp_noflag:
  s_cmp_lg_u32 s5, 0
  s_cbranch_scc1 fp_nozero
  s_mov_b32 s64, s36
  s_and_b32 s65, s37, 0xffff
  s_mov_b32 s66, 0x100
  s_mov_b32 s67, 0x00020000
  s_lshl_b32 s10, s7, 13
  s_lshl_b32 s11, s9, 11
  s_add_u32 s10, s10, s11
  s_add_u32 s10, s10, 0x900000
  v_lshl_add_u32 v24, v0, 4, s10
  v_mov_b32 v28, 0
  v_mov_b32 v29, 0
  v_mov_b32 v30, 0
  v_mov_b32 v31, 0
  buffer_store_dwordx4 v[28:31], v24, s[48:51], 0 offen sc1
  buffer_store_dwordx4 v[28:31], v24, s[48:51], 0 offen offset:1024 sc1
  s_waitcnt vmcnt(0)
  s_lshl_b32 s10, s7, 2
  v_mov_b32 v24, s10
  v_mov_b32 v25, 1
  s_mov_b64 exec, 1
  buffer_atomic_add v25, v24, s[64:67], 0 offen sc1
  s_mov_b64 exec, -1
fp_nozero:
  v_lshrrev_b32 v19, 2, v0
  v_mul_u32_u24 v19, 192, v19
  v_and_b32 v20, 3, v0
  v_lshl_add_u32 v19, v20, 3, v19
  s_lshl_b32 s11, s8, 5
  s_add_u32 s11, s11, 65536
  v_add_u32 v19, s11, v19
  v_and_b32 v20, 1, v3
  v_lshlrev_b32 v20, 5, v20
  s_cmp_eq_u32 s8, 0
  s_cselect_b32 s11, 1, -1
  v_mul_lo_u32 v20, v20, s11
  v_add_u32 v24, v19, v20
  v_sub_u32 v25, v19, v20
  v_add_u32 v18, 49152, v24
  v_add_u32 v19, 49152, v25
  s_lshl_b32 s14, s9, 12
  v_add_u32 v26, s14, v17
  v_xor_b32 v27, 64, v26
  s_lshl_b32 s12, s9, 6
  v_add_u32 v16, s12, v0
  s_lshl_b32 s12, s7, 13
  s_add_u32 s12, s12, 0x900000
  v_add_u32 v32, 0, v16
  v_mul_u32_u24 v33, 1249, v32
  v_lshrrev_b32 v33, 19, v33
  v_mul_u32_u24 v34, 420, v33
  v_sub_u32 v34, v32, v34
  v_mul_u32_u24 v35, 3277, v34
  v_lshrrev_b32 v35, 16, v35
  v_mul_u32_u24 v36, 20, v35
  v_sub_u32 v36, v34, v36
  v_mul_u32_u24 v33, 20, v33
  v_cmp_eq_u32 vcc, 20, v35
  v_add_u32 v38, v33, v36
  v_add_u32 v37, v33, v35
  v_cndmask_b32 v37, v37, v38, vcc
  v_lshrrev_b32 v39, 4, v37
  v_lshrrev_b32 v240, 4, v38
  v_lshl_add_u32 v240, v39, 1, v240
  v_add_u32 v39, 13, v39
  v_cndmask_b32 v39, v240, v39, vcc
  v_and_b32 v38, 15, v38
  v_cndmask_b32 v38, v38, 0, vcc
  v_bfe_u32 v240, v37, 2, 2
  v_lshl_add_u32 v240, v240, 4, v38
  v_lshlrev_b32 v240, 4, v240
  v_lshl_add_u32 v240, v39, 10, v240
  v_and_b32 v37, 3, v37
  v_lshl_add_u32 v240, v37, 2, v240
  v_add_u32 v240, 90112, v240
  v_lshl_add_u32 v247, v32, 2, s12
  v_add_u32 v32, 256, v16
  v_mul_u32_u24 v33, 1249, v32
  v_lshrrev_b32 v33, 19, v33
  v_mul_u32_u24 v34, 420, v33
  v_sub_u32 v34, v32, v34
  v_mul_u32_u24 v35, 3277, v34
  v_lshrrev_b32 v35, 16, v35
  v_mul_u32_u24 v36, 20, v35
  v_sub_u32 v36, v34, v36
  v_mul_u32_u24 v33, 20, v33
  v_cmp_eq_u32 vcc, 20, v35
  v_add_u32 v38, v33, v36
  v_add_u32 v37, v33, v35
  v_cndmask_b32 v37, v37, v38, vcc
  v_lshrrev_b32 v39, 4, v37
  v_lshrrev_b32 v241, 4, v38
  v_lshl_add_u32 v241, v39, 1, v241
  v_add_u32 v39, 13, v39
  v_cndmask_b32 v39, v241, v39, vcc
  v_and_b32 v38, 15, v38
  v_cndmask_b32 v38, v38, 0, vcc
  v_bfe_u32 v241, v37, 2, 2
  v_lshl_add_u32 v241, v241, 4, v38
  v_lshlrev_b32 v241, 4, v241
  v_lshl_add_u32 v241, v39, 10, v241
  v_and_b32 v37, 3, v37
  v_lshl_add_u32 v241, v37, 2, v241
  v_add_u32 v241, 90112, v241
  v_lshl_add_u32 v248, v32, 2, s12
  v_add_u32 v32, 512, v16
  v_mul_u32_u24 v33, 1249, v32
  v_lshrrev_b32 v33, 19, v33
  v_mul_u32_u24 v34, 420, v33
  v_sub_u32 v34, v32, v34
  v_mul_u32_u24 v35, 3277, v34
  v_lshrrev_b32 v35, 16, v35
  v_mul_u32_u24 v36, 20, v35
  v_sub_u32 v36, v34, v36
  v_mul_u32_u24 v33, 20, v33
  v_cmp_eq_u32 vcc, 20, v35
  v_add_u32 v38, v33, v36
  v_add_u32 v37, v33, v35
  v_cndmask_b32 v37, v37, v38, vcc
  v_lshrrev_b32 v39, 4, v37
  v_lshrrev_b32 v242, 4, v38
  v_lshl_add_u32 v242, v39, 1, v242
  v_add_u32 v39, 13, v39
  v_cndmask_b32 v39, v242, v39, vcc
  v_and_b32 v38, 15, v38
  v_cndmask_b32 v38, v38, 0, vcc
  v_bfe_u32 v242, v37, 2, 2
  v_lshl_add_u32 v242, v242, 4, v38
  v_lshlrev_b32 v242, 4, v242
  v_lshl_add_u32 v242, v39, 10, v242
  v_and_b32 v37, 3, v37
  v_lshl_add_u32 v242, v37, 2, v242
  v_add_u32 v242, 90112, v242
  v_lshl_add_u32 v249, v32, 2, s12
  v_add_u32 v32, 768, v16
  v_mul_u32_u24 v33, 1249, v32
  v_lshrrev_b32 v33, 19, v33
  v_mul_u32_u24 v34, 420, v33
  v_sub_u32 v34, v32, v34
  v_mul_u32_u24 v35, 3277, v34
  v_lshrrev_b32 v35, 16, v35
  v_mul_u32_u24 v36, 20, v35
  v_sub_u32 v36, v34, v36
  v_mul_u32_u24 v33, 20, v33
  v_cmp_eq_u32 vcc, 20, v35
  v_add_u32 v38, v33, v36
  v_add_u32 v37, v33, v35
  v_cndmask_b32 v37, v37, v38, vcc
  v_lshrrev_b32 v39, 4, v37
  v_lshrrev_b32 v243, 4, v38
  v_lshl_add_u32 v243, v39, 1, v243
  v_add_u32 v39, 13, v39
  v_cndmask_b32 v39, v243, v39, vcc
  v_and_b32 v38, 15, v38
  v_cndmask_b32 v38, v38, 0, vcc
  v_bfe_u32 v243, v37, 2, 2
  v_lshl_add_u32 v243, v243, 4, v38
  v_lshlrev_b32 v243, 4, v243
  v_lshl_add_u32 v243, v39, 10, v243
  v_and_b32 v37, 3, v37
  v_lshl_add_u32 v243, v37, 2, v243
  v_add_u32 v243, 90112, v243
  v_lshl_add_u32 v250, v32, 2, s12
  v_add_u32 v32, 1024, v16
  v_mul_u32_u24 v33, 1249, v32
  v_lshrrev_b32 v33, 19, v33
  v_mul_u32_u24 v34, 420, v33
  v_sub_u32 v34, v32, v34
  v_mul_u32_u24 v35, 3277, v34
  v_lshrrev_b32 v35, 16, v35
  v_mul_u32_u24 v36, 20, v35
  v_sub_u32 v36, v34, v36
  v_mul_u32_u24 v33, 20, v33
  v_cmp_eq_u32 vcc, 20, v35
  v_add_u32 v38, v33, v36
  v_add_u32 v37, v33, v35
  v_cndmask_b32 v37, v37, v38, vcc
  v_lshrrev_b32 v39, 4, v37
  v_lshrrev_b32 v244, 4, v38
  v_lshl_add_u32 v244, v39, 1, v244
  v_add_u32 v39, 13, v39
  v_cndmask_b32 v39, v244, v39, vcc
  v_and_b32 v38, 15, v38
  v_cndmask_b32 v38, v38, 0, vcc
  v_bfe_u32 v244, v37, 2, 2
  v_lshl_add_u32 v244, v244, 4, v38
  v_lshlrev_b32 v244, 4, v244
  v_lshl_add_u32 v244, v39, 10, v244
  v_and_b32 v37, 3, v37
  v_lshl_add_u32 v244, v37, 2, v244
  v_add_u32 v244, 90112, v244
  v_lshl_add_u32 v251, v32, 2, s12
  v_add_u32 v32, 1280, v16
  v_mul_u32_u24 v33, 1249, v32
  v_lshrrev_b32 v33, 19, v33
  v_mul_u32_u24 v34, 420, v33
  v_sub_u32 v34, v32, v34
  v_mul_u32_u24 v35, 3277, v34
  v_lshrrev_b32 v35, 16, v35
  v_mul_u32_u24 v36, 20, v35
  v_sub_u32 v36, v34, v36
  v_mul_u32_u24 v33, 20, v33
  v_cmp_eq_u32 vcc, 20, v35
  v_add_u32 v38, v33, v36
  v_add_u32 v37, v33, v35
  v_cndmask_b32 v37, v37, v38, vcc
  v_lshrrev_b32 v39, 4, v37
  v_lshrrev_b32 v245, 4, v38
  v_lshl_add_u32 v245, v39, 1, v245
  v_add_u32 v39, 13, v39
  v_cndmask_b32 v39, v245, v39, vcc
  v_and_b32 v38, 15, v38
  v_cndmask_b32 v38, v38, 0, vcc
  v_bfe_u32 v245, v37, 2, 2
  v_lshl_add_u32 v245, v245, 4, v38
  v_lshlrev_b32 v245, 4, v245
  v_lshl_add_u32 v245, v39, 10, v245
  v_and_b32 v37, 3, v37
  v_lshl_add_u32 v245, v37, 2, v245
  v_add_u32 v245, 90112, v245
  v_lshl_add_u32 v252, v32, 2, s12
  v_add_u32 v32, 1536, v16
  v_mul_u32_u24 v33, 1249, v32
  v_lshrrev_b32 v33, 19, v33
  v_mul_u32_u24 v34, 420, v33
  v_sub_u32 v34, v32, v34
  v_mul_u32_u24 v35, 3277, v34
  v_lshrrev_b32 v35, 16, v35
  v_mul_u32_u24 v36, 20, v35
  v_sub_u32 v36, v34, v36
  v_mul_u32_u24 v33, 20, v33
  v_cmp_eq_u32 vcc, 20, v35
  v_add_u32 v38, v33, v36
  v_add_u32 v37, v33, v35
  v_cndmask_b32 v37, v37, v38, vcc
  v_lshrrev_b32 v39, 4, v37
  v_lshrrev_b32 v246, 4, v38
  v_lshl_add_u32 v246, v39, 1, v246
  v_add_u32 v39, 13, v39
  v_cndmask_b32 v39, v246, v39, vcc
  v_and_b32 v38, 15, v38
  v_cndmask_b32 v38, v38, 0, vcc
  v_bfe_u32 v246, v37, 2, 2
  v_lshl_add_u32 v246, v246, 4, v38
  v_lshlrev_b32 v246, 4, v246
  v_lshl_add_u32 v246, v39, 10, v246
  v_and_b32 v37, 3, v37
  v_lshl_add_u32 v246, v37, 2, v246
  v_cmp_gt_u32 vcc, 1680, v32
  s_nop 1
  v_cndmask_b32 v246, 0, v246, vcc
  s_mov_b64 s[78:79], vcc
  v_add_u32 v246, 90112, v246
  v_lshl_add_u32 v253, v32, 2, s12
  s_mov_b32 s64, s36
  s_and_b32 s65, s37, 0xffff
  s_mov_b32 s66, 0x100
  s_mov_b32 s67, 0x00020000
  v_mov_b32 v254, 32
  s_barrier
  ds_read_b128 v[192:195], v26 offset:0
  ds_read_b64_tr_b16 v[112:113], v24 offset:0
  ds_read_b64_tr_b16 v[114:115], v24 offset:3072
  ds_read_b128 v[196:199], v26 offset:2048
  ds_read_b64_tr_b16 v[116:117], v25 offset:32
  ds_read_b64_tr_b16 v[118:119], v25 offset:3104
  ds_read_b64_tr_b16 v[120:121], v24 offset:64
  ds_read_b64_tr_b16 v[122:123], v24 offset:3136
  ds_read_b64_tr_b16 v[124:125], v25 offset:96
  ds_read_b64_tr_b16 v[126:127], v25 offset:3168
  ds_read_b64_tr_b16 v[128:129], v24 offset:128
  ds_read_b64_tr_b16 v[130:131], v24 offset:3200
  ds_read_b64_tr_b16 v[132:133], v24 offset:6144
  ds_read_b64_tr_b16 v[134:135], v24 offset:9216
  ds_read_b64_tr_b16 v[136:137], v25 offset:6176
  ds_read_b64_tr_b16 v[138:139], v25 offset:9248
  ds_read_b64_tr_b16 v[140:141], v24 offset:6208
  ds_read_b64_tr_b16 v[142:143], v24 offset:9280
  ds_read_b64_tr_b16 v[144:145], v25 offset:6240
  ds_read_b64_tr_b16 v[146:147], v25 offset:9312
  ds_read_b64_tr_b16 v[148:149], v24 offset:6272
  ds_read_b64_tr_b16 v[150:151], v24 offset:9344
  s_barrier
  ds_read_b128 v[200:203], v27 offset:0
  ds_read_b64_tr_b16 v[152:153], v24 offset:12288
  ds_read_b64_tr_b16 v[154:155], v24 offset:15360
  s_waitcnt lgkmcnt(15)
  v_mfma_f32_16x16x32_bf16 v[32:35], v[192:195], v[112:115], 0
  v_mfma_f32_16x16x32_bf16 v[36:39], v[196:199], v[112:115], 0
  ds_read_b128 v[204:207], v27 offset:2048
  ds_read_b64_tr_b16 v[156:157], v25 offset:12320
  ds_read_b64_tr_b16 v[158:159], v25 offset:15392
  v_mfma_f32_16x16x32_bf16 v[40:43], v[192:195], v[116:119], 0
  v_mfma_f32_16x16x32_bf16 v[44:47], v[196:199], v[116:119], 0
  ds_read_b64_tr_b16 v[160:161], v24 offset:12352
  ds_read_b64_tr_b16 v[162:163], v24 offset:15424
  v_mfma_f32_16x16x32_bf16 v[48:51], v[192:195], v[120:123], 0
  v_mfma_f32_16x16x32_bf16 v[52:55], v[196:199], v[120:123], 0
  ds_read_b64_tr_b16 v[164:165], v25 offset:12384
  ds_read_b64_tr_b16 v[166:167], v25 offset:15456
  v_mfma_f32_16x16x32_bf16 v[56:59], v[192:195], v[124:127], 0
  v_mfma_f32_16x16x32_bf16 v[60:63], v[196:199], v[124:127], 0
  ds_read_b64_tr_b16 v[168:169], v24 offset:12416
  ds_read_b64_tr_b16 v[170:171], v24 offset:15488
  s_waitcnt lgkmcnt(15)
  v_mfma_f32_16x16x32_bf16 v[64:67], v[192:195], v[128:131], 0
  v_mfma_f32_16x16x32_bf16 v[68:71], v[196:199], v[128:131], 0
  ds_read_b64_tr_b16 v[172:173], v24 offset:18432
  ds_read_b64_tr_b16 v[174:175], v24 offset:21504
  v_mfma_f32_16x16x32_bf16 v[72:75], v[192:195], v[132:135], 0
  v_mfma_f32_16x16x32_bf16 v[76:79], v[196:199], v[132:135], 0
  ds_read_b64_tr_b16 v[176:177], v25 offset:18464
  ds_read_b64_tr_b16 v[178:179], v25 offset:21536
  v_mfma_f32_16x16x32_bf16 v[80:83], v[192:195], v[136:139], 0
  v_mfma_f32_16x16x32_bf16 v[84:87], v[196:199], v[136:139], 0
  ds_read_b64_tr_b16 v[180:181], v24 offset:18496
  ds_read_b64_tr_b16 v[182:183], v24 offset:21568
  v_mfma_f32_16x16x32_bf16 v[88:91], v[192:195], v[140:143], 0
  v_mfma_f32_16x16x32_bf16 v[92:95], v[196:199], v[140:143], 0
  ds_read_b64_tr_b16 v[184:185], v25 offset:18528
  ds_read_b64_tr_b16 v[186:187], v25 offset:21600
  s_waitcnt lgkmcnt(15)
  v_mfma_f32_16x16x32_bf16 v[96:99], v[192:195], v[144:147], 0
  v_mfma_f32_16x16x32_bf16 v[100:103], v[196:199], v[144:147], 0
  ds_read_b64_tr_b16 v[188:189], v24 offset:18560
  ds_read_b64_tr_b16 v[190:191], v24 offset:21632
  v_mfma_f32_16x16x32_bf16 v[104:107], v[192:195], v[148:151], 0
  v_mfma_f32_16x16x32_bf16 v[108:111], v[196:199], v[148:151], 0
  s_barrier
  ds_read_b128 v[192:195], v26 offset:16384
  ds_read_b64_tr_b16 v[112:113], v24 offset:24576
  ds_read_b64_tr_b16 v[114:115], v24 offset:27648
  v_mfma_f32_16x16x32_bf16 v[32:35], v[200:203], v[152:155], v[32:35]
  v_mfma_f32_16x16x32_bf16 v[36:39], v[204:207], v[152:155], v[36:39]
  ds_read_b128 v[196:199], v26 offset:18432
  ds_read_b64_tr_b16 v[116:117], v25 offset:24608
  ds_read_b64_tr_b16 v[118:119], v25 offset:27680
  s_waitcnt lgkmcnt(15)
  v_mfma_f32_16x16x32_bf16 v[40:43], v[200:203], v[156:159], v[40:43]
  v_mfma_f32_16x16x32_bf16 v[44:47], v[204:207], v[156:159], v[44:47]
  ds_read_b64_tr_b16 v[120:121], v24 offset:24640
  ds_read_b64_tr_b16 v[122:123], v24 offset:27712
  v_mfma_f32_16x16x32_bf16 v[48:51], v[200:203], v[160:163], v[48:51]
  v_mfma_f32_16x16x32_bf16 v[52:55], v[204:207], v[160:163], v[52:55]
  ds_read_b64_tr_b16 v[124:125], v25 offset:24672
  ds_read_b64_tr_b16 v[126:127], v25 offset:27744
  v_mfma_f32_16x16x32_bf16 v[56:59], v[200:203], v[164:167], v[56:59]
  v_mfma_f32_16x16x32_bf16 v[60:63], v[204:207], v[164:167], v[60:63]
  ds_read_b64_tr_b16 v[128:129], v24 offset:24704
  ds_read_b64_tr_b16 v[130:131], v24 offset:27776
  v_mfma_f32_16x16x32_bf16 v[64:67], v[200:203], v[168:171], v[64:67]
  v_mfma_f32_16x16x32_bf16 v[68:71], v[204:207], v[168:171], v[68:71]
  ds_read_b64_tr_b16 v[132:133], v24 offset:30720
  ds_read_b64_tr_b16 v[134:135], v24 offset:33792
  s_waitcnt lgkmcnt(15)
  v_mfma_f32_16x16x32_bf16 v[72:75], v[200:203], v[172:175], v[72:75]
  v_mfma_f32_16x16x32_bf16 v[76:79], v[204:207], v[172:175], v[76:79]
  ds_read_b64_tr_b16 v[136:137], v25 offset:30752
  ds_read_b64_tr_b16 v[138:139], v25 offset:33824
  v_mfma_f32_16x16x32_bf16 v[80:83], v[200:203], v[176:179], v[80:83]
  v_mfma_f32_16x16x32_bf16 v[84:87], v[204:207], v[176:179], v[84:87]
  ds_read_b64_tr_b16 v[140:141], v24 offset:30784
  ds_read_b64_tr_b16 v[142:143], v24 offset:33856
  v_mfma_f32_16x16x32_bf16 v[88:91], v[200:203], v[180:183], v[88:91]
  v_mfma_f32_16x16x32_bf16 v[92:95], v[204:207], v[180:183], v[92:95]
  ds_read_b64_tr_b16 v[144:145], v25 offset:30816
  ds_read_b64_tr_b16 v[146:147], v25 offset:33888
  v_mfma_f32_16x16x32_bf16 v[96:99], v[200:203], v[184:187], v[96:99]
  v_mfma_f32_16x16x32_bf16 v[100:103], v[204:207], v[184:187], v[100:103]
  ds_read_b64_tr_b16 v[148:149], v24 offset:30848
  ds_read_b64_tr_b16 v[150:151], v24 offset:33920
  s_waitcnt lgkmcnt(15)
  v_mfma_f32_16x16x32_bf16 v[104:107], v[200:203], v[188:191], v[104:107]
  v_mfma_f32_16x16x32_bf16 v[108:111], v[204:207], v[188:191], v[108:111]
  ds_read_b64_tr_b16 v[208:209], v8 offset:0
  ds_read_b64_tr_b16 v[210:211], v8 offset:3072
  ds_read_b64_tr_b16 v[212:213], v9 offset:32
  ds_read_b64_tr_b16 v[214:215], v9 offset:3104
  ds_read_b64_tr_b16 v[216:217], v8 offset:64
  ds_read_b64_tr_b16 v[218:219], v8 offset:3136
  ds_read_b64_tr_b16 v[220:221], v9 offset:96
  ds_read_b64_tr_b16 v[222:223], v9 offset:3168
  ds_read_b64_tr_b16 v[224:225], v8 offset:128
  ds_read_b64_tr_b16 v[226:227], v8 offset:3200
  s_barrier
  ds_read_b128 v[200:203], v27 offset:16384
  ds_read_b64_tr_b16 v[152:153], v24 offset:36864
  ds_read_b64_tr_b16 v[154:155], v24 offset:39936
  v_mfma_f32_16x16x32_bf16 v[32:35], v[192:195], v[112:115], v[32:35]
  v_mfma_f32_16x16x32_bf16 v[36:39], v[196:199], v[112:115], v[36:39]
  ds_read_b128 v[204:207], v27 offset:18432
  ds_read_b64_tr_b16 v[156:157], v25 offset:36896
  ds_read_b64_tr_b16 v[158:159], v25 offset:39968
  v_mfma_f32_16x16x32_bf16 v[40:43], v[192:195], v[116:119], v[40:43]
  v_mfma_f32_16x16x32_bf16 v[44:47], v[196:199], v[116:119], v[44:47]
  ds_read_b64_tr_b16 v[160:161], v24 offset:36928
  ds_read_b64_tr_b16 v[162:163], v24 offset:40000
  s_waitcnt lgkmcnt(15)
  v_mfma_f32_16x16x32_bf16 v[48:51], v[192:195], v[120:123], v[48:51]
  v_mfma_f32_16x16x32_bf16 v[52:55], v[196:199], v[120:123], v[52:55]
  ds_read_b64_tr_b16 v[164:165], v25 offset:36960
  ds_read_b64_tr_b16 v[166:167], v25 offset:40032
  v_mfma_f32_16x16x32_bf16 v[56:59], v[192:195], v[124:127], v[56:59]
  v_mfma_f32_16x16x32_bf16 v[60:63], v[196:199], v[124:127], v[60:63]
  ds_read_b64_tr_b16 v[168:169], v24 offset:36992
  ds_read_b64_tr_b16 v[170:171], v24 offset:40064
  v_mfma_f32_16x16x32_bf16 v[64:67], v[192:195], v[128:131], v[64:67]
  v_mfma_f32_16x16x32_bf16 v[68:71], v[196:199], v[128:131], v[68:71]
  ds_read_b64_tr_b16 v[172:173], v24 offset:43008
  ds_read_b64_tr_b16 v[174:175], v24 offset:46080
  v_mfma_f32_16x16x32_bf16 v[72:75], v[192:195], v[132:135], v[72:75]
  v_mfma_f32_16x16x32_bf16 v[76:79], v[196:199], v[132:135], v[76:79]
  ds_read_b64_tr_b16 v[176:177], v25 offset:43040
  ds_read_b64_tr_b16 v[178:179], v25 offset:46112
  v_mfma_f32_16x16x32_bf16 v[80:83], v[192:195], v[136:139], v[80:83]
  v_mfma_f32_16x16x32_bf16 v[84:87], v[196:199], v[136:139], v[84:87]
  ds_read_b64_tr_b16 v[180:181], v24 offset:43072
  ds_read_b64_tr_b16 v[182:183], v24 offset:46144
  v_mfma_f32_16x16x32_bf16 v[88:91], v[192:195], v[140:143], v[88:91]
  v_mfma_f32_16x16x32_bf16 v[92:95], v[196:199], v[140:143], v[92:95]
  ds_read_b64_tr_b16 v[184:185], v25 offset:43104
  ds_read_b64_tr_b16 v[186:187], v25 offset:46176
  v_mfma_f32_16x16x32_bf16 v[96:99], v[192:195], v[144:147], v[96:99]
  v_mfma_f32_16x16x32_bf16 v[100:103], v[196:199], v[144:147], v[100:103]
  ds_read_b64_tr_b16 v[188:189], v24 offset:43136
  ds_read_b64_tr_b16 v[190:191], v24 offset:46208
  v_mfma_f32_16x16x32_bf16 v[104:107], v[192:195], v[148:151], v[104:107]
  v_mfma_f32_16x16x32_bf16 v[108:111], v[196:199], v[148:151], v[108:111]
  buffer_load_dword v255, v254, s[64:67], 0 offen sc1
  s_waitcnt lgkmcnt(15)
  buffer_store_dwordx4 v[208:211], v10, s[48:51], 0 offen offset:0 sc1
  buffer_store_dwordx4 v[212:215], v10, s[48:51], 0 offen offset:1024 sc1
  buffer_store_dwordx4 v[216:219], v10, s[48:51], 0 offen offset:2048 sc1
  buffer_store_dwordx4 v[220:223], v10, s[48:51], 0 offen offset:3072 sc1
  v_add_u32 v10, 4096, v10
  buffer_store_dwordx4 v[224:227], v10, s[48:51], 0 offen sc1
  s_nop 1
  s_barrier
  ds_read_b128 v[192:195], v26 offset:32768
  ds_read_b64_tr_b16 v[112:113], v18 offset:0
  ds_read_b64_tr_b16 v[114:115], v18 offset:3072
  v_mfma_f32_16x16x32_bf16 v[32:35], v[200:203], v[152:155], v[32:35]
  v_mfma_f32_16x16x32_bf16 v[36:39], v[204:207], v[152:155], v[36:39]
  ds_read_b128 v[196:199], v26 offset:34816
  ds_read_b64_tr_b16 v[116:117], v19 offset:32
  ds_read_b64_tr_b16 v[118:119], v19 offset:3104
  v_mfma_f32_16x16x32_bf16 v[40:43], v[200:203], v[156:159], v[40:43]
  v_mfma_f32_16x16x32_bf16 v[44:47], v[204:207], v[156:159], v[44:47]
  ds_read_b64_tr_b16 v[120:121], v18 offset:64
  ds_read_b64_tr_b16 v[122:123], v18 offset:3136
  s_waitcnt lgkmcnt(15)
  v_mfma_f32_16x16x32_bf16 v[48:51], v[200:203], v[160:163], v[48:51]
  v_mfma_f32_16x16x32_bf16 v[52:55], v[204:207], v[160:163], v[52:55]
  ds_read_b64_tr_b16 v[124:125], v19 offset:96
  ds_read_b64_tr_b16 v[126:127], v19 offset:3168
  v_mfma_f32_16x16x32_bf16 v[56:59], v[200:203], v[164:167], v[56:59]
  v_mfma_f32_16x16x32_bf16 v[60:63], v[204:207], v[164:167], v[60:63]
  ds_read_b64_tr_b16 v[128:129], v18 offset:128
  ds_read_b64_tr_b16 v[130:131], v18 offset:3200
  v_mfma_f32_16x16x32_bf16 v[64:67], v[200:203], v[168:171], v[64:67]
  v_mfma_f32_16x16x32_bf16 v[68:71], v[204:207], v[168:171], v[68:71]
  ds_read_b64_tr_b16 v[132:133], v18 offset:6144
  ds_read_b64_tr_b16 v[134:135], v18 offset:9216
  v_mfma_f32_16x16x32_bf16 v[72:75], v[200:203], v[172:175], v[72:75]
  v_mfma_f32_16x16x32_bf16 v[76:79], v[204:207], v[172:175], v[76:79]
  ds_read_b64_tr_b16 v[136:137], v19 offset:6176
  ds_read_b64_tr_b16 v[138:139], v19 offset:9248
  s_waitcnt lgkmcnt(15)
  v_mfma_f32_16x16x32_bf16 v[80:83], v[200:203], v[176:179], v[80:83]
  v_mfma_f32_16x16x32_bf16 v[84:87], v[204:207], v[176:179], v[84:87]
  ds_read_b64_tr_b16 v[140:141], v18 offset:6208
  ds_read_b64_tr_b16 v[142:143], v18 offset:9280
  v_mfma_f32_16x16x32_bf16 v[88:91], v[200:203], v[180:183], v[88:91]
  v_mfma_f32_16x16x32_bf16 v[92:95], v[204:207], v[180:183], v[92:95]
  ds_read_b64_tr_b16 v[144:145], v19 offset:6240
  ds_read_b64_tr_b16 v[146:147], v19 offset:9312
  v_mfma_f32_16x16x32_bf16 v[96:99], v[200:203], v[184:187], v[96:99]
  v_mfma_f32_16x16x32_bf16 v[100:103], v[204:207], v[184:187], v[100:103]
  ds_read_b64_tr_b16 v[148:149], v18 offset:6272
  ds_read_b64_tr_b16 v[150:151], v18 offset:9344
  v_mfma_f32_16x16x32_bf16 v[104:107], v[200:203], v[188:191], v[104:107]
  v_mfma_f32_16x16x32_bf16 v[108:111], v[204:207], v[188:191], v[108:111]
  s_barrier
  ds_read_b128 v[200:203], v27 offset:32768
  ds_read_b64_tr_b16 v[152:153], v18 offset:12288
  ds_read_b64_tr_b16 v[154:155], v18 offset:15360
  s_waitcnt lgkmcnt(15)
  v_mfma_f32_16x16x32_bf16 v[32:35], v[192:195], v[112:115], v[32:35]
  v_mfma_f32_16x16x32_bf16 v[36:39], v[196:199], v[112:115], v[36:39]
  ds_read_b128 v[204:207], v27 offset:34816
  ds_read_b64_tr_b16 v[156:157], v19 offset:12320
  ds_read_b64_tr_b16 v[158:159], v19 offset:15392
  v_mfma_f32_16x16x32_bf16 v[40:43], v[192:195], v[116:119], v[40:43]
  v_mfma_f32_16x16x32_bf16 v[44:47], v[196:199], v[116:119], v[44:47]
  ds_read_b64_tr_b16 v[160:161], v18 offset:12352
  ds_read_b64_tr_b16 v[162:163], v18 offset:15424
  v_mfma_f32_16x16x32_bf16 v[48:51], v[192:195], v[120:123], v[48:51]
  v_mfma_f32_16x16x32_bf16 v[52:55], v[196:199], v[120:123], v[52:55]
  ds_read_b64_tr_b16 v[164:165], v19 offset:12384
  ds_read_b64_tr_b16 v[166:167], v19 offset:15456
  v_mfma_f32_16x16x32_bf16 v[56:59], v[192:195], v[124:127], v[56:59]
  v_mfma_f32_16x16x32_bf16 v[60:63], v[196:199], v[124:127], v[60:63]
  ds_read_b64_tr_b16 v[168:169], v18 offset:12416
  ds_read_b64_tr_b16 v[170:171], v18 offset:15488
  s_waitcnt lgkmcnt(15)
  v_mfma_f32_16x16x32_bf16 v[64:67], v[192:195], v[128:131], v[64:67]
  v_mfma_f32_16x16x32_bf16 v[68:71], v[196:199], v[128:131], v[68:71]
  ds_read_b64_tr_b16 v[172:173], v18 offset:18432
  ds_read_b64_tr_b16 v[174:175], v18 offset:21504
  v_mfma_f32_16x16x32_bf16 v[72:75], v[192:195], v[132:135], v[72:75]
  v_mfma_f32_16x16x32_bf16 v[76:79], v[196:199], v[132:135], v[76:79]
  ds_read_b64_tr_b16 v[176:177], v19 offset:18464
  ds_read_b64_tr_b16 v[178:179], v19 offset:21536
  v_mfma_f32_16x16x32_bf16 v[80:83], v[192:195], v[136:139], v[80:83]
  v_mfma_f32_16x16x32_bf16 v[84:87], v[196:199], v[136:139], v[84:87]
  ds_read_b64_tr_b16 v[180:181], v18 offset:18496
  ds_read_b64_tr_b16 v[182:183], v18 offset:21568
  v_mfma_f32_16x16x32_bf16 v[88:91], v[192:195], v[140:143], v[88:91]
  v_mfma_f32_16x16x32_bf16 v[92:95], v[196:199], v[140:143], v[92:95]
  ds_read_b64_tr_b16 v[184:185], v19 offset:18528
  ds_read_b64_tr_b16 v[186:187], v19 offset:21600
  s_waitcnt lgkmcnt(15)
  v_mfma_f32_16x16x32_bf16 v[96:99], v[192:195], v[144:147], v[96:99]
  v_mfma_f32_16x16x32_bf16 v[100:103], v[196:199], v[144:147], v[100:103]
  ds_read_b64_tr_b16 v[188:189], v18 offset:18560
  ds_read_b64_tr_b16 v[190:191], v18 offset:21632
  v_mfma_f32_16x16x32_bf16 v[104:107], v[192:195], v[148:151], v[104:107]
  v_mfma_f32_16x16x32_bf16 v[108:111], v[196:199], v[148:151], v[108:111]
  s_barrier
  ds_read_b128 v[192:195], v26 offset:49152
  ds_read_b64_tr_b16 v[112:113], v18 offset:24576
  ds_read_b64_tr_b16 v[114:115], v18 offset:27648
  v_mfma_f32_16x16x32_bf16 v[32:35], v[200:203], v[152:155], v[32:35]
  v_mfma_f32_16x16x32_bf16 v[36:39], v[204:207], v[152:155], v[36:39]
  ds_read_b128 v[196:199], v26 offset:51200
  ds_read_b64_tr_b16 v[116:117], v19 offset:24608
  ds_read_b64_tr_b16 v[118:119], v19 offset:27680
  s_waitcnt lgkmcnt(15)
  v_mfma_f32_16x16x32_bf16 v[40:43], v[200:203], v[156:159], v[40:43]
  v_mfma_f32_16x16x32_bf16 v[44:47], v[204:207], v[156:159], v[44:47]
  ds_read_b64_tr_b16 v[120:121], v18 offset:24640
  ds_read_b64_tr_b16 v[122:123], v18 offset:27712
  v_mfma_f32_16x16x32_bf16 v[48:51], v[200:203], v[160:163], v[48:51]
  v_mfma_f32_16x16x32_bf16 v[52:55], v[204:207], v[160:163], v[52:55]
  ds_read_b64_tr_b16 v[124:125], v19 offset:24672
  ds_read_b64_tr_b16 v[126:127], v19 offset:27744
  v_mfma_f32_16x16x32_bf16 v[56:59], v[200:203], v[164:167], v[56:59]
  v_mfma_f32_16x16x32_bf16 v[60:63], v[204:207], v[164:167], v[60:63]
  ds_read_b64_tr_b16 v[128:129], v18 offset:24704
  ds_read_b64_tr_b16 v[130:131], v18 offset:27776
  v_mfma_f32_16x16x32_bf16 v[64:67], v[200:203], v[168:171], v[64:67]
  v_mfma_f32_16x16x32_bf16 v[68:71], v[204:207], v[168:171], v[68:71]
  ds_read_b64_tr_b16 v[132:133], v18 offset:30720
  ds_read_b64_tr_b16 v[134:135], v18 offset:33792
  s_waitcnt lgkmcnt(15)
  v_mfma_f32_16x16x32_bf16 v[72:75], v[200:203], v[172:175], v[72:75]
  v_mfma_f32_16x16x32_bf16 v[76:79], v[204:207], v[172:175], v[76:79]
  ds_read_b64_tr_b16 v[136:137], v19 offset:30752
  ds_read_b64_tr_b16 v[138:139], v19 offset:33824
  v_mfma_f32_16x16x32_bf16 v[80:83], v[200:203], v[176:179], v[80:83]
  v_mfma_f32_16x16x32_bf16 v[84:87], v[204:207], v[176:179], v[84:87]
  ds_read_b64_tr_b16 v[140:141], v18 offset:30784
  ds_read_b64_tr_b16 v[142:143], v18 offset:33856
  v_mfma_f32_16x16x32_bf16 v[88:91], v[200:203], v[180:183], v[88:91]
  v_mfma_f32_16x16x32_bf16 v[92:95], v[204:207], v[180:183], v[92:95]
  ds_read_b64_tr_b16 v[144:145], v19 offset:30816
  ds_read_b64_tr_b16 v[146:147], v19 offset:33888
  v_mfma_f32_16x16x32_bf16 v[96:99], v[200:203], v[184:187], v[96:99]
  v_mfma_f32_16x16x32_bf16 v[100:103], v[204:207], v[184:187], v[100:103]
  ds_read_b64_tr_b16 v[148:149], v18 offset:30848
  ds_read_b64_tr_b16 v[150:151], v18 offset:33920
  s_waitcnt lgkmcnt(15)
  v_mfma_f32_16x16x32_bf16 v[104:107], v[200:203], v[188:191], v[104:107]
  v_mfma_f32_16x16x32_bf16 v[108:111], v[204:207], v[188:191], v[108:111]
  s_barrier
  ds_read_b128 v[200:203], v27 offset:49152
  ds_read_b64_tr_b16 v[152:153], v18 offset:36864
  ds_read_b64_tr_b16 v[154:155], v18 offset:39936
  v_mfma_f32_16x16x32_bf16 v[32:35], v[192:195], v[112:115], v[32:35]
  v_mfma_f32_16x16x32_bf16 v[36:39], v[196:199], v[112:115], v[36:39]
  ds_read_b128 v[204:207], v27 offset:51200
  ds_read_b64_tr_b16 v[156:157], v19 offset:36896
  ds_read_b64_tr_b16 v[158:159], v19 offset:39968
  v_mfma_f32_16x16x32_bf16 v[40:43], v[192:195], v[116:119], v[40:43]
  v_mfma_f32_16x16x32_bf16 v[44:47], v[196:199], v[116:119], v[44:47]
  ds_read_b64_tr_b16 v[160:161], v18 offset:36928
  ds_read_b64_tr_b16 v[162:163], v18 offset:40000
  s_waitcnt lgkmcnt(15)
  v_mfma_f32_16x16x32_bf16 v[48:51], v[192:195], v[120:123], v[48:51]
  v_mfma_f32_16x16x32_bf16 v[52:55], v[196:199], v[120:123], v[52:55]
  ds_read_b64_tr_b16 v[164:165], v19 offset:36960
  ds_read_b64_tr_b16 v[166:167], v19 offset:40032
  v_mfma_f32_16x16x32_bf16 v[56:59], v[192:195], v[124:127], v[56:59]
  v_mfma_f32_16x16x32_bf16 v[60:63], v[196:199], v[124:127], v[60:63]
  ds_read_b64_tr_b16 v[168:169], v18 offset:36992
  ds_read_b64_tr_b16 v[170:171], v18 offset:40064
  v_mfma_f32_16x16x32_bf16 v[64:67], v[192:195], v[128:131], v[64:67]
  v_mfma_f32_16x16x32_bf16 v[68:71], v[196:199], v[128:131], v[68:71]
  ds_read_b64_tr_b16 v[172:173], v18 offset:43008
  ds_read_b64_tr_b16 v[174:175], v18 offset:46080
  v_mfma_f32_16x16x32_bf16 v[72:75], v[192:195], v[132:135], v[72:75]
  v_mfma_f32_16x16x32_bf16 v[76:79], v[196:199], v[132:135], v[76:79]
  ds_read_b64_tr_b16 v[176:177], v19 offset:43040
  ds_read_b64_tr_b16 v[178:179], v19 offset:46112
  s_waitcnt lgkmcnt(15)
  v_mfma_f32_16x16x32_bf16 v[80:83], v[192:195], v[136:139], v[80:83]
  v_mfma_f32_16x16x32_bf16 v[84:87], v[196:199], v[136:139], v[84:87]
  ds_read_b64_tr_b16 v[180:181], v18 offset:43072
  ds_read_b64_tr_b16 v[182:183], v18 offset:46144
  v_mfma_f32_16x16x32_bf16 v[88:91], v[192:195], v[140:143], v[88:91]
  v_mfma_f32_16x16x32_bf16 v[92:95], v[196:199], v[140:143], v[92:95]
  ds_read_b64_tr_b16 v[184:185], v19 offset:43104
  ds_read_b64_tr_b16 v[186:187], v19 offset:46176
  v_mfma_f32_16x16x32_bf16 v[96:99], v[192:195], v[144:147], v[96:99]
  v_mfma_f32_16x16x32_bf16 v[100:103], v[196:199], v[144:147], v[100:103]
  ds_read_b64_tr_b16 v[188:189], v18 offset:43136
  ds_read_b64_tr_b16 v[190:191], v18 offset:46208
  v_mfma_f32_16x16x32_bf16 v[104:107], v[192:195], v[148:151], v[104:107]
  v_mfma_f32_16x16x32_bf16 v[108:111], v[196:199], v[148:151], v[108:111]
  s_waitcnt vmcnt(0)
  s_barrier
  s_cmp_lg_u32 s9, 0
  s_cbranch_scc1 fc_norpFalse
  v_readfirstlane_b32 s72, v255
  s_cmp_ge_u32 s72, 1
  s_cbranch_scc1 fc_norpFalse_p_done
  s_mov_b32 s64, s36
  s_and_b32 s65, s37, 0xffff
  s_mov_b32 s66, 0x100
  s_mov_b32 s67, 0x00020000
fc_norpFalse_p:
  buffer_load_dword v255, v254, s[64:67], 0 offen sc1
  s_waitcnt vmcnt(0)
  v_readfirstlane_b32 s72, v255
  s_cmp_ge_u32 s72, 1
  s_cbranch_scc1 fc_norpFalse_p_done
  s_sleep 4
  s_branch fc_norpFalse_p
fc_norpFalse_p_done:
  s_lshl_b32 s10, s75, 7
  s_add_u32 s10, s10, 0x11f0000
  v_mov_b32 v254, s10
  v_mov_b32 v255, 1
  s_mov_b64 exec, 1
  buffer_atomic_add v255, v254, s[48:51], 0 offen sc1
  s_mov_b64 exec, -1
fc_norpFalse:
  ds_read_b128 v[192:195], v26 offset:0
  ds_read_b64_tr_b16 v[112:113], v24 offset:0
  ds_read_b64_tr_b16 v[114:115], v24 offset:3072
  s_waitcnt lgkmcnt(15)
  v_mfma_f32_16x16x32_bf16 v[32:35], v[200:203], v[152:155], v[32:35]
  v_mfma_f32_16x16x32_bf16 v[36:39], v[204:207], v[152:155], v[36:39]
  ds_read_b128 v[196:199], v26 offset:2048
  ds_read_b64_tr_b16 v[116:117], v25 offset:32
  ds_read_b64_tr_b16 v[118:119], v25 offset:3104
  v_mfma_f32_16x16x32_bf16 v[40:43], v[200:203], v[156:159], v[40:43]
  v_mfma_f32_16x16x32_bf16 v[44:47], v[204:207], v[156:159], v[44:47]
  ds_read_b64_tr_b16 v[120:121], v24 offset:64
  ds_read_b64_tr_b16 v[122:123], v24 offset:3136
  v_mfma_f32_16x16x32_bf16 v[48:51], v[200:203], v[160:163], v[48:51]
  v_mfma_f32_16x16x32_bf16 v[52:55], v[204:207], v[160:163], v[52:55]
  ds_read_b64_tr_b16 v[124:125], v25 offset:96
  ds_read_b64_tr_b16 v[126:127], v25 offset:3168
  v_mfma_f32_16x16x32_bf16 v[56:59], v[200:203], v[164:167], v[56:59]
  v_mfma_f32_16x16x32_bf16 v[60:63], v[204:207], v[164:167], v[60:63]
  ds_read_b64_tr_b16 v[128:129], v24 offset:128
  ds_read_b64_tr_b16 v[130:131], v24 offset:3200
  s_waitcnt lgkmcnt(15)
  v_mfma_f32_16x16x32_bf16 v[64:67], v[200:203], v[168:171], v[64:67]
  v_mfma_f32_16x16x32_bf16 v[68:71], v[204:207], v[168:171], v[68:71]
  ds_read_b64_tr_b16 v[132:133], v24 offset:6144
  ds_read_b64_tr_b16 v[134:135], v24 offset:9216
  v_mfma_f32_16x16x32_bf16 v[72:75], v[200:203], v[172:175], v[72:75]
  v_mfma_f32_16x16x32_bf16 v[76:79], v[204:207], v[172:175], v[76:79]
  ds_read_b64_tr_b16 v[136:137], v25 offset:6176
  ds_read_b64_tr_b16 v[138:139], v25 offset:9248
  v_mfma_f32_16x16x32_bf16 v[80:83], v[200:203], v[176:179], v[80:83]
  v_mfma_f32_16x16x32_bf16 v[84:87], v[204:207], v[176:179], v[84:87]
  ds_read_b64_tr_b16 v[140:141], v24 offset:6208
  ds_read_b64_tr_b16 v[142:143], v24 offset:9280
  v_mfma_f32_16x16x32_bf16 v[88:91], v[200:203], v[180:183], v[88:91]
  v_mfma_f32_16x16x32_bf16 v[92:95], v[204:207], v[180:183], v[92:95]
  ds_read_b64_tr_b16 v[144:145], v25 offset:6240
  ds_read_b64_tr_b16 v[146:147], v25 offset:9312
  s_waitcnt lgkmcnt(15)
  v_mfma_f32_16x16x32_bf16 v[96:99], v[200:203], v[184:187], v[96:99]
  v_mfma_f32_16x16x32_bf16 v[100:103], v[204:207], v[184:187], v[100:103]
  ds_read_b64_tr_b16 v[148:149], v24 offset:6272
  ds_read_b64_tr_b16 v[150:151], v24 offset:9344
  v_mfma_f32_16x16x32_bf16 v[104:107], v[200:203], v[188:191], v[104:107]
  v_mfma_f32_16x16x32_bf16 v[108:111], v[204:207], v[188:191], v[108:111]
  s_barrier
  ds_read_b128 v[200:203], v27 offset:0
  ds_read_b64_tr_b16 v[152:153], v24 offset:12288
  ds_read_b64_tr_b16 v[154:155], v24 offset:15360
  v_mfma_f32_16x16x32_bf16 v[32:35], v[192:195], v[112:115], v[32:35]
  v_mfma_f32_16x16x32_bf16 v[36:39], v[196:199], v[112:115], v[36:39]
  ds_read_b128 v[204:207], v27 offset:2048
  ds_read_b64_tr_b16 v[156:157], v25 offset:12320
  ds_read_b64_tr_b16 v[158:159], v25 offset:15392
  s_waitcnt lgkmcnt(15)
  v_mfma_f32_16x16x32_bf16 v[40:43], v[192:195], v[116:119], v[40:43]
  v_mfma_f32_16x16x32_bf16 v[44:47], v[196:199], v[116:119], v[44:47]
  ds_read_b64_tr_b16 v[160:161], v24 offset:12352
  ds_read_b64_tr_b16 v[162:163], v24 offset:15424
  v_mfma_f32_16x16x32_bf16 v[48:51], v[192:195], v[120:123], v[48:51]
  v_mfma_f32_16x16x32_bf16 v[52:55], v[196:199], v[120:123], v[52:55]
  ds_read_b64_tr_b16 v[164:165], v25 offset:12384
  ds_read_b64_tr_b16 v[166:167], v25 offset:15456
  v_mfma_f32_16x16x32_bf16 v[56:59], v[192:195], v[124:127], v[56:59]
  v_mfma_f32_16x16x32_bf16 v[60:63], v[196:199], v[124:127], v[60:63]
  ds_read_b64_tr_b16 v[168:169], v24 offset:12416
  ds_read_b64_tr_b16 v[170:171], v24 offset:15488
  v_mfma_f32_16x16x32_bf16 v[64:67], v[192:195], v[128:131], v[64:67]
  v_mfma_f32_16x16x32_bf16 v[68:71], v[196:199], v[128:131], v[68:71]
  ds_read_b64_tr_b16 v[172:173], v24 offset:18432
  ds_read_b64_tr_b16 v[174:175], v24 offset:21504
  s_waitcnt lgkmcnt(15)
  v_mfma_f32_16x16x32_bf16 v[72:75], v[192:195], v[132:135], v[72:75]
  v_mfma_f32_16x16x32_bf16 v[76:79], v[196:199], v[132:135], v[76:79]
  ds_read_b64_tr_b16 v[176:177], v25 offset:18464
  ds_read_b64_tr_b16 v[178:179], v25 offset:21536
  v_mfma_f32_16x16x32_bf16 v[80:83], v[192:195], v[136:139], v[80:83]
  v_mfma_f32_16x16x32_bf16 v[84:87], v[196:199], v[136:139], v[84:87]
  ds_read_b64_tr_b16 v[180:181], v24 offset:18496
  ds_read_b64_tr_b16 v[182:183], v24 offset:21568
  v_mfma_f32_16x16x32_bf16 v[88:91], v[192:195], v[140:143], v[88:91]
  v_mfma_f32_16x16x32_bf16 v[92:95], v[196:199], v[140:143], v[92:95]
  ds_read_b64_tr_b16 v[184:185], v25 offset:18528
  ds_read_b64_tr_b16 v[186:187], v25 offset:21600
  v_mfma_f32_16x16x32_bf16 v[96:99], v[192:195], v[144:147], v[96:99]
  v_mfma_f32_16x16x32_bf16 v[100:103], v[196:199], v[144:147], v[100:103]
  ds_read_b64_tr_b16 v[188:189], v24 offset:18560
  ds_read_b64_tr_b16 v[190:191], v24 offset:21632
  s_waitcnt lgkmcnt(15)
  v_mfma_f32_16x16x32_bf16 v[104:107], v[192:195], v[148:151], v[104:107]
  v_mfma_f32_16x16x32_bf16 v[108:111], v[196:199], v[148:151], v[108:111]
  s_barrier
  ds_read_b128 v[192:195], v26 offset:16384
  ds_read_b64_tr_b16 v[112:113], v24 offset:24576
  ds_read_b64_tr_b16 v[114:115], v24 offset:27648
  v_mfma_f32_16x16x32_bf16 v[32:35], v[200:203], v[152:155], v[32:35]
  v_mfma_f32_16x16x32_bf16 v[36:39], v[204:207], v[152:155], v[36:39]
  ds_read_b128 v[196:199], v26 offset:18432
  ds_read_b64_tr_b16 v[116:117], v25 offset:24608
  ds_read_b64_tr_b16 v[118:119], v25 offset:27680
  v_mfma_f32_16x16x32_bf16 v[40:43], v[200:203], v[156:159], v[40:43]
  v_mfma_f32_16x16x32_bf16 v[44:47], v[204:207], v[156:159], v[44:47]
  ds_read_b64_tr_b16 v[120:121], v24 offset:24640
  ds_read_b64_tr_b16 v[122:123], v24 offset:27712
  s_waitcnt lgkmcnt(15)
  v_mfma_f32_16x16x32_bf16 v[48:51], v[200:203], v[160:163], v[48:51]
  v_mfma_f32_16x16x32_bf16 v[52:55], v[204:207], v[160:163], v[52:55]
  ds_read_b64_tr_b16 v[124:125], v25 offset:24672
  ds_read_b64_tr_b16 v[126:127], v25 offset:27744
  v_mfma_f32_16x16x32_bf16 v[56:59], v[200:203], v[164:167], v[56:59]
  v_mfma_f32_16x16x32_bf16 v[60:63], v[204:207], v[164:167], v[60:63]
  ds_read_b64_tr_b16 v[128:129], v24 offset:24704
  ds_read_b64_tr_b16 v[130:131], v24 offset:27776
  v_mfma_f32_16x16x32_bf16 v[64:67], v[200:203], v[168:171], v[64:67]
  v_mfma_f32_16x16x32_bf16 v[68:71], v[204:207], v[168:171], v[68:71]
  ds_read_b64_tr_b16 v[132:133], v24 offset:30720
  ds_read_b64_tr_b16 v[134:135], v24 offset:33792
  v_mfma_f32_16x16x32_bf16 v[72:75], v[200:203], v[172:175], v[72:75]
  v_mfma_f32_16x16x32_bf16 v[76:79], v[204:207], v[172:175], v[76:79]
  ds_read_b64_tr_b16 v[136:137], v25 offset:30752
  ds_read_b64_tr_b16 v[138:139], v25 offset:33824
  s_waitcnt lgkmcnt(15)
  v_mfma_f32_16x16x32_bf16 v[80:83], v[200:203], v[176:179], v[80:83]
  v_mfma_f32_16x16x32_bf16 v[84:87], v[204:207], v[176:179], v[84:87]
  ds_read_b64_tr_b16 v[140:141], v24 offset:30784
  ds_read_b64_tr_b16 v[142:143], v24 offset:33856
  v_mfma_f32_16x16x32_bf16 v[88:91], v[200:203], v[180:183], v[88:91]
  v_mfma_f32_16x16x32_bf16 v[92:95], v[204:207], v[180:183], v[92:95]
  ds_read_b64_tr_b16 v[144:145], v25 offset:30816
  ds_read_b64_tr_b16 v[146:147], v25 offset:33888
  v_mfma_f32_16x16x32_bf16 v[96:99], v[200:203], v[184:187], v[96:99]
  v_mfma_f32_16x16x32_bf16 v[100:103], v[204:207], v[184:187], v[100:103]
  ds_read_b64_tr_b16 v[148:149], v24 offset:30848
  ds_read_b64_tr_b16 v[150:151], v24 offset:33920
  v_mfma_f32_16x16x32_bf16 v[104:107], v[200:203], v[188:191], v[104:107]
  v_mfma_f32_16x16x32_bf16 v[108:111], v[204:207], v[188:191], v[108:111]
  s_barrier
  ds_read_b128 v[200:203], v27 offset:16384
  ds_read_b64_tr_b16 v[152:153], v24 offset:36864
  ds_read_b64_tr_b16 v[154:155], v24 offset:39936
  s_waitcnt lgkmcnt(15)
  v_mfma_f32_16x16x32_bf16 v[32:35], v[192:195], v[112:115], v[32:35]
  v_mfma_f32_16x16x32_bf16 v[36:39], v[196:199], v[112:115], v[36:39]
  ds_read_b128 v[204:207], v27 offset:18432
  ds_read_b64_tr_b16 v[156:157], v25 offset:36896
  ds_read_b64_tr_b16 v[158:159], v25 offset:39968
  v_mfma_f32_16x16x32_bf16 v[40:43], v[192:195], v[116:119], v[40:43]
  v_mfma_f32_16x16x32_bf16 v[44:47], v[196:199], v[116:119], v[44:47]
  ds_read_b64_tr_b16 v[160:161], v24 offset:36928
  ds_read_b64_tr_b16 v[162:163], v24 offset:40000
  v_mfma_f32_16x16x32_bf16 v[48:51], v[192:195], v[120:123], v[48:51]
  v_mfma_f32_16x16x32_bf16 v[52:55], v[196:199], v[120:123], v[52:55]
  ds_read_b64_tr_b16 v[164:165], v25 offset:36960
  ds_read_b64_tr_b16 v[166:167], v25 offset:40032
  v_mfma_f32_16x16x32_bf16 v[56:59], v[192:195], v[124:127], v[56:59]
  v_mfma_f32_16x16x32_bf16 v[60:63], v[196:199], v[124:127], v[60:63]
  ds_read_b64_tr_b16 v[168:169], v24 offset:36992
  ds_read_b64_tr_b16 v[170:171], v24 offset:40064
  s_waitcnt lgkmcnt(15)
  v_mfma_f32_16x16x32_bf16 v[64:67], v[192:195], v[128:131], v[64:67]
  v_mfma_f32_16x16x32_bf16 v[68:71], v[196:199], v[128:131], v[68:71]
  ds_read_b64_tr_b16 v[172:173], v24 offset:43008
  ds_read_b64_tr_b16 v[174:175], v24 offset:46080
  v_mfma_f32_16x16x32_bf16 v[72:75], v[192:195], v[132:135], v[72:75]
  v_mfma_f32_16x16x32_bf16 v[76:79], v[196:199], v[132:135], v[76:79]
  ds_read_b64_tr_b16 v[176:177], v25 offset:43040
  ds_read_b64_tr_b16 v[178:179], v25 offset:46112
  v_mfma_f32_16x16x32_bf16 v[80:83], v[192:195], v[136:139], v[80:83]
  v_mfma_f32_16x16x32_bf16 v[84:87], v[196:199], v[136:139], v[84:87]
  ds_read_b64_tr_b16 v[180:181], v24 offset:43072
  ds_read_b64_tr_b16 v[182:183], v24 offset:46144
  v_mfma_f32_16x16x32_bf16 v[88:91], v[192:195], v[140:143], v[88:91]
  v_mfma_f32_16x16x32_bf16 v[92:95], v[196:199], v[140:143], v[92:95]
  ds_read_b64_tr_b16 v[184:185], v25 offset:43104
  ds_read_b64_tr_b16 v[186:187], v25 offset:46176
  s_waitcnt lgkmcnt(15)
  v_mfma_f32_16x16x32_bf16 v[96:99], v[192:195], v[144:147], v[96:99]
  v_mfma_f32_16x16x32_bf16 v[100:103], v[196:199], v[144:147], v[100:103]
  ds_read_b64_tr_b16 v[188:189], v24 offset:43136
  ds_read_b64_tr_b16 v[190:191], v24 offset:46208
  v_mfma_f32_16x16x32_bf16 v[104:107], v[192:195], v[148:151], v[104:107]
  v_mfma_f32_16x16x32_bf16 v[108:111], v[196:199], v[148:151], v[108:111]
  s_barrier
  ds_read_b128 v[192:195], v26 offset:32768
  ds_read_b64_tr_b16 v[112:113], v18 offset:0
  ds_read_b64_tr_b16 v[114:115], v18 offset:3072
  v_mfma_f32_16x16x32_bf16 v[32:35], v[200:203], v[152:155], v[32:35]
  v_mfma_f32_16x16x32_bf16 v[36:39], v[204:207], v[152:155], v[36:39]
  ds_read_b128 v[196:199], v26 offset:34816
  ds_read_b64_tr_b16 v[116:117], v19 offset:32
  ds_read_b64_tr_b16 v[118:119], v19 offset:3104
  s_waitcnt lgkmcnt(15)
  v_mfma_f32_16x16x32_bf16 v[40:43], v[200:203], v[156:159], v[40:43]
  v_mfma_f32_16x16x32_bf16 v[44:47], v[204:207], v[156:159], v[44:47]
  ds_read_b64_tr_b16 v[120:121], v18 offset:64
  ds_read_b64_tr_b16 v[122:123], v18 offset:3136
  v_mfma_f32_16x16x32_bf16 v[48:51], v[200:203], v[160:163], v[48:51]
  v_mfma_f32_16x16x32_bf16 v[52:55], v[204:207], v[160:163], v[52:55]
  ds_read_b64_tr_b16 v[124:125], v19 offset:96
  ds_read_b64_tr_b16 v[126:127], v19 offset:3168
  v_mfma_f32_16x16x32_bf16 v[56:59], v[200:203], v[164:167], v[56:59]
  v_mfma_f32_16x16x32_bf16 v[60:63], v[204:207], v[164:167], v[60:63]
  ds_read_b64_tr_b16 v[128:129], v18 offset:128
  ds_read_b64_tr_b16 v[130:131], v18 offset:3200
  v_mfma_f32_16x16x32_bf16 v[64:67], v[200:203], v[168:171], v[64:67]
  v_mfma_f32_16x16x32_bf16 v[68:71], v[204:207], v[168:171], v[68:71]
  ds_read_b64_tr_b16 v[132:133], v18 offset:6144
  ds_read_b64_tr_b16 v[134:135], v18 offset:9216
  s_waitcnt lgkmcnt(15)
  v_mfma_f32_16x16x32_bf16 v[72:75], v[200:203], v[172:175], v[72:75]
  v_mfma_f32_16x16x32_bf16 v[76:79], v[204:207], v[172:175], v[76:79]
  ds_read_b64_tr_b16 v[136:137], v19 offset:6176
  ds_read_b64_tr_b16 v[138:139], v19 offset:9248
  v_mfma_f32_16x16x32_bf16 v[80:83], v[200:203], v[176:179], v[80:83]
  v_mfma_f32_16x16x32_bf16 v[84:87], v[204:207], v[176:179], v[84:87]
  ds_read_b64_tr_b16 v[140:141], v18 offset:6208
  ds_read_b64_tr_b16 v[142:143], v18 offset:9280
  v_mfma_f32_16x16x32_bf16 v[88:91], v[200:203], v[180:183], v[88:91]
  v_mfma_f32_16x16x32_bf16 v[92:95], v[204:207], v[180:183], v[92:95]
  ds_read_b64_tr_b16 v[144:145], v19 offset:6240
  ds_read_b64_tr_b16 v[146:147], v19 offset:9312
  v_mfma_f32_16x16x32_bf16 v[96:99], v[200:203], v[184:187], v[96:99]
  v_mfma_f32_16x16x32_bf16 v[100:103], v[204:207], v[184:187], v[100:103]
  ds_read_b64_tr_b16 v[148:149], v18 offset:6272
  ds_read_b64_tr_b16 v[150:151], v18 offset:9344
  s_waitcnt lgkmcnt(15)
  v_mfma_f32_16x16x32_bf16 v[104:107], v[200:203], v[188:191], v[104:107]
  v_mfma_f32_16x16x32_bf16 v[108:111], v[204:207], v[188:191], v[108:111]
  s_barrier
  ds_read_b128 v[200:203], v27 offset:32768
  ds_read_b64_tr_b16 v[152:153], v18 offset:12288
  ds_read_b64_tr_b16 v[154:155], v18 offset:15360
  v_mfma_f32_16x16x32_bf16 v[32:35], v[192:195], v[112:115], v[32:35]
  v_mfma_f32_16x16x32_bf16 v[36:39], v[196:199], v[112:115], v[36:39]
  ds_read_b128 v[204:207], v27 offset:34816
  ds_read_b64_tr_b16 v[156:157], v19 offset:12320
  ds_read_b64_tr_b16 v[158:159], v19 offset:15392
  v_mfma_f32_16x16x32_bf16 v[40:43], v[192:195], v[116:119], v[40:43]
  v_mfma_f32_16x16x32_bf16 v[44:47], v[196:199], v[116:119], v[44:47]
  ds_read_b64_tr_b16 v[160:161], v18 offset:12352
  ds_read_b64_tr_b16 v[162:163], v18 offset:15424
  s_waitcnt lgkmcnt(15)
  v_mfma_f32_16x16x32_bf16 v[48:51], v[192:195], v[120:123], v[48:51]
  v_mfma_f32_16x16x32_bf16 v[52:55], v[196:199], v[120:123], v[52:55]
  ds_read_b64_tr_b16 v[164:165], v19 offset:12384
  ds_read_b64_tr_b16 v[166:167], v19 offset:15456
  v_mfma_f32_16x16x32_bf16 v[56:59], v[192:195], v[124:127], v[56:59]
  v_mfma_f32_16x16x32_bf16 v[60:63], v[196:199], v[124:127], v[60:63]
  ds_read_b64_tr_b16 v[168:169], v18 offset:12416
  ds_read_b64_tr_b16 v[170:171], v18 offset:15488
  v_mfma_f32_16x16x32_bf16 v[64:67], v[192:195], v[128:131], v[64:67]
  v_mfma_f32_16x16x32_bf16 v[68:71], v[196:199], v[128:131], v[68:71]
  ds_read_b64_tr_b16 v[172:173], v18 offset:18432
  ds_read_b64_tr_b16 v[174:175], v18 offset:21504
  v_mfma_f32_16x16x32_bf16 v[72:75], v[192:195], v[132:135], v[72:75]
  v_mfma_f32_16x16x32_bf16 v[76:79], v[196:199], v[132:135], v[76:79]
  ds_read_b64_tr_b16 v[176:177], v19 offset:18464
  ds_read_b64_tr_b16 v[178:179], v19 offset:21536
  s_waitcnt lgkmcnt(15)
  v_mfma_f32_16x16x32_bf16 v[80:83], v[192:195], v[136:139], v[80:83]
  v_mfma_f32_16x16x32_bf16 v[84:87], v[196:199], v[136:139], v[84:87]
  ds_read_b64_tr_b16 v[180:181], v18 offset:18496
  ds_read_b64_tr_b16 v[182:183], v18 offset:21568
  v_mfma_f32_16x16x32_bf16 v[88:91], v[192:195], v[140:143], v[88:91]
  v_mfma_f32_16x16x32_bf16 v[92:95], v[196:199], v[140:143], v[92:95]
  ds_read_b64_tr_b16 v[184:185], v19 offset:18528
  ds_read_b64_tr_b16 v[186:187], v19 offset:21600
  v_mfma_f32_16x16x32_bf16 v[96:99], v[192:195], v[144:147], v[96:99]
  v_mfma_f32_16x16x32_bf16 v[100:103], v[196:199], v[144:147], v[100:103]
  ds_read_b64_tr_b16 v[188:189], v18 offset:18560
  ds_read_b64_tr_b16 v[190:191], v18 offset:21632
  v_mfma_f32_16x16x32_bf16 v[104:107], v[192:195], v[148:151], v[104:107]
  v_mfma_f32_16x16x32_bf16 v[108:111], v[196:199], v[148:151], v[108:111]
  s_barrier
  ds_read_b128 v[192:195], v26 offset:49152
  ds_read_b64_tr_b16 v[112:113], v18 offset:24576
  ds_read_b64_tr_b16 v[114:115], v18 offset:27648
  s_waitcnt lgkmcnt(15)
  v_mfma_f32_16x16x32_bf16 v[32:35], v[200:203], v[152:155], v[32:35]
  v_mfma_f32_16x16x32_bf16 v[36:39], v[204:207], v[152:155], v[36:39]
  ds_read_b128 v[196:199], v26 offset:51200
  ds_read_b64_tr_b16 v[116:117], v19 offset:24608
  ds_read_b64_tr_b16 v[118:119], v19 offset:27680
  v_mfma_f32_16x16x32_bf16 v[40:43], v[200:203], v[156:159], v[40:43]
  v_mfma_f32_16x16x32_bf16 v[44:47], v[204:207], v[156:159], v[44:47]
  ds_read_b64_tr_b16 v[120:121], v18 offset:24640
  ds_read_b64_tr_b16 v[122:123], v18 offset:27712
  v_mfma_f32_16x16x32_bf16 v[48:51], v[200:203], v[160:163], v[48:51]
  v_mfma_f32_16x16x32_bf16 v[52:55], v[204:207], v[160:163], v[52:55]
  ds_read_b64_tr_b16 v[124:125], v19 offset:24672
  ds_read_b64_tr_b16 v[126:127], v19 offset:27744
  v_mfma_f32_16x16x32_bf16 v[56:59], v[200:203], v[164:167], v[56:59]
  v_mfma_f32_16x16x32_bf16 v[60:63], v[204:207], v[164:167], v[60:63]
  ds_read_b64_tr_b16 v[128:129], v18 offset:24704
  ds_read_b64_tr_b16 v[130:131], v18 offset:27776
  s_waitcnt lgkmcnt(15)
  v_mfma_f32_16x16x32_bf16 v[64:67], v[200:203], v[168:171], v[64:67]
  v_mfma_f32_16x16x32_bf16 v[68:71], v[204:207], v[168:171], v[68:71]
  ds_read_b64_tr_b16 v[132:133], v18 offset:30720
  ds_read_b64_tr_b16 v[134:135], v18 offset:33792
  v_mfma_f32_16x16x32_bf16 v[72:75], v[200:203], v[172:175], v[72:75]
  v_mfma_f32_16x16x32_bf16 v[76:79], v[204:207], v[172:175], v[76:79]
  ds_read_b64_tr_b16 v[136:137], v19 offset:30752
  ds_read_b64_tr_b16 v[138:139], v19 offset:33824
  v_mfma_f32_16x16x32_bf16 v[80:83], v[200:203], v[176:179], v[80:83]
  v_mfma_f32_16x16x32_bf16 v[84:87], v[204:207], v[176:179], v[84:87]
  ds_read_b64_tr_b16 v[140:141], v18 offset:30784
  ds_read_b64_tr_b16 v[142:143], v18 offset:33856
  v_mfma_f32_16x16x32_bf16 v[88:91], v[200:203], v[180:183], v[88:91]
  v_mfma_f32_16x16x32_bf16 v[92:95], v[204:207], v[180:183], v[92:95]
  ds_read_b64_tr_b16 v[144:145], v19 offset:30816
  ds_read_b64_tr_b16 v[146:147], v19 offset:33888
  s_waitcnt lgkmcnt(15)
  v_mfma_f32_16x16x32_bf16 v[96:99], v[200:203], v[184:187], v[96:99]
  v_mfma_f32_16x16x32_bf16 v[100:103], v[204:207], v[184:187], v[100:103]
  ds_read_b64_tr_b16 v[148:149], v18 offset:30848
  ds_read_b64_tr_b16 v[150:151], v18 offset:33920
  v_mfma_f32_16x16x32_bf16 v[104:107], v[200:203], v[188:191], v[104:107]
  v_mfma_f32_16x16x32_bf16 v[108:111], v[204:207], v[188:191], v[108:111]
  s_barrier
  ds_read_b128 v[200:203], v27 offset:49152
  ds_read_b64_tr_b16 v[152:153], v18 offset:36864
  ds_read_b64_tr_b16 v[154:155], v18 offset:39936
  v_mfma_f32_16x16x32_bf16 v[32:35], v[192:195], v[112:115], v[32:35]
  v_mfma_f32_16x16x32_bf16 v[36:39], v[196:199], v[112:115], v[36:39]
  ds_read_b128 v[204:207], v27 offset:51200
  ds_read_b64_tr_b16 v[156:157], v19 offset:36896
  ds_read_b64_tr_b16 v[158:159], v19 offset:39968
  s_waitcnt lgkmcnt(15)
  v_mfma_f32_16x16x32_bf16 v[40:43], v[192:195], v[116:119], v[40:43]
  v_mfma_f32_16x16x32_bf16 v[44:47], v[196:199], v[116:119], v[44:47]
  ds_read_b64_tr_b16 v[160:161], v18 offset:36928
  ds_read_b64_tr_b16 v[162:163], v18 offset:40000
  v_mfma_f32_16x16x32_bf16 v[48:51], v[192:195], v[120:123], v[48:51]
  v_mfma_f32_16x16x32_bf16 v[52:55], v[196:199], v[120:123], v[52:55]
  ds_read_b64_tr_b16 v[164:165], v19 offset:36960
  ds_read_b64_tr_b16 v[166:167], v19 offset:40032
  v_mfma_f32_16x16x32_bf16 v[56:59], v[192:195], v[124:127], v[56:59]
  v_mfma_f32_16x16x32_bf16 v[60:63], v[196:199], v[124:127], v[60:63]
  ds_read_b64_tr_b16 v[168:169], v18 offset:36992
  ds_read_b64_tr_b16 v[170:171], v18 offset:40064
  v_mfma_f32_16x16x32_bf16 v[64:67], v[192:195], v[128:131], v[64:67]
  v_mfma_f32_16x16x32_bf16 v[68:71], v[196:199], v[128:131], v[68:71]
  ds_read_b64_tr_b16 v[172:173], v18 offset:43008
  ds_read_b64_tr_b16 v[174:175], v18 offset:46080
  s_waitcnt lgkmcnt(15)
  v_mfma_f32_16x16x32_bf16 v[72:75], v[192:195], v[132:135], v[72:75]
  v_mfma_f32_16x16x32_bf16 v[76:79], v[196:199], v[132:135], v[76:79]
  ds_read_b64_tr_b16 v[176:177], v19 offset:43040
  ds_read_b64_tr_b16 v[178:179], v19 offset:46112
  v_mfma_f32_16x16x32_bf16 v[80:83], v[192:195], v[136:139], v[80:83]
  v_mfma_f32_16x16x32_bf16 v[84:87], v[196:199], v[136:139], v[84:87]
  ds_read_b64_tr_b16 v[180:181], v18 offset:43072
  ds_read_b64_tr_b16 v[182:183], v18 offset:46144
  v_mfma_f32_16x16x32_bf16 v[88:91], v[192:195], v[140:143], v[88:91]
  v_mfma_f32_16x16x32_bf16 v[92:95], v[196:199], v[140:143], v[92:95]
  ds_read_b64_tr_b16 v[184:185], v19 offset:43104
  ds_read_b64_tr_b16 v[186:187], v19 offset:46176
  v_mfma_f32_16x16x32_bf16 v[96:99], v[192:195], v[144:147], v[96:99]
  v_mfma_f32_16x16x32_bf16 v[100:103], v[196:199], v[144:147], v[100:103]
  ds_read_b64_tr_b16 v[188:189], v18 offset:43136
  ds_read_b64_tr_b16 v[190:191], v18 offset:46208
  s_waitcnt lgkmcnt(15)
  v_mfma_f32_16x16x32_bf16 v[104:107], v[192:195], v[148:151], v[104:107]
  v_mfma_f32_16x16x32_bf16 v[108:111], v[196:199], v[148:151], v[108:111]
  s_barrier
  ds_read_b128 v[192:195], v26 offset:0
  ds_read_b64_tr_b16 v[112:113], v24 offset:0
  ds_read_b64_tr_b16 v[114:115], v24 offset:3072
  v_mfma_f32_16x16x32_bf16 v[32:35], v[200:203], v[152:155], v[32:35]
  v_mfma_f32_16x16x32_bf16 v[36:39], v[204:207], v[152:155], v[36:39]
  ds_read_b128 v[196:199], v26 offset:2048
  ds_read_b64_tr_b16 v[116:117], v25 offset:32
  ds_read_b64_tr_b16 v[118:119], v25 offset:3104
  v_mfma_f32_16x16x32_bf16 v[40:43], v[200:203], v[156:159], v[40:43]
  v_mfma_f32_16x16x32_bf16 v[44:47], v[204:207], v[156:159], v[44:47]
  ds_read_b64_tr_b16 v[120:121], v24 offset:64
  ds_read_b64_tr_b16 v[122:123], v24 offset:3136
  s_waitcnt lgkmcnt(15)
  v_mfma_f32_16x16x32_bf16 v[48:51], v[200:203], v[160:163], v[48:51]
  v_mfma_f32_16x16x32_bf16 v[52:55], v[204:207], v[160:163], v[52:55]
  ds_read_b64_tr_b16 v[124:125], v25 offset:96
  ds_read_b64_tr_b16 v[126:127], v25 offset:3168
  v_mfma_f32_16x16x32_bf16 v[56:59], v[200:203], v[164:167], v[56:59]
  v_mfma_f32_16x16x32_bf16 v[60:63], v[204:207], v[164:167], v[60:63]
  ds_read_b64_tr_b16 v[128:129], v24 offset:128
  ds_read_b64_tr_b16 v[130:131], v24 offset:3200
  v_mfma_f32_16x16x32_bf16 v[64:67], v[200:203], v[168:171], v[64:67]
  v_mfma_f32_16x16x32_bf16 v[68:71], v[204:207], v[168:171], v[68:71]
  ds_read_b64_tr_b16 v[132:133], v24 offset:6144
  ds_read_b64_tr_b16 v[134:135], v24 offset:9216
  v_mfma_f32_16x16x32_bf16 v[72:75], v[200:203], v[172:175], v[72:75]
  v_mfma_f32_16x16x32_bf16 v[76:79], v[204:207], v[172:175], v[76:79]
  ds_read_b64_tr_b16 v[136:137], v25 offset:6176
  ds_read_b64_tr_b16 v[138:139], v25 offset:9248
  s_waitcnt lgkmcnt(15)
  v_mfma_f32_16x16x32_bf16 v[80:83], v[200:203], v[176:179], v[80:83]
  v_mfma_f32_16x16x32_bf16 v[84:87], v[204:207], v[176:179], v[84:87]
  ds_read_b64_tr_b16 v[140:141], v24 offset:6208
  ds_read_b64_tr_b16 v[142:143], v24 offset:9280
  v_mfma_f32_16x16x32_bf16 v[88:91], v[200:203], v[180:183], v[88:91]
  v_mfma_f32_16x16x32_bf16 v[92:95], v[204:207], v[180:183], v[92:95]
  ds_read_b64_tr_b16 v[144:145], v25 offset:6240
  ds_read_b64_tr_b16 v[146:147], v25 offset:9312
  v_mfma_f32_16x16x32_bf16 v[96:99], v[200:203], v[184:187], v[96:99]
  v_mfma_f32_16x16x32_bf16 v[100:103], v[204:207], v[184:187], v[100:103]
  ds_read_b64_tr_b16 v[148:149], v24 offset:6272
  ds_read_b64_tr_b16 v[150:151], v24 offset:9344
  v_mfma_f32_16x16x32_bf16 v[104:107], v[200:203], v[188:191], v[104:107]
  v_mfma_f32_16x16x32_bf16 v[108:111], v[204:207], v[188:191], v[108:111]
  s_barrier
  ds_read_b128 v[200:203], v27 offset:0
  ds_read_b64_tr_b16 v[152:153], v24 offset:12288
  ds_read_b64_tr_b16 v[154:155], v24 offset:15360
  s_waitcnt lgkmcnt(15)
  v_mfma_f32_16x16x32_bf16 v[32:35], v[192:195], v[112:115], v[32:35]
  v_mfma_f32_16x16x32_bf16 v[36:39], v[196:199], v[112:115], v[36:39]
  ds_read_b128 v[204:207], v27 offset:2048
  ds_read_b64_tr_b16 v[156:157], v25 offset:12320
  ds_read_b64_tr_b16 v[158:159], v25 offset:15392
  v_mfma_f32_16x16x32_bf16 v[40:43], v[192:195], v[116:119], v[40:43]
  v_mfma_f32_16x16x32_bf16 v[44:47], v[196:199], v[116:119], v[44:47]
  ds_read_b64_tr_b16 v[160:161], v24 offset:12352
  ds_read_b64_tr_b16 v[162:163], v24 offset:15424
  v_mfma_f32_16x16x32_bf16 v[48:51], v[192:195], v[120:123], v[48:51]
  v_mfma_f32_16x16x32_bf16 v[52:55], v[196:199], v[120:123], v[52:55]
  ds_read_b64_tr_b16 v[164:165], v25 offset:12384
  ds_read_b64_tr_b16 v[166:167], v25 offset:15456
  v_mfma_f32_16x16x32_bf16 v[56:59], v[192:195], v[124:127], v[56:59]
  v_mfma_f32_16x16x32_bf16 v[60:63], v[196:199], v[124:127], v[60:63]
  ds_read_b64_tr_b16 v[168:169], v24 offset:12416
  ds_read_b64_tr_b16 v[170:171], v24 offset:15488
  s_waitcnt lgkmcnt(15)
  v_mfma_f32_16x16x32_bf16 v[64:67], v[192:195], v[128:131], v[64:67]
  v_mfma_f32_16x16x32_bf16 v[68:71], v[196:199], v[128:131], v[68:71]
  ds_read_b64_tr_b16 v[172:173], v24 offset:18432
  ds_read_b64_tr_b16 v[174:175], v24 offset:21504
  v_mfma_f32_16x16x32_bf16 v[72:75], v[192:195], v[132:135], v[72:75]
  v_mfma_f32_16x16x32_bf16 v[76:79], v[196:199], v[132:135], v[76:79]
  ds_read_b64_tr_b16 v[176:177], v25 offset:18464
  ds_read_b64_tr_b16 v[178:179], v25 offset:21536
  v_mfma_f32_16x16x32_bf16 v[80:83], v[192:195], v[136:139], v[80:83]
  v_mfma_f32_16x16x32_bf16 v[84:87], v[196:199], v[136:139], v[84:87]
  ds_read_b64_tr_b16 v[180:181], v24 offset:18496
  ds_read_b64_tr_b16 v[182:183], v24 offset:21568
  v_mfma_f32_16x16x32_bf16 v[88:91], v[192:195], v[140:143], v[88:91]
  v_mfma_f32_16x16x32_bf16 v[92:95], v[196:199], v[140:143], v[92:95]
  ds_read_b64_tr_b16 v[184:185], v25 offset:18528
  ds_read_b64_tr_b16 v[186:187], v25 offset:21600
  s_waitcnt lgkmcnt(15)
  v_mfma_f32_16x16x32_bf16 v[96:99], v[192:195], v[144:147], v[96:99]
  v_mfma_f32_16x16x32_bf16 v[100:103], v[196:199], v[144:147], v[100:103]
  ds_read_b64_tr_b16 v[188:189], v24 offset:18560
  ds_read_b64_tr_b16 v[190:191], v24 offset:21632
  v_mfma_f32_16x16x32_bf16 v[104:107], v[192:195], v[148:151], v[104:107]
  v_mfma_f32_16x16x32_bf16 v[108:111], v[196:199], v[148:151], v[108:111]
  s_barrier
  ds_read_b128 v[192:195], v26 offset:16384
  ds_read_b64_tr_b16 v[112:113], v24 offset:24576
  ds_read_b64_tr_b16 v[114:115], v24 offset:27648
  v_mfma_f32_16x16x32_bf16 v[32:35], v[200:203], v[152:155], v[32:35]
  v_mfma_f32_16x16x32_bf16 v[36:39], v[204:207], v[152:155], v[36:39]
  ds_read_b128 v[196:199], v26 offset:18432
  ds_read_b64_tr_b16 v[116:117], v25 offset:24608
  ds_read_b64_tr_b16 v[118:119], v25 offset:27680
  s_waitcnt lgkmcnt(15)
  v_mfma_f32_16x16x32_bf16 v[40:43], v[200:203], v[156:159], v[40:43]
  v_mfma_f32_16x16x32_bf16 v[44:47], v[204:207], v[156:159], v[44:47]
  ds_read_b64_tr_b16 v[120:121], v24 offset:24640
  ds_read_b64_tr_b16 v[122:123], v24 offset:27712
  v_mfma_f32_16x16x32_bf16 v[48:51], v[200:203], v[160:163], v[48:51]
  v_mfma_f32_16x16x32_bf16 v[52:55], v[204:207], v[160:163], v[52:55]
  ds_read_b64_tr_b16 v[124:125], v25 offset:24672
  ds_read_b64_tr_b16 v[126:127], v25 offset:27744
  v_mfma_f32_16x16x32_bf16 v[56:59], v[200:203], v[164:167], v[56:59]
  v_mfma_f32_16x16x32_bf16 v[60:63], v[204:207], v[164:167], v[60:63]
  ds_read_b64_tr_b16 v[128:129], v24 offset:24704
  ds_read_b64_tr_b16 v[130:131], v24 offset:27776
  v_mfma_f32_16x16x32_bf16 v[64:67], v[200:203], v[168:171], v[64:67]
  v_mfma_f32_16x16x32_bf16 v[68:71], v[204:207], v[168:171], v[68:71]
  ds_read_b64_tr_b16 v[132:133], v24 offset:30720
  ds_read_b64_tr_b16 v[134:135], v24 offset:33792
  s_waitcnt lgkmcnt(15)
  v_mfma_f32_16x16x32_bf16 v[72:75], v[200:203], v[172:175], v[72:75]
  v_mfma_f32_16x16x32_bf16 v[76:79], v[204:207], v[172:175], v[76:79]
  ds_read_b64_tr_b16 v[136:137], v25 offset:30752
  ds_read_b64_tr_b16 v[138:139], v25 offset:33824
  v_mfma_f32_16x16x32_bf16 v[80:83], v[200:203], v[176:179], v[80:83]
  v_mfma_f32_16x16x32_bf16 v[84:87], v[204:207], v[176:179], v[84:87]
  ds_read_b64_tr_b16 v[140:141], v24 offset:30784
  ds_read_b64_tr_b16 v[142:143], v24 offset:33856
  v_mfma_f32_16x16x32_bf16 v[88:91], v[200:203], v[180:183], v[88:91]
  v_mfma_f32_16x16x32_bf16 v[92:95], v[204:207], v[180:183], v[92:95]
  ds_read_b64_tr_b16 v[144:145], v25 offset:30816
  ds_read_b64_tr_b16 v[146:147], v25 offset:33888
  v_mfma_f32_16x16x32_bf16 v[96:99], v[200:203], v[184:187], v[96:99]
  v_mfma_f32_16x16x32_bf16 v[100:103], v[204:207], v[184:187], v[100:103]
  ds_read_b64_tr_b16 v[148:149], v24 offset:30848
  ds_read_b64_tr_b16 v[150:151], v24 offset:33920
  s_waitcnt lgkmcnt(15)
  v_mfma_f32_16x16x32_bf16 v[104:107], v[200:203], v[188:191], v[104:107]
  v_mfma_f32_16x16x32_bf16 v[108:111], v[204:207], v[188:191], v[108:111]
  s_barrier
  ds_read_b128 v[200:203], v27 offset:16384
  ds_read_b64_tr_b16 v[152:153], v24 offset:36864
  ds_read_b64_tr_b16 v[154:155], v24 offset:39936
  v_mfma_f32_16x16x32_bf16 v[32:35], v[192:195], v[112:115], v[32:35]
  v_mfma_f32_16x16x32_bf16 v[36:39], v[196:199], v[112:115], v[36:39]
  ds_read_b128 v[204:207], v27 offset:18432
  ds_read_b64_tr_b16 v[156:157], v25 offset:36896
  ds_read_b64_tr_b16 v[158:159], v25 offset:39968
  v_mfma_f32_16x16x32_bf16 v[40:43], v[192:195], v[116:119], v[40:43]
  v_mfma_f32_16x16x32_bf16 v[44:47], v[196:199], v[116:119], v[44:47]
  ds_read_b64_tr_b16 v[160:161], v24 offset:36928
  ds_read_b64_tr_b16 v[162:163], v24 offset:40000
  s_waitcnt lgkmcnt(15)
  v_mfma_f32_16x16x32_bf16 v[48:51], v[192:195], v[120:123], v[48:51]
  v_mfma_f32_16x16x32_bf16 v[52:55], v[196:199], v[120:123], v[52:55]
  ds_read_b64_tr_b16 v[164:165], v25 offset:36960
  ds_read_b64_tr_b16 v[166:167], v25 offset:40032
  v_mfma_f32_16x16x32_bf16 v[56:59], v[192:195], v[124:127], v[56:59]
  v_mfma_f32_16x16x32_bf16 v[60:63], v[196:199], v[124:127], v[60:63]
  ds_read_b64_tr_b16 v[168:169], v24 offset:36992
  ds_read_b64_tr_b16 v[170:171], v24 offset:40064
  v_mfma_f32_16x16x32_bf16 v[64:67], v[192:195], v[128:131], v[64:67]
  v_mfma_f32_16x16x32_bf16 v[68:71], v[196:199], v[128:131], v[68:71]
  ds_read_b64_tr_b16 v[172:173], v24 offset:43008
  ds_read_b64_tr_b16 v[174:175], v24 offset:46080
  v_mfma_f32_16x16x32_bf16 v[72:75], v[192:195], v[132:135], v[72:75]
  v_mfma_f32_16x16x32_bf16 v[76:79], v[196:199], v[132:135], v[76:79]
  ds_read_b64_tr_b16 v[176:177], v25 offset:43040
  ds_read_b64_tr_b16 v[178:179], v25 offset:46112
  s_waitcnt lgkmcnt(15)
  v_mfma_f32_16x16x32_bf16 v[80:83], v[192:195], v[136:139], v[80:83]
  v_mfma_f32_16x16x32_bf16 v[84:87], v[196:199], v[136:139], v[84:87]
  ds_read_b64_tr_b16 v[180:181], v24 offset:43072
  ds_read_b64_tr_b16 v[182:183], v24 offset:46144
  v_mfma_f32_16x16x32_bf16 v[88:91], v[192:195], v[140:143], v[88:91]
  v_mfma_f32_16x16x32_bf16 v[92:95], v[196:199], v[140:143], v[92:95]
  ds_read_b64_tr_b16 v[184:185], v25 offset:43104
  ds_read_b64_tr_b16 v[186:187], v25 offset:46176
  v_mfma_f32_16x16x32_bf16 v[96:99], v[192:195], v[144:147], v[96:99]
  v_mfma_f32_16x16x32_bf16 v[100:103], v[196:199], v[144:147], v[100:103]
  ds_read_b64_tr_b16 v[188:189], v24 offset:43136
  ds_read_b64_tr_b16 v[190:191], v24 offset:46208
  v_mfma_f32_16x16x32_bf16 v[104:107], v[192:195], v[148:151], v[104:107]
  v_mfma_f32_16x16x32_bf16 v[108:111], v[196:199], v[148:151], v[108:111]
  s_waitcnt lgkmcnt(15)
  v_mfma_f32_16x16x32_bf16 v[32:35], v[200:203], v[152:155], v[32:35]
  v_mfma_f32_16x16x32_bf16 v[36:39], v[204:207], v[152:155], v[36:39]
  v_mfma_f32_16x16x32_bf16 v[40:43], v[200:203], v[156:159], v[40:43]
  v_mfma_f32_16x16x32_bf16 v[44:47], v[204:207], v[156:159], v[44:47]
  s_waitcnt lgkmcnt(14)
  v_mfma_f32_16x16x32_bf16 v[48:51], v[200:203], v[160:163], v[48:51]
  v_mfma_f32_16x16x32_bf16 v[52:55], v[204:207], v[160:163], v[52:55]
  s_waitcnt lgkmcnt(12)
  v_mfma_f32_16x16x32_bf16 v[56:59], v[200:203], v[164:167], v[56:59]
  v_mfma_f32_16x16x32_bf16 v[60:63], v[204:207], v[164:167], v[60:63]
  s_waitcnt lgkmcnt(10)
  v_mfma_f32_16x16x32_bf16 v[64:67], v[200:203], v[168:171], v[64:67]
  v_mfma_f32_16x16x32_bf16 v[68:71], v[204:207], v[168:171], v[68:71]
  s_waitcnt lgkmcnt(8)
  v_mfma_f32_16x16x32_bf16 v[72:75], v[200:203], v[172:175], v[72:75]
  v_mfma_f32_16x16x32_bf16 v[76:79], v[204:207], v[172:175], v[76:79]
  s_waitcnt lgkmcnt(6)
  v_mfma_f32_16x16x32_bf16 v[80:83], v[200:203], v[176:179], v[80:83]
  v_mfma_f32_16x16x32_bf16 v[84:87], v[204:207], v[176:179], v[84:87]
  s_waitcnt lgkmcnt(4)
  v_mfma_f32_16x16x32_bf16 v[88:91], v[200:203], v[180:183], v[88:91]
  v_mfma_f32_16x16x32_bf16 v[92:95], v[204:207], v[180:183], v[92:95]
  s_waitcnt lgkmcnt(2)
  v_mfma_f32_16x16x32_bf16 v[96:99], v[200:203], v[184:187], v[96:99]
  v_mfma_f32_16x16x32_bf16 v[100:103], v[204:207], v[184:187], v[100:103]
  s_waitcnt lgkmcnt(0)
  v_mfma_f32_16x16x32_bf16 v[104:107], v[200:203], v[188:191], v[104:107]
  v_mfma_f32_16x16x32_bf16 v[108:111], v[204:207], v[188:191], v[108:111]
  s_barrier
  s_mov_b32 s60, 0x3fb8aa3b
  s_mov_b32 s61, 0x3fb8aa3b
  s_mov_b32 s62, 1.0
  s_mov_b32 s63, 1.0
  s_mov_b32 s64, 0x358637bd
  s_mov_b32 s65, 0x358637bd
  s_nop 3
  v_cvt_pk_bf16_f32 v152, v32, v33
  v_cvt_pk_bf16_f32 v153, v34, v35
  v_lshlrev_b32 v154, 16, v152
  v_and_b32 v155, 0xffff0000, v152
  v_lshlrev_b32 v156, 16, v153
  v_and_b32 v157, 0xffff0000, v153
  v_pk_mul_f32 v[158:159], v[154:155], s[60:61]
  v_pk_mul_f32 v[160:161], v[156:157], s[60:61]
  v_exp_f32 v158, v158
  v_exp_f32 v159, v159
  v_exp_f32 v160, v160
  v_exp_f32 v161, v161
  v_pk_add_f32 v[154:155], v[154:155], s[62:63]
  v_pk_add_f32 v[156:157], v[156:157], s[62:63]
  v_med3_f32 v154, v154, v158, 1.0
  v_med3_f32 v155, v155, v159, 1.0
  v_med3_f32 v156, v156, v160, 1.0
  v_med3_f32 v157, v157, v161, 1.0
  v_cvt_pk_bf16_f32 v152, v154, v155
  v_cvt_pk_bf16_f32 v153, v156, v157
  v_lshlrev_b32 v154, 16, v152
  v_and_b32 v155, 0xffff0000, v152
  v_lshlrev_b32 v156, 16, v153
  v_and_b32 v157, 0xffff0000, v153
  v_pk_add_f32 v[154:155], v[154:155], s[64:65]
  v_pk_add_f32 v[156:157], v[156:157], s[64:65]
  v_cvt_pk_bf16_f32 v112, v154, v155
  v_cvt_pk_bf16_f32 v113, v156, v157
  v_cvt_pk_bf16_f32 v164, v36, v37
  v_cvt_pk_bf16_f32 v165, v38, v39
  v_lshlrev_b32 v166, 16, v164
  v_and_b32 v167, 0xffff0000, v164
  v_lshlrev_b32 v168, 16, v165
  v_and_b32 v169, 0xffff0000, v165
  v_pk_mul_f32 v[170:171], v[166:167], s[60:61]
  v_pk_mul_f32 v[172:173], v[168:169], s[60:61]
  v_exp_f32 v170, v170
  v_exp_f32 v171, v171
  v_exp_f32 v172, v172
  v_exp_f32 v173, v173
  v_pk_add_f32 v[166:167], v[166:167], s[62:63]
  v_pk_add_f32 v[168:169], v[168:169], s[62:63]
  v_med3_f32 v166, v166, v170, 1.0
  v_med3_f32 v167, v167, v171, 1.0
  v_med3_f32 v168, v168, v172, 1.0
  v_med3_f32 v169, v169, v173, 1.0
  v_cvt_pk_bf16_f32 v164, v166, v167
  v_cvt_pk_bf16_f32 v165, v168, v169
  v_lshlrev_b32 v166, 16, v164
  v_and_b32 v167, 0xffff0000, v164
  v_lshlrev_b32 v168, 16, v165
  v_and_b32 v169, 0xffff0000, v165
  v_pk_add_f32 v[166:167], v[166:167], s[64:65]
  v_pk_add_f32 v[168:169], v[168:169], s[64:65]
  v_cvt_pk_bf16_f32 v114, v166, v167
  v_cvt_pk_bf16_f32 v115, v168, v169
  v_cvt_pk_bf16_f32 v152, v40, v41
  v_cvt_pk_bf16_f32 v153, v42, v43
  v_lshlrev_b32 v154, 16, v152
  v_and_b32 v155, 0xffff0000, v152
  v_lshlrev_b32 v156, 16, v153
  v_and_b32 v157, 0xffff0000, v153
  v_pk_mul_f32 v[158:159], v[154:155], s[60:61]
  v_pk_mul_f32 v[160:161], v[156:157], s[60:61]
  v_exp_f32 v158, v158
  v_exp_f32 v159, v159
  v_exp_f32 v160, v160
  v_exp_f32 v161, v161
  v_pk_add_f32 v[154:155], v[154:155], s[62:63]
  v_pk_add_f32 v[156:157], v[156:157], s[62:63]
  v_med3_f32 v154, v154, v158, 1.0
  v_med3_f32 v155, v155, v159, 1.0
  v_med3_f32 v156, v156, v160, 1.0
  v_med3_f32 v157, v157, v161, 1.0
  v_cvt_pk_bf16_f32 v152, v154, v155
  v_cvt_pk_bf16_f32 v153, v156, v157
  v_lshlrev_b32 v154, 16, v152
  v_and_b32 v155, 0xffff0000, v152
  v_lshlrev_b32 v156, 16, v153
  v_and_b32 v157, 0xffff0000, v153
  v_pk_add_f32 v[154:155], v[154:155], s[64:65]
  v_pk_add_f32 v[156:157], v[156:157], s[64:65]
  v_cvt_pk_bf16_f32 v116, v154, v155
  v_cvt_pk_bf16_f32 v117, v156, v157
  v_cvt_pk_bf16_f32 v164, v44, v45
  v_cvt_pk_bf16_f32 v165, v46, v47
  v_lshlrev_b32 v166, 16, v164
  v_and_b32 v167, 0xffff0000, v164
  v_lshlrev_b32 v168, 16, v165
  v_and_b32 v169, 0xffff0000, v165
  v_pk_mul_f32 v[170:171], v[166:167], s[60:61]
  v_pk_mul_f32 v[172:173], v[168:169], s[60:61]
  v_exp_f32 v170, v170
  v_exp_f32 v171, v171
  v_exp_f32 v172, v172
  v_exp_f32 v173, v173
  v_pk_add_f32 v[166:167], v[166:167], s[62:63]
  v_pk_add_f32 v[168:169], v[168:169], s[62:63]
  v_med3_f32 v166, v166, v170, 1.0
  v_med3_f32 v167, v167, v171, 1.0
  v_med3_f32 v168, v168, v172, 1.0
  v_med3_f32 v169, v169, v173, 1.0
  v_cvt_pk_bf16_f32 v164, v166, v167
  v_cvt_pk_bf16_f32 v165, v168, v169
  v_lshlrev_b32 v166, 16, v164
  v_and_b32 v167, 0xffff0000, v164
  v_lshlrev_b32 v168, 16, v165
  v_and_b32 v169, 0xffff0000, v165
  v_pk_add_f32 v[166:167], v[166:167], s[64:65]
  v_pk_add_f32 v[168:169], v[168:169], s[64:65]
  v_cvt_pk_bf16_f32 v118, v166, v167
  v_cvt_pk_bf16_f32 v119, v168, v169
  v_cvt_pk_bf16_f32 v152, v48, v49
  v_cvt_pk_bf16_f32 v153, v50, v51
  v_lshlrev_b32 v154, 16, v152
  v_and_b32 v155, 0xffff0000, v152
  v_lshlrev_b32 v156, 16, v153
  v_and_b32 v157, 0xffff0000, v153
  v_pk_mul_f32 v[158:159], v[154:155], s[60:61]
  v_pk_mul_f32 v[160:161], v[156:157], s[60:61]
  v_exp_f32 v158, v158
  v_exp_f32 v159, v159
  v_exp_f32 v160, v160
  v_exp_f32 v161, v161
  v_pk_add_f32 v[154:155], v[154:155], s[62:63]
  v_pk_add_f32 v[156:157], v[156:157], s[62:63]
  v_med3_f32 v154, v154, v158, 1.0
  v_med3_f32 v155, v155, v159, 1.0
  v_med3_f32 v156, v156, v160, 1.0
  v_med3_f32 v157, v157, v161, 1.0
  v_cvt_pk_bf16_f32 v152, v154, v155
  v_cvt_pk_bf16_f32 v153, v156, v157
  v_lshlrev_b32 v154, 16, v152
  v_and_b32 v155, 0xffff0000, v152
  v_lshlrev_b32 v156, 16, v153
  v_and_b32 v157, 0xffff0000, v153
  v_pk_add_f32 v[154:155], v[154:155], s[64:65]
  v_pk_add_f32 v[156:157], v[156:157], s[64:65]
  v_cvt_pk_bf16_f32 v120, v154, v155
  v_cvt_pk_bf16_f32 v121, v156, v157
  v_cvt_pk_bf16_f32 v164, v52, v53
  v_cvt_pk_bf16_f32 v165, v54, v55
  v_lshlrev_b32 v166, 16, v164
  v_and_b32 v167, 0xffff0000, v164
  v_lshlrev_b32 v168, 16, v165
  v_and_b32 v169, 0xffff0000, v165
  v_pk_mul_f32 v[170:171], v[166:167], s[60:61]
  v_pk_mul_f32 v[172:173], v[168:169], s[60:61]
  v_exp_f32 v170, v170
  v_exp_f32 v171, v171
  v_exp_f32 v172, v172
  v_exp_f32 v173, v173
  v_pk_add_f32 v[166:167], v[166:167], s[62:63]
  v_pk_add_f32 v[168:169], v[168:169], s[62:63]
  v_med3_f32 v166, v166, v170, 1.0
  v_med3_f32 v167, v167, v171, 1.0
  v_med3_f32 v168, v168, v172, 1.0
  v_med3_f32 v169, v169, v173, 1.0
  v_cvt_pk_bf16_f32 v164, v166, v167
  v_cvt_pk_bf16_f32 v165, v168, v169
  v_lshlrev_b32 v166, 16, v164
  v_and_b32 v167, 0xffff0000, v164
  v_lshlrev_b32 v168, 16, v165
  v_and_b32 v169, 0xffff0000, v165
  v_pk_add_f32 v[166:167], v[166:167], s[64:65]
  v_pk_add_f32 v[168:169], v[168:169], s[64:65]
  v_cvt_pk_bf16_f32 v122, v166, v167
  v_cvt_pk_bf16_f32 v123, v168, v169
  v_cvt_pk_bf16_f32 v152, v56, v57
  v_cvt_pk_bf16_f32 v153, v58, v59
  v_lshlrev_b32 v154, 16, v152
  v_and_b32 v155, 0xffff0000, v152
  v_lshlrev_b32 v156, 16, v153
  v_and_b32 v157, 0xffff0000, v153
  v_pk_mul_f32 v[158:159], v[154:155], s[60:61]
  v_pk_mul_f32 v[160:161], v[156:157], s[60:61]
  v_exp_f32 v158, v158
  v_exp_f32 v159, v159
  v_exp_f32 v160, v160
  v_exp_f32 v161, v161
  v_pk_add_f32 v[154:155], v[154:155], s[62:63]
  v_pk_add_f32 v[156:157], v[156:157], s[62:63]
  v_med3_f32 v154, v154, v158, 1.0
  v_med3_f32 v155, v155, v159, 1.0
  v_med3_f32 v156, v156, v160, 1.0
  v_med3_f32 v157, v157, v161, 1.0
  v_cvt_pk_bf16_f32 v152, v154, v155
  v_cvt_pk_bf16_f32 v153, v156, v157
  v_lshlrev_b32 v154, 16, v152
  v_and_b32 v155, 0xffff0000, v152
  v_lshlrev_b32 v156, 16, v153
  v_and_b32 v157, 0xffff0000, v153
  v_pk_add_f32 v[154:155], v[154:155], s[64:65]
  v_pk_add_f32 v[156:157], v[156:157], s[64:65]
  v_cvt_pk_bf16_f32 v124, v154, v155
  v_cvt_pk_bf16_f32 v125, v156, v157
  v_cvt_pk_bf16_f32 v164, v60, v61
  v_cvt_pk_bf16_f32 v165, v62, v63
  v_lshlrev_b32 v166, 16, v164
  v_and_b32 v167, 0xffff0000, v164
  v_lshlrev_b32 v168, 16, v165
  v_and_b32 v169, 0xffff0000, v165
  v_pk_mul_f32 v[170:171], v[166:167], s[60:61]
  v_pk_mul_f32 v[172:173], v[168:169], s[60:61]
  v_exp_f32 v170, v170
  v_exp_f32 v171, v171
  v_exp_f32 v172, v172
  v_exp_f32 v173, v173
  v_pk_add_f32 v[166:167], v[166:167], s[62:63]
  v_pk_add_f32 v[168:169], v[168:169], s[62:63]
  v_med3_f32 v166, v166, v170, 1.0
  v_med3_f32 v167, v167, v171, 1.0
  v_med3_f32 v168, v168, v172, 1.0
  v_med3_f32 v169, v169, v173, 1.0
  v_cvt_pk_bf16_f32 v164, v166, v167
  v_cvt_pk_bf16_f32 v165, v168, v169
  v_lshlrev_b32 v166, 16, v164
  v_and_b32 v167, 0xffff0000, v164
  v_lshlrev_b32 v168, 16, v165
  v_and_b32 v169, 0xffff0000, v165
  v_pk_add_f32 v[166:167], v[166:167], s[64:65]
  v_pk_add_f32 v[168:169], v[168:169], s[64:65]
  v_cvt_pk_bf16_f32 v126, v166, v167
  v_cvt_pk_bf16_f32 v127, v168, v169
  v_cvt_pk_bf16_f32 v152, v64, v65
  v_cvt_pk_bf16_f32 v153, v66, v67
  v_lshlrev_b32 v154, 16, v152
  v_and_b32 v155, 0xffff0000, v152
  v_lshlrev_b32 v156, 16, v153
  v_and_b32 v157, 0xffff0000, v153
  v_pk_mul_f32 v[158:159], v[154:155], s[60:61]
  v_pk_mul_f32 v[160:161], v[156:157], s[60:61]
  v_exp_f32 v158, v158
  v_exp_f32 v159, v159
  v_exp_f32 v160, v160
  v_exp_f32 v161, v161
  v_pk_add_f32 v[154:155], v[154:155], s[62:63]
  v_pk_add_f32 v[156:157], v[156:157], s[62:63]
  v_med3_f32 v154, v154, v158, 1.0
  v_med3_f32 v155, v155, v159, 1.0
  v_med3_f32 v156, v156, v160, 1.0
  v_med3_f32 v157, v157, v161, 1.0
  v_cvt_pk_bf16_f32 v152, v154, v155
  v_cvt_pk_bf16_f32 v153, v156, v157
  v_lshlrev_b32 v154, 16, v152
  v_and_b32 v155, 0xffff0000, v152
  v_lshlrev_b32 v156, 16, v153
  v_and_b32 v157, 0xffff0000, v153
  v_pk_add_f32 v[154:155], v[154:155], s[64:65]
  v_pk_add_f32 v[156:157], v[156:157], s[64:65]
  v_cvt_pk_bf16_f32 v128, v154, v155
  v_cvt_pk_bf16_f32 v129, v156, v157
  v_cvt_pk_bf16_f32 v164, v68, v69
  v_cvt_pk_bf16_f32 v165, v70, v71
  v_lshlrev_b32 v166, 16, v164
  v_and_b32 v167, 0xffff0000, v164
  v_lshlrev_b32 v168, 16, v165
  v_and_b32 v169, 0xffff0000, v165
  v_pk_mul_f32 v[170:171], v[166:167], s[60:61]
  v_pk_mul_f32 v[172:173], v[168:169], s[60:61]
  v_exp_f32 v170, v170
  v_exp_f32 v171, v171
  v_exp_f32 v172, v172
  v_exp_f32 v173, v173
  v_pk_add_f32 v[166:167], v[166:167], s[62:63]
  v_pk_add_f32 v[168:169], v[168:169], s[62:63]
  v_med3_f32 v166, v166, v170, 1.0
  v_med3_f32 v167, v167, v171, 1.0
  v_med3_f32 v168, v168, v172, 1.0
  v_med3_f32 v169, v169, v173, 1.0
  v_cvt_pk_bf16_f32 v164, v166, v167
  v_cvt_pk_bf16_f32 v165, v168, v169
  v_lshlrev_b32 v166, 16, v164
  v_and_b32 v167, 0xffff0000, v164
  v_lshlrev_b32 v168, 16, v165
  v_and_b32 v169, 0xffff0000, v165
  v_pk_add_f32 v[166:167], v[166:167], s[64:65]
  v_pk_add_f32 v[168:169], v[168:169], s[64:65]
  v_cvt_pk_bf16_f32 v130, v166, v167
  v_cvt_pk_bf16_f32 v131, v168, v169
  v_cvt_pk_bf16_f32 v132, v72, v73
  v_cvt_pk_bf16_f32 v133, v74, v75
  v_cvt_pk_bf16_f32 v134, v76, v77
  v_cvt_pk_bf16_f32 v135, v78, v79
  v_cvt_pk_bf16_f32 v136, v80, v81
  v_cvt_pk_bf16_f32 v137, v82, v83
  v_cvt_pk_bf16_f32 v138, v84, v85
  v_cvt_pk_bf16_f32 v139, v86, v87
  v_cvt_pk_bf16_f32 v140, v88, v89
  v_cvt_pk_bf16_f32 v141, v90, v91
  v_cvt_pk_bf16_f32 v142, v92, v93
  v_cvt_pk_bf16_f32 v143, v94, v95
  v_cvt_pk_bf16_f32 v144, v96, v97
  v_cvt_pk_bf16_f32 v145, v98, v99
  v_cvt_pk_bf16_f32 v146, v100, v101
  v_cvt_pk_bf16_f32 v147, v102, v103
  v_cvt_pk_bf16_f32 v148, v104, v105
  v_cvt_pk_bf16_f32 v149, v106, v107
  v_cvt_pk_bf16_f32 v150, v108, v109
  v_cvt_pk_bf16_f32 v151, v110, v111
  v_mov_b32 v176, 0x3f803f80
  v_mov_b32 v177, 0x3f803f80
  v_mov_b32 v178, 0x3f803f80
  v_mov_b32 v179, 0x3f803f80
  s_nop 1
  v_mfma_f32_16x16x32_bf16 v[32:35], v[112:115], v[132:135], 0
  v_mfma_f32_16x16x32_bf16 v[36:39], v[112:115], v[136:139], 0
  v_mfma_f32_16x16x32_bf16 v[40:43], v[116:119], v[132:135], 0
  v_mfma_f32_16x16x32_bf16 v[44:47], v[116:119], v[136:139], 0
  v_mfma_f32_16x16x32_bf16 v[48:51], v[116:119], v[140:143], 0
  v_mfma_f32_16x16x32_bf16 v[52:55], v[120:123], v[136:139], 0
  v_mfma_f32_16x16x32_bf16 v[56:59], v[120:123], v[140:143], 0
  v_mfma_f32_16x16x32_bf16 v[60:63], v[120:123], v[144:147], 0
  v_mfma_f32_16x16x32_bf16 v[64:67], v[124:127], v[140:143], 0
  v_mfma_f32_16x16x32_bf16 v[68:71], v[124:127], v[144:147], 0
  v_mfma_f32_16x16x32_bf16 v[72:75], v[124:127], v[148:151], 0
  v_mfma_f32_16x16x32_bf16 v[76:79], v[128:131], v[144:147], 0
  v_mfma_f32_16x16x32_bf16 v[80:83], v[128:131], v[148:151], 0
  v_mfma_f32_16x16x32_bf16 v[84:87], v[112:115], v[176:179], 0
  v_mfma_f32_16x16x32_bf16 v[88:91], v[116:119], v[176:179], 0
  v_mfma_f32_16x16x32_bf16 v[92:95], v[120:123], v[176:179], 0
  v_mfma_f32_16x16x32_bf16 v[96:99], v[124:127], v[176:179], 0
  v_mfma_f32_16x16x32_bf16 v[100:103], v[128:131], v[176:179], 0
  s_mul_i32 s12, s9, 18432
  s_add_u32 s12, s12, 90112
  v_add_u32 v14, s12, v7
  s_mov_b32 s64, s36
  s_and_b32 s65, s37, 0xffff
  s_mov_b32 s66, 0x100
  s_mov_b32 s67, 0x00020000
  s_lshl_b32 s10, s7, 2
  v_mov_b32 v20, s10
  buffer_load_dword v22, v20, s[64:67], 0 offen sc1
  s_nop 1
  ds_write_b128 v14, v[32:35] offset:0
  ds_write_b128 v14, v[36:39] offset:1024
  ds_write_b128 v14, v[40:43] offset:2048
  ds_write_b128 v14, v[44:47] offset:3072
  ds_write_b128 v14, v[48:51] offset:4096
  ds_write_b128 v14, v[52:55] offset:5120
  ds_write_b128 v14, v[56:59] offset:6144
  ds_write_b128 v14, v[60:63] offset:7168
  ds_write_b128 v14, v[64:67] offset:8192
  ds_write_b128 v14, v[68:71] offset:9216
  ds_write_b128 v14, v[72:75] offset:10240
  ds_write_b128 v14, v[76:79] offset:11264
  ds_write_b128 v14, v[80:83] offset:12288
  ds_write_b128 v14, v[84:87] offset:13312
  ds_write_b128 v14, v[88:91] offset:14336
  ds_write_b128 v14, v[92:95] offset:15360
  ds_write_b128 v14, v[96:99] offset:16384
  ds_write_b128 v14, v[100:103] offset:17408
  s_waitcnt lgkmcnt(0)
  s_barrier
  ds_read_b32 v112, v240 offset:0
  ds_read_b32 v113, v240 offset:18432
  ds_read_b32 v114, v240 offset:36864
  ds_read_b32 v115, v240 offset:55296
  ds_read_b32 v116, v241 offset:0
  ds_read_b32 v117, v241 offset:18432
  ds_read_b32 v118, v241 offset:36864
  ds_read_b32 v119, v241 offset:55296
  ds_read_b32 v120, v242 offset:0
  ds_read_b32 v121, v242 offset:18432
  ds_read_b32 v122, v242 offset:36864
  ds_read_b32 v123, v242 offset:55296
  ds_read_b32 v124, v243 offset:0
  ds_read_b32 v125, v243 offset:18432
  ds_read_b32 v126, v243 offset:36864
  ds_read_b32 v127, v243 offset:55296
  ds_read_b32 v128, v244 offset:0
  ds_read_b32 v129, v244 offset:18432
  ds_read_b32 v130, v244 offset:36864
  ds_read_b32 v131, v244 offset:55296
  ds_read_b32 v132, v245 offset:0
  ds_read_b32 v133, v245 offset:18432
  ds_read_b32 v134, v245 offset:36864
  ds_read_b32 v135, v245 offset:55296
  ds_read_b32 v136, v246 offset:0
  ds_read_b32 v137, v246 offset:18432
  ds_read_b32 v138, v246 offset:36864
  ds_read_b32 v139, v246 offset:55296
  s_waitcnt lgkmcnt(0)
  s_barrier
  s_waitcnt vmcnt(0)
  v_readfirstlane_b32 s72, v22
  s_cmp_ge_u32 s72, 4
  s_cbranch_scc1 fc_zp_done
fc_zp:
  buffer_load_dword v21, v20, s[64:67], 0 offen sc1
  s_waitcnt vmcnt(0)
  v_readfirstlane_b32 s72, v21
  s_cmp_ge_u32 s72, 4
  s_cbranch_scc1 fc_zp_done
  s_sleep 4
  s_branch fc_zp
fc_zp_done:
  v_add_f32 v112, v112, v113
  v_add_f32 v114, v114, v115
  v_add_f32 v112, v112, v114
  buffer_atomic_add_f32 v112, v247, s[48:51], 0 offen sc0 sc1
  v_add_f32 v116, v116, v117
  v_add_f32 v118, v118, v119
  v_add_f32 v116, v116, v118
  buffer_atomic_add_f32 v116, v248, s[48:51], 0 offen sc0 sc1
  v_add_f32 v120, v120, v121
  v_add_f32 v122, v122, v123
  v_add_f32 v120, v120, v122
  buffer_atomic_add_f32 v120, v249, s[48:51], 0 offen sc0 sc1
  v_add_f32 v124, v124, v125
  v_add_f32 v126, v126, v127
  v_add_f32 v124, v124, v126
  buffer_atomic_add_f32 v124, v250, s[48:51], 0 offen sc0 sc1
  v_add_f32 v128, v128, v129
  v_add_f32 v130, v130, v131
  v_add_f32 v128, v128, v130
  buffer_atomic_add_f32 v128, v251, s[48:51], 0 offen sc0 sc1
  v_add_f32 v132, v132, v133
  v_add_f32 v134, v134, v135
  v_add_f32 v132, v132, v134
  buffer_atomic_add_f32 v132, v252, s[48:51], 0 offen sc0 sc1
  v_add_f32 v136, v136, v137
  v_add_f32 v138, v138, v139
  v_add_f32 v136, v136, v138
  s_mov_b64 exec, s[78:79]
  buffer_atomic_add_f32 v136, v253, s[48:51], 0 offen sc0 sc1
  s_mov_b64 exec, -1
  s_lshl_b32 s71, s7, 7
  s_add_u32 s71, s71, 0x11f0400
  s_branch fc_b
fc_h:
  v_lshrrev_b32 v14, 5, v0
  v_mul_u32_u24 v14, 3072, v14
  v_bfe_u32 v15, v0, 2, 3
  v_lshl_add_u32 v14, v15, 7, v14
  v_and_b32 v16, 3, v0
  v_lshl_add_u32 v14, v16, 3, v14
  v_add_u32 v14, 65536, v14
  v_lshrrev_b32 v15, 1, v15
  s_and_b32 s13, s9, 1
  s_mul_i32 s12, s13, 6
  s_add_u32 s12, s12, 0
  s_and_b32 s11, s12, 3
  s_lshr_b32 s12, s12, 2
  s_lshl_b32 s12, s12, 10
  v_xor_b32 v16, s11, v15
  v_lshl_add_u32 v20, v16, 5, v14
  v_add_u32 v20, s12, v20
  v_add_u32 v240, 49152, v20
  s_mul_i32 s12, s13, 6
  s_add_u32 s12, s12, 1
  s_and_b32 s11, s12, 3
  s_lshr_b32 s12, s12, 2
  s_lshl_b32 s12, s12, 10
  v_xor_b32 v16, s11, v15
  v_lshl_add_u32 v21, v16, 5, v14
  v_add_u32 v21, s12, v21
  v_add_u32 v241, 49152, v21
  s_mul_i32 s12, s13, 6
  s_add_u32 s12, s12, 2
  s_and_b32 s11, s12, 3
  s_lshr_b32 s12, s12, 2
  s_lshl_b32 s12, s12, 10
  v_xor_b32 v16, s11, v15
  v_lshl_add_u32 v22, v16, 5, v14
  v_add_u32 v22, s12, v22
  v_add_u32 v242, 49152, v22
  s_mul_i32 s12, s13, 6
  s_add_u32 s12, s12, 3
  s_and_b32 s11, s12, 3
  s_lshr_b32 s12, s12, 2
  s_lshl_b32 s12, s12, 10
  v_xor_b32 v16, s11, v15
  v_lshl_add_u32 v23, v16, 5, v14
  v_add_u32 v23, s12, v23
  v_add_u32 v243, 49152, v23
  s_mul_i32 s12, s13, 6
  s_add_u32 s12, s12, 4
  s_and_b32 s11, s12, 3
  s_lshr_b32 s12, s12, 2
  s_lshl_b32 s12, s12, 10
  v_xor_b32 v16, s11, v15
  v_lshl_add_u32 v24, v16, 5, v14
  v_add_u32 v24, s12, v24
  v_add_u32 v244, 49152, v24
  s_mul_i32 s12, s13, 6
  s_add_u32 s12, s12, 5
  s_and_b32 s11, s12, 3
  s_lshr_b32 s12, s12, 2
  s_lshl_b32 s12, s12, 10
  v_xor_b32 v16, s11, v15
  v_lshl_add_u32 v25, v16, 5, v14
  v_add_u32 v25, s12, v25
  v_add_u32 v245, 49152, v25
  s_lshr_b32 s12, s9, 1
  s_lshl_b32 s12, s12, 13
  v_add_u32 v26, s12, v17
  v_xor_b32 v27, 64, v26
  s_mov_b32 s64, s36
  s_and_b32 s65, s37, 0xffff
  s_mov_b32 s66, 0x100
  s_mov_b32 s67, 0x00020000
  v_mov_b32 v254, 32
  s_barrier
  ds_read_b128 v[176:179], v26 offset:0
  ds_read_b64_tr_b16 v[128:129], v20 offset:0
  ds_read_b64_tr_b16 v[130:131], v20 offset:6144
  ds_read_b128 v[180:183], v26 offset:2048
  ds_read_b64_tr_b16 v[132:133], v21 offset:0
  ds_read_b64_tr_b16 v[134:135], v21 offset:6144
  ds_read_b128 v[184:187], v26 offset:4096
  ds_read_b64_tr_b16 v[136:137], v22 offset:0
  ds_read_b64_tr_b16 v[138:139], v22 offset:6144
  ds_read_b128 v[188:191], v26 offset:6144
  ds_read_b64_tr_b16 v[140:141], v23 offset:0
  ds_read_b64_tr_b16 v[142:143], v23 offset:6144
  ds_read_b64_tr_b16 v[144:145], v24 offset:0
  ds_read_b64_tr_b16 v[146:147], v24 offset:6144
  ds_read_b64_tr_b16 v[148:149], v25 offset:0
  ds_read_b64_tr_b16 v[150:151], v25 offset:6144
  s_barrier
  ds_read_b128 v[192:195], v27 offset:0
  ds_read_b64_tr_b16 v[152:153], v20 offset:12288
  ds_read_b64_tr_b16 v[154:155], v20 offset:18432
  s_waitcnt lgkmcnt(9)
  v_mfma_f32_16x16x32_bf16 v[32:35], v[128:131], v[176:179], 0
  v_mfma_f32_16x16x32_bf16 v[36:39], v[128:131], v[180:183], 0
  v_mfma_f32_16x16x32_bf16 v[40:43], v[128:131], v[184:187], 0
  v_mfma_f32_16x16x32_bf16 v[44:47], v[128:131], v[188:191], 0
  ds_read_b128 v[196:199], v27 offset:2048
  ds_read_b64_tr_b16 v[156:157], v21 offset:12288
  ds_read_b64_tr_b16 v[158:159], v21 offset:18432
  v_mfma_f32_16x16x32_bf16 v[48:51], v[132:135], v[176:179], 0
  v_mfma_f32_16x16x32_bf16 v[52:55], v[132:135], v[180:183], 0
  v_mfma_f32_16x16x32_bf16 v[56:59], v[132:135], v[184:187], 0
  v_mfma_f32_16x16x32_bf16 v[60:63], v[132:135], v[188:191], 0
  ds_read_b128 v[200:203], v27 offset:4096
  ds_read_b64_tr_b16 v[160:161], v22 offset:12288
  ds_read_b64_tr_b16 v[162:163], v22 offset:18432
  v_mfma_f32_16x16x32_bf16 v[64:67], v[136:139], v[176:179], 0
  v_mfma_f32_16x16x32_bf16 v[68:71], v[136:139], v[180:183], 0
  v_mfma_f32_16x16x32_bf16 v[72:75], v[136:139], v[184:187], 0
  v_mfma_f32_16x16x32_bf16 v[76:79], v[136:139], v[188:191], 0
  ds_read_b128 v[204:207], v27 offset:6144
  ds_read_b64_tr_b16 v[164:165], v23 offset:12288
  ds_read_b64_tr_b16 v[166:167], v23 offset:18432
  s_waitcnt lgkmcnt(15)
  v_mfma_f32_16x16x32_bf16 v[80:83], v[140:143], v[176:179], 0
  v_mfma_f32_16x16x32_bf16 v[84:87], v[140:143], v[180:183], 0
  v_mfma_f32_16x16x32_bf16 v[88:91], v[140:143], v[184:187], 0
  v_mfma_f32_16x16x32_bf16 v[92:95], v[140:143], v[188:191], 0
  ds_read_b64_tr_b16 v[168:169], v24 offset:12288
  ds_read_b64_tr_b16 v[170:171], v24 offset:18432
  s_waitcnt lgkmcnt(15)
  v_mfma_f32_16x16x32_bf16 v[96:99], v[144:147], v[176:179], 0
  v_mfma_f32_16x16x32_bf16 v[100:103], v[144:147], v[180:183], 0
  v_mfma_f32_16x16x32_bf16 v[104:107], v[144:147], v[184:187], 0
  v_mfma_f32_16x16x32_bf16 v[108:111], v[144:147], v[188:191], 0
  ds_read_b64_tr_b16 v[172:173], v25 offset:12288
  ds_read_b64_tr_b16 v[174:175], v25 offset:18432
  s_waitcnt lgkmcnt(15)
  v_mfma_f32_16x16x32_bf16 v[112:115], v[148:151], v[176:179], 0
  v_mfma_f32_16x16x32_bf16 v[116:119], v[148:151], v[180:183], 0
  v_mfma_f32_16x16x32_bf16 v[120:123], v[148:151], v[184:187], 0
  v_mfma_f32_16x16x32_bf16 v[124:127], v[148:151], v[188:191], 0
  s_barrier
  ds_read_b128 v[176:179], v26 offset:16384
  ds_read_b64_tr_b16 v[128:129], v20 offset:24576
  ds_read_b64_tr_b16 v[130:131], v20 offset:30720
  s_waitcnt lgkmcnt(9)
  v_mfma_f32_16x16x32_bf16 v[32:35], v[152:155], v[192:195], v[32:35]
  v_mfma_f32_16x16x32_bf16 v[36:39], v[152:155], v[196:199], v[36:39]
  v_mfma_f32_16x16x32_bf16 v[40:43], v[152:155], v[200:203], v[40:43]
  v_mfma_f32_16x16x32_bf16 v[44:47], v[152:155], v[204:207], v[44:47]
  ds_read_b128 v[180:183], v26 offset:18432
  ds_read_b64_tr_b16 v[132:133], v21 offset:24576
  ds_read_b64_tr_b16 v[134:135], v21 offset:30720
  v_mfma_f32_16x16x32_bf16 v[48:51], v[156:159], v[192:195], v[48:51]
  v_mfma_f32_16x16x32_bf16 v[52:55], v[156:159], v[196:199], v[52:55]
  v_mfma_f32_16x16x32_bf16 v[56:59], v[156:159], v[200:203], v[56:59]
  v_mfma_f32_16x16x32_bf16 v[60:63], v[156:159], v[204:207], v[60:63]
  ds_read_b128 v[184:187], v26 offset:20480
  ds_read_b64_tr_b16 v[136:137], v22 offset:24576
  ds_read_b64_tr_b16 v[138:139], v22 offset:30720
  v_mfma_f32_16x16x32_bf16 v[64:67], v[160:163], v[192:195], v[64:67]
  v_mfma_f32_16x16x32_bf16 v[68:71], v[160:163], v[196:199], v[68:71]
  v_mfma_f32_16x16x32_bf16 v[72:75], v[160:163], v[200:203], v[72:75]
  v_mfma_f32_16x16x32_bf16 v[76:79], v[160:163], v[204:207], v[76:79]
  ds_read_b128 v[188:191], v26 offset:22528
  ds_read_b64_tr_b16 v[140:141], v23 offset:24576
  ds_read_b64_tr_b16 v[142:143], v23 offset:30720
  s_waitcnt lgkmcnt(15)
  v_mfma_f32_16x16x32_bf16 v[80:83], v[164:167], v[192:195], v[80:83]
  v_mfma_f32_16x16x32_bf16 v[84:87], v[164:167], v[196:199], v[84:87]
  v_mfma_f32_16x16x32_bf16 v[88:91], v[164:167], v[200:203], v[88:91]
  v_mfma_f32_16x16x32_bf16 v[92:95], v[164:167], v[204:207], v[92:95]
  ds_read_b64_tr_b16 v[144:145], v24 offset:24576
  ds_read_b64_tr_b16 v[146:147], v24 offset:30720
  s_waitcnt lgkmcnt(15)
  v_mfma_f32_16x16x32_bf16 v[96:99], v[168:171], v[192:195], v[96:99]
  v_mfma_f32_16x16x32_bf16 v[100:103], v[168:171], v[196:199], v[100:103]
  v_mfma_f32_16x16x32_bf16 v[104:107], v[168:171], v[200:203], v[104:107]
  v_mfma_f32_16x16x32_bf16 v[108:111], v[168:171], v[204:207], v[108:111]
  ds_read_b64_tr_b16 v[148:149], v25 offset:24576
  ds_read_b64_tr_b16 v[150:151], v25 offset:30720
  s_waitcnt lgkmcnt(15)
  v_mfma_f32_16x16x32_bf16 v[112:115], v[172:175], v[192:195], v[112:115]
  v_mfma_f32_16x16x32_bf16 v[116:119], v[172:175], v[196:199], v[116:119]
  v_mfma_f32_16x16x32_bf16 v[120:123], v[172:175], v[200:203], v[120:123]
  v_mfma_f32_16x16x32_bf16 v[124:127], v[172:175], v[204:207], v[124:127]
  ds_read_b64_tr_b16 v[208:209], v8 offset:0
  ds_read_b64_tr_b16 v[210:211], v8 offset:3072
  ds_read_b64_tr_b16 v[212:213], v9 offset:32
  ds_read_b64_tr_b16 v[214:215], v9 offset:3104
  ds_read_b64_tr_b16 v[216:217], v8 offset:64
  ds_read_b64_tr_b16 v[218:219], v8 offset:3136
  ds_read_b64_tr_b16 v[220:221], v9 offset:96
  ds_read_b64_tr_b16 v[222:223], v9 offset:3168
  ds_read_b64_tr_b16 v[224:225], v8 offset:128
  ds_read_b64_tr_b16 v[226:227], v8 offset:3200
  s_barrier
  ds_read_b128 v[192:195], v27 offset:16384
  ds_read_b64_tr_b16 v[152:153], v20 offset:36864
  ds_read_b64_tr_b16 v[154:155], v20 offset:43008
  s_waitcnt lgkmcnt(15)
  v_mfma_f32_16x16x32_bf16 v[32:35], v[128:131], v[176:179], v[32:35]
  v_mfma_f32_16x16x32_bf16 v[36:39], v[128:131], v[180:183], v[36:39]
  v_mfma_f32_16x16x32_bf16 v[40:43], v[128:131], v[184:187], v[40:43]
  v_mfma_f32_16x16x32_bf16 v[44:47], v[128:131], v[188:191], v[44:47]
  ds_read_b128 v[196:199], v27 offset:18432
  ds_read_b64_tr_b16 v[156:157], v21 offset:36864
  ds_read_b64_tr_b16 v[158:159], v21 offset:43008
  v_mfma_f32_16x16x32_bf16 v[48:51], v[132:135], v[176:179], v[48:51]
  v_mfma_f32_16x16x32_bf16 v[52:55], v[132:135], v[180:183], v[52:55]
  v_mfma_f32_16x16x32_bf16 v[56:59], v[132:135], v[184:187], v[56:59]
  v_mfma_f32_16x16x32_bf16 v[60:63], v[132:135], v[188:191], v[60:63]
  ds_read_b128 v[200:203], v27 offset:20480
  ds_read_b64_tr_b16 v[160:161], v22 offset:36864
  ds_read_b64_tr_b16 v[162:163], v22 offset:43008
  v_mfma_f32_16x16x32_bf16 v[64:67], v[136:139], v[176:179], v[64:67]
  v_mfma_f32_16x16x32_bf16 v[68:71], v[136:139], v[180:183], v[68:71]
  v_mfma_f32_16x16x32_bf16 v[72:75], v[136:139], v[184:187], v[72:75]
  v_mfma_f32_16x16x32_bf16 v[76:79], v[136:139], v[188:191], v[76:79]
  ds_read_b128 v[204:207], v27 offset:22528
  ds_read_b64_tr_b16 v[164:165], v23 offset:36864
  ds_read_b64_tr_b16 v[166:167], v23 offset:43008
  v_mfma_f32_16x16x32_bf16 v[80:83], v[140:143], v[176:179], v[80:83]
  v_mfma_f32_16x16x32_bf16 v[84:87], v[140:143], v[180:183], v[84:87]
  v_mfma_f32_16x16x32_bf16 v[88:91], v[140:143], v[184:187], v[88:91]
  v_mfma_f32_16x16x32_bf16 v[92:95], v[140:143], v[188:191], v[92:95]
  ds_read_b64_tr_b16 v[168:169], v24 offset:36864
  ds_read_b64_tr_b16 v[170:171], v24 offset:43008
  v_mfma_f32_16x16x32_bf16 v[96:99], v[144:147], v[176:179], v[96:99]
  v_mfma_f32_16x16x32_bf16 v[100:103], v[144:147], v[180:183], v[100:103]
  v_mfma_f32_16x16x32_bf16 v[104:107], v[144:147], v[184:187], v[104:107]
  v_mfma_f32_16x16x32_bf16 v[108:111], v[144:147], v[188:191], v[108:111]
  ds_read_b64_tr_b16 v[172:173], v25 offset:36864
  ds_read_b64_tr_b16 v[174:175], v25 offset:43008
  s_waitcnt lgkmcnt(15)
  v_mfma_f32_16x16x32_bf16 v[112:115], v[148:151], v[176:179], v[112:115]
  v_mfma_f32_16x16x32_bf16 v[116:119], v[148:151], v[180:183], v[116:119]
  v_mfma_f32_16x16x32_bf16 v[120:123], v[148:151], v[184:187], v[120:123]
  v_mfma_f32_16x16x32_bf16 v[124:127], v[148:151], v[188:191], v[124:127]
  buffer_load_dword v255, v254, s[64:67], 0 offen sc1
  buffer_store_dwordx4 v[208:211], v10, s[48:51], 0 offen offset:0 sc1
  buffer_store_dwordx4 v[212:215], v10, s[48:51], 0 offen offset:1024 sc1
  buffer_store_dwordx4 v[216:219], v10, s[48:51], 0 offen offset:2048 sc1
  buffer_store_dwordx4 v[220:223], v10, s[48:51], 0 offen offset:3072 sc1
  v_add_u32 v10, 4096, v10
  buffer_store_dwordx4 v[224:227], v10, s[48:51], 0 offen sc1
  s_nop 1
  s_mov_b32 s64, s26
  s_and_b32 s65, s27, 0xffff
  s_mov_b32 s66, 0xc00
  s_mov_b32 s67, 0x00020000
  s_mul_i32 s12, s7, 384
  s_mul_i32 s11, s13, 192
  s_add_u32 s12, s12, s11
  v_lshl_add_u32 v28, v3, 3, s12
  buffer_load_dwordx2 v[228:229], v28, s[64:67], 0 offen offset:0
  buffer_load_dwordx2 v[230:231], v28, s[64:67], 0 offen offset:32
  buffer_load_dwordx2 v[232:233], v28, s[64:67], 0 offen offset:64
  buffer_load_dwordx2 v[234:235], v28, s[64:67], 0 offen offset:96
  buffer_load_dwordx2 v[236:237], v28, s[64:67], 0 offen offset:128
  buffer_load_dwordx2 v[238:239], v28, s[64:67], 0 offen offset:160
  s_barrier
  ds_read_b128 v[176:179], v26 offset:32768
  ds_read_b64_tr_b16 v[128:129], v240 offset:0
  ds_read_b64_tr_b16 v[130:131], v240 offset:6144
  s_waitcnt lgkmcnt(9)
  v_mfma_f32_16x16x32_bf16 v[32:35], v[152:155], v[192:195], v[32:35]
  v_mfma_f32_16x16x32_bf16 v[36:39], v[152:155], v[196:199], v[36:39]
  v_mfma_f32_16x16x32_bf16 v[40:43], v[152:155], v[200:203], v[40:43]
  v_mfma_f32_16x16x32_bf16 v[44:47], v[152:155], v[204:207], v[44:47]
  ds_read_b128 v[180:183], v26 offset:34816
  ds_read_b64_tr_b16 v[132:133], v241 offset:0
  ds_read_b64_tr_b16 v[134:135], v241 offset:6144
  v_mfma_f32_16x16x32_bf16 v[48:51], v[156:159], v[192:195], v[48:51]
  v_mfma_f32_16x16x32_bf16 v[52:55], v[156:159], v[196:199], v[52:55]
  v_mfma_f32_16x16x32_bf16 v[56:59], v[156:159], v[200:203], v[56:59]
  v_mfma_f32_16x16x32_bf16 v[60:63], v[156:159], v[204:207], v[60:63]
  ds_read_b128 v[184:187], v26 offset:36864
  ds_read_b64_tr_b16 v[136:137], v242 offset:0
  ds_read_b64_tr_b16 v[138:139], v242 offset:6144
  v_mfma_f32_16x16x32_bf16 v[64:67], v[160:163], v[192:195], v[64:67]
  v_mfma_f32_16x16x32_bf16 v[68:71], v[160:163], v[196:199], v[68:71]
  v_mfma_f32_16x16x32_bf16 v[72:75], v[160:163], v[200:203], v[72:75]
  v_mfma_f32_16x16x32_bf16 v[76:79], v[160:163], v[204:207], v[76:79]
  ds_read_b128 v[188:191], v26 offset:38912
  ds_read_b64_tr_b16 v[140:141], v243 offset:0
  ds_read_b64_tr_b16 v[142:143], v243 offset:6144
  s_waitcnt lgkmcnt(15)
  v_mfma_f32_16x16x32_bf16 v[80:83], v[164:167], v[192:195], v[80:83]
  v_mfma_f32_16x16x32_bf16 v[84:87], v[164:167], v[196:199], v[84:87]
  v_mfma_f32_16x16x32_bf16 v[88:91], v[164:167], v[200:203], v[88:91]
  v_mfma_f32_16x16x32_bf16 v[92:95], v[164:167], v[204:207], v[92:95]
  ds_read_b64_tr_b16 v[144:145], v244 offset:0
  ds_read_b64_tr_b16 v[146:147], v244 offset:6144
  s_waitcnt lgkmcnt(15)
  v_mfma_f32_16x16x32_bf16 v[96:99], v[168:171], v[192:195], v[96:99]
  v_mfma_f32_16x16x32_bf16 v[100:103], v[168:171], v[196:199], v[100:103]
  v_mfma_f32_16x16x32_bf16 v[104:107], v[168:171], v[200:203], v[104:107]
  v_mfma_f32_16x16x32_bf16 v[108:111], v[168:171], v[204:207], v[108:111]
  ds_read_b64_tr_b16 v[148:149], v245 offset:0
  ds_read_b64_tr_b16 v[150:151], v245 offset:6144
  s_waitcnt lgkmcnt(15)
  v_mfma_f32_16x16x32_bf16 v[112:115], v[172:175], v[192:195], v[112:115]
  v_mfma_f32_16x16x32_bf16 v[116:119], v[172:175], v[196:199], v[116:119]
  v_mfma_f32_16x16x32_bf16 v[120:123], v[172:175], v[200:203], v[120:123]
  v_mfma_f32_16x16x32_bf16 v[124:127], v[172:175], v[204:207], v[124:127]
  s_barrier
  ds_read_b128 v[192:195], v27 offset:32768
  ds_read_b64_tr_b16 v[152:153], v240 offset:12288
  ds_read_b64_tr_b16 v[154:155], v240 offset:18432
  s_waitcnt lgkmcnt(9)
  v_mfma_f32_16x16x32_bf16 v[32:35], v[128:131], v[176:179], v[32:35]
  v_mfma_f32_16x16x32_bf16 v[36:39], v[128:131], v[180:183], v[36:39]
  v_mfma_f32_16x16x32_bf16 v[40:43], v[128:131], v[184:187], v[40:43]
  v_mfma_f32_16x16x32_bf16 v[44:47], v[128:131], v[188:191], v[44:47]
  ds_read_b128 v[196:199], v27 offset:34816
  ds_read_b64_tr_b16 v[156:157], v241 offset:12288
  ds_read_b64_tr_b16 v[158:159], v241 offset:18432
  v_mfma_f32_16x16x32_bf16 v[48:51], v[132:135], v[176:179], v[48:51]
  v_mfma_f32_16x16x32_bf16 v[52:55], v[132:135], v[180:183], v[52:55]
  v_mfma_f32_16x16x32_bf16 v[56:59], v[132:135], v[184:187], v[56:59]
  v_mfma_f32_16x16x32_bf16 v[60:63], v[132:135], v[188:191], v[60:63]
  ds_read_b128 v[200:203], v27 offset:36864
  ds_read_b64_tr_b16 v[160:161], v242 offset:12288
  ds_read_b64_tr_b16 v[162:163], v242 offset:18432
  v_mfma_f32_16x16x32_bf16 v[64:67], v[136:139], v[176:179], v[64:67]
  v_mfma_f32_16x16x32_bf16 v[68:71], v[136:139], v[180:183], v[68:71]
  v_mfma_f32_16x16x32_bf16 v[72:75], v[136:139], v[184:187], v[72:75]
  v_mfma_f32_16x16x32_bf16 v[76:79], v[136:139], v[188:191], v[76:79]
  ds_read_b128 v[204:207], v27 offset:38912
  ds_read_b64_tr_b16 v[164:165], v243 offset:12288
  ds_read_b64_tr_b16 v[166:167], v243 offset:18432
  s_waitcnt lgkmcnt(15)
  v_mfma_f32_16x16x32_bf16 v[80:83], v[140:143], v[176:179], v[80:83]
  v_mfma_f32_16x16x32_bf16 v[84:87], v[140:143], v[180:183], v[84:87]
  v_mfma_f32_16x16x32_bf16 v[88:91], v[140:143], v[184:187], v[88:91]
  v_mfma_f32_16x16x32_bf16 v[92:95], v[140:143], v[188:191], v[92:95]
  ds_read_b64_tr_b16 v[168:169], v244 offset:12288
  ds_read_b64_tr_b16 v[170:171], v244 offset:18432
  s_waitcnt lgkmcnt(15)
  v_mfma_f32_16x16x32_bf16 v[96:99], v[144:147], v[176:179], v[96:99]
  v_mfma_f32_16x16x32_bf16 v[100:103], v[144:147], v[180:183], v[100:103]
  v_mfma_f32_16x16x32_bf16 v[104:107], v[144:147], v[184:187], v[104:107]
  v_mfma_f32_16x16x32_bf16 v[108:111], v[144:147], v[188:191], v[108:111]
  ds_read_b64_tr_b16 v[172:173], v245 offset:12288
  ds_read_b64_tr_b16 v[174:175], v245 offset:18432
  s_waitcnt lgkmcnt(15)
  v_mfma_f32_16x16x32_bf16 v[112:115], v[148:151], v[176:179], v[112:115]
  v_mfma_f32_16x16x32_bf16 v[116:119], v[148:151], v[180:183], v[116:119]
  v_mfma_f32_16x16x32_bf16 v[120:123], v[148:151], v[184:187], v[120:123]
  v_mfma_f32_16x16x32_bf16 v[124:127], v[148:151], v[188:191], v[124:127]
  s_barrier
  ds_read_b128 v[176:179], v26 offset:49152
  ds_read_b64_tr_b16 v[128:129], v240 offset:24576
  ds_read_b64_tr_b16 v[130:131], v240 offset:30720
  s_waitcnt lgkmcnt(9)
  v_mfma_f32_16x16x32_bf16 v[32:35], v[152:155], v[192:195], v[32:35]
  v_mfma_f32_16x16x32_bf16 v[36:39], v[152:155], v[196:199], v[36:39]
  v_mfma_f32_16x16x32_bf16 v[40:43], v[152:155], v[200:203], v[40:43]
  v_mfma_f32_16x16x32_bf16 v[44:47], v[152:155], v[204:207], v[44:47]
  ds_read_b128 v[180:183], v26 offset:51200
  ds_read_b64_tr_b16 v[132:133], v241 offset:24576
  ds_read_b64_tr_b16 v[134:135], v241 offset:30720
  v_mfma_f32_16x16x32_bf16 v[48:51], v[156:159], v[192:195], v[48:51]
  v_mfma_f32_16x16x32_bf16 v[52:55], v[156:159], v[196:199], v[52:55]
  v_mfma_f32_16x16x32_bf16 v[56:59], v[156:159], v[200:203], v[56:59]
  v_mfma_f32_16x16x32_bf16 v[60:63], v[156:159], v[204:207], v[60:63]
  ds_read_b128 v[184:187], v26 offset:53248
  ds_read_b64_tr_b16 v[136:137], v242 offset:24576
  ds_read_b64_tr_b16 v[138:139], v242 offset:30720
  v_mfma_f32_16x16x32_bf16 v[64:67], v[160:163], v[192:195], v[64:67]
  v_mfma_f32_16x16x32_bf16 v[68:71], v[160:163], v[196:199], v[68:71]
  v_mfma_f32_16x16x32_bf16 v[72:75], v[160:163], v[200:203], v[72:75]
  v_mfma_f32_16x16x32_bf16 v[76:79], v[160:163], v[204:207], v[76:79]
  ds_read_b128 v[188:191], v26 offset:55296
  ds_read_b64_tr_b16 v[140:141], v243 offset:24576
  ds_read_b64_tr_b16 v[142:143], v243 offset:30720
  s_waitcnt lgkmcnt(15)
  v_mfma_f32_16x16x32_bf16 v[80:83], v[164:167], v[192:195], v[80:83]
  v_mfma_f32_16x16x32_bf16 v[84:87], v[164:167], v[196:199], v[84:87]
  v_mfma_f32_16x16x32_bf16 v[88:91], v[164:167], v[200:203], v[88:91]
  v_mfma_f32_16x16x32_bf16 v[92:95], v[164:167], v[204:207], v[92:95]
  ds_read_b64_tr_b16 v[144:145], v244 offset:24576
  ds_read_b64_tr_b16 v[146:147], v244 offset:30720
  s_waitcnt lgkmcnt(15)
  v_mfma_f32_16x16x32_bf16 v[96:99], v[168:171], v[192:195], v[96:99]
  v_mfma_f32_16x16x32_bf16 v[100:103], v[168:171], v[196:199], v[100:103]
  v_mfma_f32_16x16x32_bf16 v[104:107], v[168:171], v[200:203], v[104:107]
  v_mfma_f32_16x16x32_bf16 v[108:111], v[168:171], v[204:207], v[108:111]
  ds_read_b64_tr_b16 v[148:149], v245 offset:24576
  ds_read_b64_tr_b16 v[150:151], v245 offset:30720
  s_waitcnt lgkmcnt(15)
  v_mfma_f32_16x16x32_bf16 v[112:115], v[172:175], v[192:195], v[112:115]
  v_mfma_f32_16x16x32_bf16 v[116:119], v[172:175], v[196:199], v[116:119]
  v_mfma_f32_16x16x32_bf16 v[120:123], v[172:175], v[200:203], v[120:123]
  v_mfma_f32_16x16x32_bf16 v[124:127], v[172:175], v[204:207], v[124:127]
  s_barrier
  ds_read_b128 v[192:195], v27 offset:49152
  ds_read_b64_tr_b16 v[152:153], v240 offset:36864
  ds_read_b64_tr_b16 v[154:155], v240 offset:43008
  s_waitcnt lgkmcnt(9)
  v_mfma_f32_16x16x32_bf16 v[32:35], v[128:131], v[176:179], v[32:35]
  v_mfma_f32_16x16x32_bf16 v[36:39], v[128:131], v[180:183], v[36:39]
  v_mfma_f32_16x16x32_bf16 v[40:43], v[128:131], v[184:187], v[40:43]
  v_mfma_f32_16x16x32_bf16 v[44:47], v[128:131], v[188:191], v[44:47]
  ds_read_b128 v[196:199], v27 offset:51200
  ds_read_b64_tr_b16 v[156:157], v241 offset:36864
  ds_read_b64_tr_b16 v[158:159], v241 offset:43008
  v_mfma_f32_16x16x32_bf16 v[48:51], v[132:135], v[176:179], v[48:51]
  v_mfma_f32_16x16x32_bf16 v[52:55], v[132:135], v[180:183], v[52:55]
  v_mfma_f32_16x16x32_bf16 v[56:59], v[132:135], v[184:187], v[56:59]
  v_mfma_f32_16x16x32_bf16 v[60:63], v[132:135], v[188:191], v[60:63]
  ds_read_b128 v[200:203], v27 offset:53248
  ds_read_b64_tr_b16 v[160:161], v242 offset:36864
  ds_read_b64_tr_b16 v[162:163], v242 offset:43008
  v_mfma_f32_16x16x32_bf16 v[64:67], v[136:139], v[176:179], v[64:67]
  v_mfma_f32_16x16x32_bf16 v[68:71], v[136:139], v[180:183], v[68:71]
  v_mfma_f32_16x16x32_bf16 v[72:75], v[136:139], v[184:187], v[72:75]
  v_mfma_f32_16x16x32_bf16 v[76:79], v[136:139], v[188:191], v[76:79]
  ds_read_b128 v[204:207], v27 offset:55296
  ds_read_b64_tr_b16 v[164:165], v243 offset:36864
  ds_read_b64_tr_b16 v[166:167], v243 offset:43008
  s_waitcnt lgkmcnt(15)
  v_mfma_f32_16x16x32_bf16 v[80:83], v[140:143], v[176:179], v[80:83]
  v_mfma_f32_16x16x32_bf16 v[84:87], v[140:143], v[180:183], v[84:87]
  v_mfma_f32_16x16x32_bf16 v[88:91], v[140:143], v[184:187], v[88:91]
  v_mfma_f32_16x16x32_bf16 v[92:95], v[140:143], v[188:191], v[92:95]
  ds_read_b64_tr_b16 v[168:169], v244 offset:36864
  ds_read_b64_tr_b16 v[170:171], v244 offset:43008
  s_waitcnt lgkmcnt(15)
  v_mfma_f32_16x16x32_bf16 v[96:99], v[144:147], v[176:179], v[96:99]
  v_mfma_f32_16x16x32_bf16 v[100:103], v[144:147], v[180:183], v[100:103]
  v_mfma_f32_16x16x32_bf16 v[104:107], v[144:147], v[184:187], v[104:107]
  v_mfma_f32_16x16x32_bf16 v[108:111], v[144:147], v[188:191], v[108:111]
  ds_read_b64_tr_b16 v[172:173], v245 offset:36864
  ds_read_b64_tr_b16 v[174:175], v245 offset:43008
  s_waitcnt lgkmcnt(15)
  v_mfma_f32_16x16x32_bf16 v[112:115], v[148:151], v[176:179], v[112:115]
  v_mfma_f32_16x16x32_bf16 v[116:119], v[148:151], v[180:183], v[116:119]
  v_mfma_f32_16x16x32_bf16 v[120:123], v[148:151], v[184:187], v[120:123]
  v_mfma_f32_16x16x32_bf16 v[124:127], v[148:151], v[188:191], v[124:127]
  s_waitcnt vmcnt(6)
  s_barrier
  s_cmp_lg_u32 s9, 0
  s_cbranch_scc1 fc_norpTrue
  v_readfirstlane_b32 s72, v255
  s_cmp_ge_u32 s72, 1
  s_cbranch_scc1 fc_norpTrue_p_done
  s_mov_b32 s64, s36
  s_and_b32 s65, s37, 0xffff
  s_mov_b32 s66, 0x100
  s_mov_b32 s67, 0x00020000
fc_norpTrue_p:
  buffer_load_dword v255, v254, s[64:67], 0 offen sc1
  s_waitcnt vmcnt(0)
  v_readfirstlane_b32 s72, v255
  s_cmp_ge_u32 s72, 1
  s_cbranch_scc1 fc_norpTrue_p_done
  s_sleep 4
  s_branch fc_norpTrue_p
fc_norpTrue_p_done:
  s_lshl_b32 s10, s75, 7
  s_add_u32 s10, s10, 0x11f0000
  v_mov_b32 v254, s10
  v_mov_b32 v255, 1
  s_mov_b64 exec, 1
  buffer_atomic_add v255, v254, s[48:51], 0 offen sc1
  s_mov_b64 exec, -1
fc_norpTrue:
  ds_read_b128 v[176:179], v26 offset:0
  ds_read_b64_tr_b16 v[128:129], v20 offset:0
  ds_read_b64_tr_b16 v[130:131], v20 offset:6144
  s_waitcnt lgkmcnt(9)
  v_mfma_f32_16x16x32_bf16 v[32:35], v[152:155], v[192:195], v[32:35]
  v_mfma_f32_16x16x32_bf16 v[36:39], v[152:155], v[196:199], v[36:39]
  v_mfma_f32_16x16x32_bf16 v[40:43], v[152:155], v[200:203], v[40:43]
  v_mfma_f32_16x16x32_bf16 v[44:47], v[152:155], v[204:207], v[44:47]
  ds_read_b128 v[180:183], v26 offset:2048
  ds_read_b64_tr_b16 v[132:133], v21 offset:0
  ds_read_b64_tr_b16 v[134:135], v21 offset:6144
  v_mfma_f32_16x16x32_bf16 v[48:51], v[156:159], v[192:195], v[48:51]
  v_mfma_f32_16x16x32_bf16 v[52:55], v[156:159], v[196:199], v[52:55]
  v_mfma_f32_16x16x32_bf16 v[56:59], v[156:159], v[200:203], v[56:59]
  v_mfma_f32_16x16x32_bf16 v[60:63], v[156:159], v[204:207], v[60:63]
  ds_read_b128 v[184:187], v26 offset:4096
  ds_read_b64_tr_b16 v[136:137], v22 offset:0
  ds_read_b64_tr_b16 v[138:139], v22 offset:6144
  v_mfma_f32_16x16x32_bf16 v[64:67], v[160:163], v[192:195], v[64:67]
  v_mfma_f32_16x16x32_bf16 v[68:71], v[160:163], v[196:199], v[68:71]
  v_mfma_f32_16x16x32_bf16 v[72:75], v[160:163], v[200:203], v[72:75]
  v_mfma_f32_16x16x32_bf16 v[76:79], v[160:163], v[204:207], v[76:79]
  ds_read_b128 v[188:191], v26 offset:6144
  ds_read_b64_tr_b16 v[140:141], v23 offset:0
  ds_read_b64_tr_b16 v[142:143], v23 offset:6144
  s_waitcnt lgkmcnt(15)
  v_mfma_f32_16x16x32_bf16 v[80:83], v[164:167], v[192:195], v[80:83]
  v_mfma_f32_16x16x32_bf16 v[84:87], v[164:167], v[196:199], v[84:87]
  v_mfma_f32_16x16x32_bf16 v[88:91], v[164:167], v[200:203], v[88:91]
  v_mfma_f32_16x16x32_bf16 v[92:95], v[164:167], v[204:207], v[92:95]
  ds_read_b64_tr_b16 v[144:145], v24 offset:0
  ds_read_b64_tr_b16 v[146:147], v24 offset:6144
  s_waitcnt lgkmcnt(15)
  v_mfma_f32_16x16x32_bf16 v[96:99], v[168:171], v[192:195], v[96:99]
  v_mfma_f32_16x16x32_bf16 v[100:103], v[168:171], v[196:199], v[100:103]
  v_mfma_f32_16x16x32_bf16 v[104:107], v[168:171], v[200:203], v[104:107]
  v_mfma_f32_16x16x32_bf16 v[108:111], v[168:171], v[204:207], v[108:111]
  ds_read_b64_tr_b16 v[148:149], v25 offset:0
  ds_read_b64_tr_b16 v[150:151], v25 offset:6144
  s_waitcnt lgkmcnt(15)
  v_mfma_f32_16x16x32_bf16 v[112:115], v[172:175], v[192:195], v[112:115]
  v_mfma_f32_16x16x32_bf16 v[116:119], v[172:175], v[196:199], v[116:119]
  v_mfma_f32_16x16x32_bf16 v[120:123], v[172:175], v[200:203], v[120:123]
  v_mfma_f32_16x16x32_bf16 v[124:127], v[172:175], v[204:207], v[124:127]
  s_barrier
  ds_read_b128 v[192:195], v27 offset:0
  ds_read_b64_tr_b16 v[152:153], v20 offset:12288
  ds_read_b64_tr_b16 v[154:155], v20 offset:18432
  s_waitcnt lgkmcnt(9)
  v_mfma_f32_16x16x32_bf16 v[32:35], v[128:131], v[176:179], v[32:35]
  v_mfma_f32_16x16x32_bf16 v[36:39], v[128:131], v[180:183], v[36:39]
  v_mfma_f32_16x16x32_bf16 v[40:43], v[128:131], v[184:187], v[40:43]
  v_mfma_f32_16x16x32_bf16 v[44:47], v[128:131], v[188:191], v[44:47]
  ds_read_b128 v[196:199], v27 offset:2048
  ds_read_b64_tr_b16 v[156:157], v21 offset:12288
  ds_read_b64_tr_b16 v[158:159], v21 offset:18432
  v_mfma_f32_16x16x32_bf16 v[48:51], v[132:135], v[176:179], v[48:51]
  v_mfma_f32_16x16x32_bf16 v[52:55], v[132:135], v[180:183], v[52:55]
  v_mfma_f32_16x16x32_bf16 v[56:59], v[132:135], v[184:187], v[56:59]
  v_mfma_f32_16x16x32_bf16 v[60:63], v[132:135], v[188:191], v[60:63]
  ds_read_b128 v[200:203], v27 offset:4096
  ds_read_b64_tr_b16 v[160:161], v22 offset:12288
  ds_read_b64_tr_b16 v[162:163], v22 offset:18432
  v_mfma_f32_16x16x32_bf16 v[64:67], v[136:139], v[176:179], v[64:67]
  v_mfma_f32_16x16x32_bf16 v[68:71], v[136:139], v[180:183], v[68:71]
  v_mfma_f32_16x16x32_bf16 v[72:75], v[136:139], v[184:187], v[72:75]
  v_mfma_f32_16x16x32_bf16 v[76:79], v[136:139], v[188:191], v[76:79]
  ds_read_b128 v[204:207], v27 offset:6144
  ds_read_b64_tr_b16 v[164:165], v23 offset:12288
  ds_read_b64_tr_b16 v[166:167], v23 offset:18432
  s_waitcnt lgkmcnt(15)
  v_mfma_f32_16x16x32_bf16 v[80:83], v[140:143], v[176:179], v[80:83]
  v_mfma_f32_16x16x32_bf16 v[84:87], v[140:143], v[180:183], v[84:87]
  v_mfma_f32_16x16x32_bf16 v[88:91], v[140:143], v[184:187], v[88:91]
  v_mfma_f32_16x16x32_bf16 v[92:95], v[140:143], v[188:191], v[92:95]
  ds_read_b64_tr_b16 v[168:169], v24 offset:12288
  ds_read_b64_tr_b16 v[170:171], v24 offset:18432
  s_waitcnt lgkmcnt(15)
  v_mfma_f32_16x16x32_bf16 v[96:99], v[144:147], v[176:179], v[96:99]
  v_mfma_f32_16x16x32_bf16 v[100:103], v[144:147], v[180:183], v[100:103]
  v_mfma_f32_16x16x32_bf16 v[104:107], v[144:147], v[184:187], v[104:107]
  v_mfma_f32_16x16x32_bf16 v[108:111], v[144:147], v[188:191], v[108:111]
  ds_read_b64_tr_b16 v[172:173], v25 offset:12288
  ds_read_b64_tr_b16 v[174:175], v25 offset:18432
  s_waitcnt lgkmcnt(15)
  v_mfma_f32_16x16x32_bf16 v[112:115], v[148:151], v[176:179], v[112:115]
  v_mfma_f32_16x16x32_bf16 v[116:119], v[148:151], v[180:183], v[116:119]
  v_mfma_f32_16x16x32_bf16 v[120:123], v[148:151], v[184:187], v[120:123]
  v_mfma_f32_16x16x32_bf16 v[124:127], v[148:151], v[188:191], v[124:127]
  s_barrier
  ds_read_b128 v[176:179], v26 offset:16384
  ds_read_b64_tr_b16 v[128:129], v20 offset:24576
  ds_read_b64_tr_b16 v[130:131], v20 offset:30720
  s_waitcnt lgkmcnt(9)
  v_mfma_f32_16x16x32_bf16 v[32:35], v[152:155], v[192:195], v[32:35]
  v_mfma_f32_16x16x32_bf16 v[36:39], v[152:155], v[196:199], v[36:39]
  v_mfma_f32_16x16x32_bf16 v[40:43], v[152:155], v[200:203], v[40:43]
  v_mfma_f32_16x16x32_bf16 v[44:47], v[152:155], v[204:207], v[44:47]
  ds_read_b128 v[180:183], v26 offset:18432
  ds_read_b64_tr_b16 v[132:133], v21 offset:24576
  ds_read_b64_tr_b16 v[134:135], v21 offset:30720
  v_mfma_f32_16x16x32_bf16 v[48:51], v[156:159], v[192:195], v[48:51]
  v_mfma_f32_16x16x32_bf16 v[52:55], v[156:159], v[196:199], v[52:55]
  v_mfma_f32_16x16x32_bf16 v[56:59], v[156:159], v[200:203], v[56:59]
  v_mfma_f32_16x16x32_bf16 v[60:63], v[156:159], v[204:207], v[60:63]
  ds_read_b128 v[184:187], v26 offset:20480
  ds_read_b64_tr_b16 v[136:137], v22 offset:24576
  ds_read_b64_tr_b16 v[138:139], v22 offset:30720
  v_mfma_f32_16x16x32_bf16 v[64:67], v[160:163], v[192:195], v[64:67]
  v_mfma_f32_16x16x32_bf16 v[68:71], v[160:163], v[196:199], v[68:71]
  v_mfma_f32_16x16x32_bf16 v[72:75], v[160:163], v[200:203], v[72:75]
  v_mfma_f32_16x16x32_bf16 v[76:79], v[160:163], v[204:207], v[76:79]
  ds_read_b128 v[188:191], v26 offset:22528
  ds_read_b64_tr_b16 v[140:141], v23 offset:24576
  ds_read_b64_tr_b16 v[142:143], v23 offset:30720
  s_waitcnt lgkmcnt(15)
  v_mfma_f32_16x16x32_bf16 v[80:83], v[164:167], v[192:195], v[80:83]
  v_mfma_f32_16x16x32_bf16 v[84:87], v[164:167], v[196:199], v[84:87]
  v_mfma_f32_16x16x32_bf16 v[88:91], v[164:167], v[200:203], v[88:91]
  v_mfma_f32_16x16x32_bf16 v[92:95], v[164:167], v[204:207], v[92:95]
  ds_read_b64_tr_b16 v[144:145], v24 offset:24576
  ds_read_b64_tr_b16 v[146:147], v24 offset:30720
  s_waitcnt lgkmcnt(15)
  v_mfma_f32_16x16x32_bf16 v[96:99], v[168:171], v[192:195], v[96:99]
  v_mfma_f32_16x16x32_bf16 v[100:103], v[168:171], v[196:199], v[100:103]
  v_mfma_f32_16x16x32_bf16 v[104:107], v[168:171], v[200:203], v[104:107]
  v_mfma_f32_16x16x32_bf16 v[108:111], v[168:171], v[204:207], v[108:111]
  ds_read_b64_tr_b16 v[148:149], v25 offset:24576
  ds_read_b64_tr_b16 v[150:151], v25 offset:30720
  s_waitcnt lgkmcnt(15)
  v_mfma_f32_16x16x32_bf16 v[112:115], v[172:175], v[192:195], v[112:115]
  v_mfma_f32_16x16x32_bf16 v[116:119], v[172:175], v[196:199], v[116:119]
  v_mfma_f32_16x16x32_bf16 v[120:123], v[172:175], v[200:203], v[120:123]
  v_mfma_f32_16x16x32_bf16 v[124:127], v[172:175], v[204:207], v[124:127]
  s_barrier
  ds_read_b128 v[192:195], v27 offset:16384
  ds_read_b64_tr_b16 v[152:153], v20 offset:36864
  ds_read_b64_tr_b16 v[154:155], v20 offset:43008
  s_waitcnt lgkmcnt(9)
  v_mfma_f32_16x16x32_bf16 v[32:35], v[128:131], v[176:179], v[32:35]
  v_mfma_f32_16x16x32_bf16 v[36:39], v[128:131], v[180:183], v[36:39]
  v_mfma_f32_16x16x32_bf16 v[40:43], v[128:131], v[184:187], v[40:43]
  v_mfma_f32_16x16x32_bf16 v[44:47], v[128:131], v[188:191], v[44:47]
  ds_read_b128 v[196:199], v27 offset:18432
  ds_read_b64_tr_b16 v[156:157], v21 offset:36864
  ds_read_b64_tr_b16 v[158:159], v21 offset:43008
  v_mfma_f32_16x16x32_bf16 v[48:51], v[132:135], v[176:179], v[48:51]
  v_mfma_f32_16x16x32_bf16 v[52:55], v[132:135], v[180:183], v[52:55]
  v_mfma_f32_16x16x32_bf16 v[56:59], v[132:135], v[184:187], v[56:59]
  v_mfma_f32_16x16x32_bf16 v[60:63], v[132:135], v[188:191], v[60:63]
  ds_read_b128 v[200:203], v27 offset:20480
  ds_read_b64_tr_b16 v[160:161], v22 offset:36864
  ds_read_b64_tr_b16 v[162:163], v22 offset:43008
  v_mfma_f32_16x16x32_bf16 v[64:67], v[136:139], v[176:179], v[64:67]
  v_mfma_f32_16x16x32_bf16 v[68:71], v[136:139], v[180:183], v[68:71]
  v_mfma_f32_16x16x32_bf16 v[72:75], v[136:139], v[184:187], v[72:75]
  v_mfma_f32_16x16x32_bf16 v[76:79], v[136:139], v[188:191], v[76:79]
  ds_read_b128 v[204:207], v27 offset:22528
  ds_read_b64_tr_b16 v[164:165], v23 offset:36864
  ds_read_b64_tr_b16 v[166:167], v23 offset:43008
  s_waitcnt lgkmcnt(15)
  v_mfma_f32_16x16x32_bf16 v[80:83], v[140:143], v[176:179], v[80:83]
  v_mfma_f32_16x16x32_bf16 v[84:87], v[140:143], v[180:183], v[84:87]
  v_mfma_f32_16x16x32_bf16 v[88:91], v[140:143], v[184:187], v[88:91]
  v_mfma_f32_16x16x32_bf16 v[92:95], v[140:143], v[188:191], v[92:95]
  ds_read_b64_tr_b16 v[168:169], v24 offset:36864
  ds_read_b64_tr_b16 v[170:171], v24 offset:43008
  s_waitcnt lgkmcnt(15)
  v_mfma_f32_16x16x32_bf16 v[96:99], v[144:147], v[176:179], v[96:99]
  v_mfma_f32_16x16x32_bf16 v[100:103], v[144:147], v[180:183], v[100:103]
  v_mfma_f32_16x16x32_bf16 v[104:107], v[144:147], v[184:187], v[104:107]
  v_mfma_f32_16x16x32_bf16 v[108:111], v[144:147], v[188:191], v[108:111]
  ds_read_b64_tr_b16 v[172:173], v25 offset:36864
  ds_read_b64_tr_b16 v[174:175], v25 offset:43008
  s_waitcnt lgkmcnt(15)
  v_mfma_f32_16x16x32_bf16 v[112:115], v[148:151], v[176:179], v[112:115]
  v_mfma_f32_16x16x32_bf16 v[116:119], v[148:151], v[180:183], v[116:119]
  v_mfma_f32_16x16x32_bf16 v[120:123], v[148:151], v[184:187], v[120:123]
  v_mfma_f32_16x16x32_bf16 v[124:127], v[148:151], v[188:191], v[124:127]
  s_barrier
  ds_read_b128 v[176:179], v26 offset:32768
  ds_read_b64_tr_b16 v[128:129], v240 offset:0
  ds_read_b64_tr_b16 v[130:131], v240 offset:6144
  s_waitcnt lgkmcnt(9)
  v_mfma_f32_16x16x32_bf16 v[32:35], v[152:155], v[192:195], v[32:35]
  v_mfma_f32_16x16x32_bf16 v[36:39], v[152:155], v[196:199], v[36:39]
  v_mfma_f32_16x16x32_bf16 v[40:43], v[152:155], v[200:203], v[40:43]
  v_mfma_f32_16x16x32_bf16 v[44:47], v[152:155], v[204:207], v[44:47]
  ds_read_b128 v[180:183], v26 offset:34816
  ds_read_b64_tr_b16 v[132:133], v241 offset:0
  ds_read_b64_tr_b16 v[134:135], v241 offset:6144
  v_mfma_f32_16x16x32_bf16 v[48:51], v[156:159], v[192:195], v[48:51]
  v_mfma_f32_16x16x32_bf16 v[52:55], v[156:159], v[196:199], v[52:55]
  v_mfma_f32_16x16x32_bf16 v[56:59], v[156:159], v[200:203], v[56:59]
  v_mfma_f32_16x16x32_bf16 v[60:63], v[156:159], v[204:207], v[60:63]
  ds_read_b128 v[184:187], v26 offset:36864
  ds_read_b64_tr_b16 v[136:137], v242 offset:0
  ds_read_b64_tr_b16 v[138:139], v242 offset:6144
  v_mfma_f32_16x16x32_bf16 v[64:67], v[160:163], v[192:195], v[64:67]
  v_mfma_f32_16x16x32_bf16 v[68:71], v[160:163], v[196:199], v[68:71]
  v_mfma_f32_16x16x32_bf16 v[72:75], v[160:163], v[200:203], v[72:75]
  v_mfma_f32_16x16x32_bf16 v[76:79], v[160:163], v[204:207], v[76:79]
  ds_read_b128 v[188:191], v26 offset:38912
  ds_read_b64_tr_b16 v[140:141], v243 offset:0
  ds_read_b64_tr_b16 v[142:143], v243 offset:6144
  s_waitcnt lgkmcnt(15)
  v_mfma_f32_16x16x32_bf16 v[80:83], v[164:167], v[192:195], v[80:83]
  v_mfma_f32_16x16x32_bf16 v[84:87], v[164:167], v[196:199], v[84:87]
  v_mfma_f32_16x16x32_bf16 v[88:91], v[164:167], v[200:203], v[88:91]
  v_mfma_f32_16x16x32_bf16 v[92:95], v[164:167], v[204:207], v[92:95]
  ds_read_b64_tr_b16 v[144:145], v244 offset:0
  ds_read_b64_tr_b16 v[146:147], v244 offset:6144
  s_waitcnt lgkmcnt(15)
  v_mfma_f32_16x16x32_bf16 v[96:99], v[168:171], v[192:195], v[96:99]
  v_mfma_f32_16x16x32_bf16 v[100:103], v[168:171], v[196:199], v[100:103]
  v_mfma_f32_16x16x32_bf16 v[104:107], v[168:171], v[200:203], v[104:107]
  v_mfma_f32_16x16x32_bf16 v[108:111], v[168:171], v[204:207], v[108:111]
  ds_read_b64_tr_b16 v[148:149], v245 offset:0
  ds_read_b64_tr_b16 v[150:151], v245 offset:6144
  s_waitcnt lgkmcnt(15)
  v_mfma_f32_16x16x32_bf16 v[112:115], v[172:175], v[192:195], v[112:115]
  v_mfma_f32_16x16x32_bf16 v[116:119], v[172:175], v[196:199], v[116:119]
  v_mfma_f32_16x16x32_bf16 v[120:123], v[172:175], v[200:203], v[120:123]
  v_mfma_f32_16x16x32_bf16 v[124:127], v[172:175], v[204:207], v[124:127]
  s_barrier
  ds_read_b128 v[192:195], v27 offset:32768
  ds_read_b64_tr_b16 v[152:153], v240 offset:12288
  ds_read_b64_tr_b16 v[154:155], v240 offset:18432
  s_waitcnt lgkmcnt(9)
  v_mfma_f32_16x16x32_bf16 v[32:35], v[128:131], v[176:179], v[32:35]
  v_mfma_f32_16x16x32_bf16 v[36:39], v[128:131], v[180:183], v[36:39]
  v_mfma_f32_16x16x32_bf16 v[40:43], v[128:131], v[184:187], v[40:43]
  v_mfma_f32_16x16x32_bf16 v[44:47], v[128:131], v[188:191], v[44:47]
  ds_read_b128 v[196:199], v27 offset:34816
  ds_read_b64_tr_b16 v[156:157], v241 offset:12288
  ds_read_b64_tr_b16 v[158:159], v241 offset:18432
  v_mfma_f32_16x16x32_bf16 v[48:51], v[132:135], v[176:179], v[48:51]
  v_mfma_f32_16x16x32_bf16 v[52:55], v[132:135], v[180:183], v[52:55]
  v_mfma_f32_16x16x32_bf16 v[56:59], v[132:135], v[184:187], v[56:59]
  v_mfma_f32_16x16x32_bf16 v[60:63], v[132:135], v[188:191], v[60:63]
  ds_read_b128 v[200:203], v27 offset:36864
  ds_read_b64_tr_b16 v[160:161], v242 offset:12288
  ds_read_b64_tr_b16 v[162:163], v242 offset:18432
  v_mfma_f32_16x16x32_bf16 v[64:67], v[136:139], v[176:179], v[64:67]
  v_mfma_f32_16x16x32_bf16 v[68:71], v[136:139], v[180:183], v[68:71]
  v_mfma_f32_16x16x32_bf16 v[72:75], v[136:139], v[184:187], v[72:75]
  v_mfma_f32_16x16x32_bf16 v[76:79], v[136:139], v[188:191], v[76:79]
  ds_read_b128 v[204:207], v27 offset:38912
  ds_read_b64_tr_b16 v[164:165], v243 offset:12288
  ds_read_b64_tr_b16 v[166:167], v243 offset:18432
  s_waitcnt lgkmcnt(15)
  v_mfma_f32_16x16x32_bf16 v[80:83], v[140:143], v[176:179], v[80:83]
  v_mfma_f32_16x16x32_bf16 v[84:87], v[140:143], v[180:183], v[84:87]
  v_mfma_f32_16x16x32_bf16 v[88:91], v[140:143], v[184:187], v[88:91]
  v_mfma_f32_16x16x32_bf16 v[92:95], v[140:143], v[188:191], v[92:95]
  ds_read_b64_tr_b16 v[168:169], v244 offset:12288
  ds_read_b64_tr_b16 v[170:171], v244 offset:18432
  s_waitcnt lgkmcnt(15)
  v_mfma_f32_16x16x32_bf16 v[96:99], v[144:147], v[176:179], v[96:99]
  v_mfma_f32_16x16x32_bf16 v[100:103], v[144:147], v[180:183], v[100:103]
  v_mfma_f32_16x16x32_bf16 v[104:107], v[144:147], v[184:187], v[104:107]
  v_mfma_f32_16x16x32_bf16 v[108:111], v[144:147], v[188:191], v[108:111]
  ds_read_b64_tr_b16 v[172:173], v245 offset:12288
  ds_read_b64_tr_b16 v[174:175], v245 offset:18432
  s_waitcnt lgkmcnt(15)
  v_mfma_f32_16x16x32_bf16 v[112:115], v[148:151], v[176:179], v[112:115]
  v_mfma_f32_16x16x32_bf16 v[116:119], v[148:151], v[180:183], v[116:119]
  v_mfma_f32_16x16x32_bf16 v[120:123], v[148:151], v[184:187], v[120:123]
  v_mfma_f32_16x16x32_bf16 v[124:127], v[148:151], v[188:191], v[124:127]
  s_barrier
  ds_read_b128 v[176:179], v26 offset:49152
  ds_read_b64_tr_b16 v[128:129], v240 offset:24576
  ds_read_b64_tr_b16 v[130:131], v240 offset:30720
  s_waitcnt lgkmcnt(9)
  v_mfma_f32_16x16x32_bf16 v[32:35], v[152:155], v[192:195], v[32:35]
  v_mfma_f32_16x16x32_bf16 v[36:39], v[152:155], v[196:199], v[36:39]
  v_mfma_f32_16x16x32_bf16 v[40:43], v[152:155], v[200:203], v[40:43]
  v_mfma_f32_16x16x32_bf16 v[44:47], v[152:155], v[204:207], v[44:47]
  ds_read_b128 v[180:183], v26 offset:51200
  ds_read_b64_tr_b16 v[132:133], v241 offset:24576
  ds_read_b64_tr_b16 v[134:135], v241 offset:30720
  v_mfma_f32_16x16x32_bf16 v[48:51], v[156:159], v[192:195], v[48:51]
  v_mfma_f32_16x16x32_bf16 v[52:55], v[156:159], v[196:199], v[52:55]
  v_mfma_f32_16x16x32_bf16 v[56:59], v[156:159], v[200:203], v[56:59]
  v_mfma_f32_16x16x32_bf16 v[60:63], v[156:159], v[204:207], v[60:63]
  ds_read_b128 v[184:187], v26 offset:53248
  ds_read_b64_tr_b16 v[136:137], v242 offset:24576
  ds_read_b64_tr_b16 v[138:139], v242 offset:30720
  v_mfma_f32_16x16x32_bf16 v[64:67], v[160:163], v[192:195], v[64:67]
  v_mfma_f32_16x16x32_bf16 v[68:71], v[160:163], v[196:199], v[68:71]
  v_mfma_f32_16x16x32_bf16 v[72:75], v[160:163], v[200:203], v[72:75]
  v_mfma_f32_16x16x32_bf16 v[76:79], v[160:163], v[204:207], v[76:79]
  ds_read_b128 v[188:191], v26 offset:55296
  ds_read_b64_tr_b16 v[140:141], v243 offset:24576
  ds_read_b64_tr_b16 v[142:143], v243 offset:30720
  s_waitcnt lgkmcnt(15)
  v_mfma_f32_16x16x32_bf16 v[80:83], v[164:167], v[192:195], v[80:83]
  v_mfma_f32_16x16x32_bf16 v[84:87], v[164:167], v[196:199], v[84:87]
  v_mfma_f32_16x16x32_bf16 v[88:91], v[164:167], v[200:203], v[88:91]
  v_mfma_f32_16x16x32_bf16 v[92:95], v[164:167], v[204:207], v[92:95]
  ds_read_b64_tr_b16 v[144:145], v244 offset:24576
  ds_read_b64_tr_b16 v[146:147], v244 offset:30720
  s_waitcnt lgkmcnt(15)
  v_mfma_f32_16x16x32_bf16 v[96:99], v[168:171], v[192:195], v[96:99]
  v_mfma_f32_16x16x32_bf16 v[100:103], v[168:171], v[196:199], v[100:103]
  v_mfma_f32_16x16x32_bf16 v[104:107], v[168:171], v[200:203], v[104:107]
  v_mfma_f32_16x16x32_bf16 v[108:111], v[168:171], v[204:207], v[108:111]
  ds_read_b64_tr_b16 v[148:149], v245 offset:24576
  ds_read_b64_tr_b16 v[150:151], v245 offset:30720
  s_waitcnt lgkmcnt(15)
  v_mfma_f32_16x16x32_bf16 v[112:115], v[172:175], v[192:195], v[112:115]
  v_mfma_f32_16x16x32_bf16 v[116:119], v[172:175], v[196:199], v[116:119]
  v_mfma_f32_16x16x32_bf16 v[120:123], v[172:175], v[200:203], v[120:123]
  v_mfma_f32_16x16x32_bf16 v[124:127], v[172:175], v[204:207], v[124:127]
  s_barrier
  ds_read_b128 v[192:195], v27 offset:49152
  ds_read_b64_tr_b16 v[152:153], v240 offset:36864
  ds_read_b64_tr_b16 v[154:155], v240 offset:43008
  s_waitcnt lgkmcnt(9)
  v_mfma_f32_16x16x32_bf16 v[32:35], v[128:131], v[176:179], v[32:35]
  v_mfma_f32_16x16x32_bf16 v[36:39], v[128:131], v[180:183], v[36:39]
  v_mfma_f32_16x16x32_bf16 v[40:43], v[128:131], v[184:187], v[40:43]
  v_mfma_f32_16x16x32_bf16 v[44:47], v[128:131], v[188:191], v[44:47]
  ds_read_b128 v[196:199], v27 offset:51200
  ds_read_b64_tr_b16 v[156:157], v241 offset:36864
  ds_read_b64_tr_b16 v[158:159], v241 offset:43008
  v_mfma_f32_16x16x32_bf16 v[48:51], v[132:135], v[176:179], v[48:51]
  v_mfma_f32_16x16x32_bf16 v[52:55], v[132:135], v[180:183], v[52:55]
  v_mfma_f32_16x16x32_bf16 v[56:59], v[132:135], v[184:187], v[56:59]
  v_mfma_f32_16x16x32_bf16 v[60:63], v[132:135], v[188:191], v[60:63]
  ds_read_b128 v[200:203], v27 offset:53248
  ds_read_b64_tr_b16 v[160:161], v242 offset:36864
  ds_read_b64_tr_b16 v[162:163], v242 offset:43008
  v_mfma_f32_16x16x32_bf16 v[64:67], v[136:139], v[176:179], v[64:67]
  v_mfma_f32_16x16x32_bf16 v[68:71], v[136:139], v[180:183], v[68:71]
  v_mfma_f32_16x16x32_bf16 v[72:75], v[136:139], v[184:187], v[72:75]
  v_mfma_f32_16x16x32_bf16 v[76:79], v[136:139], v[188:191], v[76:79]
  ds_read_b128 v[204:207], v27 offset:55296
  ds_read_b64_tr_b16 v[164:165], v243 offset:36864
  ds_read_b64_tr_b16 v[166:167], v243 offset:43008
  s_waitcnt lgkmcnt(15)
  v_mfma_f32_16x16x32_bf16 v[80:83], v[140:143], v[176:179], v[80:83]
  v_mfma_f32_16x16x32_bf16 v[84:87], v[140:143], v[180:183], v[84:87]
  v_mfma_f32_16x16x32_bf16 v[88:91], v[140:143], v[184:187], v[88:91]
  v_mfma_f32_16x16x32_bf16 v[92:95], v[140:143], v[188:191], v[92:95]
  ds_read_b64_tr_b16 v[168:169], v244 offset:36864
  ds_read_b64_tr_b16 v[170:171], v244 offset:43008
  s_waitcnt lgkmcnt(15)
  v_mfma_f32_16x16x32_bf16 v[96:99], v[144:147], v[176:179], v[96:99]
  v_mfma_f32_16x16x32_bf16 v[100:103], v[144:147], v[180:183], v[100:103]
  v_mfma_f32_16x16x32_bf16 v[104:107], v[144:147], v[184:187], v[104:107]
  v_mfma_f32_16x16x32_bf16 v[108:111], v[144:147], v[188:191], v[108:111]
  ds_read_b64_tr_b16 v[172:173], v245 offset:36864
  ds_read_b64_tr_b16 v[174:175], v245 offset:43008
  s_waitcnt lgkmcnt(15)
  v_mfma_f32_16x16x32_bf16 v[112:115], v[148:151], v[176:179], v[112:115]
  v_mfma_f32_16x16x32_bf16 v[116:119], v[148:151], v[180:183], v[116:119]
  v_mfma_f32_16x16x32_bf16 v[120:123], v[148:151], v[184:187], v[120:123]
  v_mfma_f32_16x16x32_bf16 v[124:127], v[148:151], v[188:191], v[124:127]
  s_barrier
  ds_read_b128 v[176:179], v26 offset:0
  ds_read_b64_tr_b16 v[128:129], v20 offset:0
  ds_read_b64_tr_b16 v[130:131], v20 offset:6144
  s_waitcnt lgkmcnt(9)
  v_mfma_f32_16x16x32_bf16 v[32:35], v[152:155], v[192:195], v[32:35]
  v_mfma_f32_16x16x32_bf16 v[36:39], v[152:155], v[196:199], v[36:39]
  v_mfma_f32_16x16x32_bf16 v[40:43], v[152:155], v[200:203], v[40:43]
  v_mfma_f32_16x16x32_bf16 v[44:47], v[152:155], v[204:207], v[44:47]
  ds_read_b128 v[180:183], v26 offset:2048
  ds_read_b64_tr_b16 v[132:133], v21 offset:0
  ds_read_b64_tr_b16 v[134:135], v21 offset:6144
  v_mfma_f32_16x16x32_bf16 v[48:51], v[156:159], v[192:195], v[48:51]
  v_mfma_f32_16x16x32_bf16 v[52:55], v[156:159], v[196:199], v[52:55]
  v_mfma_f32_16x16x32_bf16 v[56:59], v[156:159], v[200:203], v[56:59]
  v_mfma_f32_16x16x32_bf16 v[60:63], v[156:159], v[204:207], v[60:63]
  ds_read_b128 v[184:187], v26 offset:4096
  ds_read_b64_tr_b16 v[136:137], v22 offset:0
  ds_read_b64_tr_b16 v[138:139], v22 offset:6144
  v_mfma_f32_16x16x32_bf16 v[64:67], v[160:163], v[192:195], v[64:67]
  v_mfma_f32_16x16x32_bf16 v[68:71], v[160:163], v[196:199], v[68:71]
  v_mfma_f32_16x16x32_bf16 v[72:75], v[160:163], v[200:203], v[72:75]
  v_mfma_f32_16x16x32_bf16 v[76:79], v[160:163], v[204:207], v[76:79]
  ds_read_b128 v[188:191], v26 offset:6144
  ds_read_b64_tr_b16 v[140:141], v23 offset:0
  ds_read_b64_tr_b16 v[142:143], v23 offset:6144
  s_waitcnt lgkmcnt(15)
  v_mfma_f32_16x16x32_bf16 v[80:83], v[164:167], v[192:195], v[80:83]
  v_mfma_f32_16x16x32_bf16 v[84:87], v[164:167], v[196:199], v[84:87]
  v_mfma_f32_16x16x32_bf16 v[88:91], v[164:167], v[200:203], v[88:91]
  v_mfma_f32_16x16x32_bf16 v[92:95], v[164:167], v[204:207], v[92:95]
  ds_read_b64_tr_b16 v[144:145], v24 offset:0
  ds_read_b64_tr_b16 v[146:147], v24 offset:6144
  s_waitcnt lgkmcnt(15)
  v_mfma_f32_16x16x32_bf16 v[96:99], v[168:171], v[192:195], v[96:99]
  v_mfma_f32_16x16x32_bf16 v[100:103], v[168:171], v[196:199], v[100:103]
  v_mfma_f32_16x16x32_bf16 v[104:107], v[168:171], v[200:203], v[104:107]
  v_mfma_f32_16x16x32_bf16 v[108:111], v[168:171], v[204:207], v[108:111]
  ds_read_b64_tr_b16 v[148:149], v25 offset:0
  ds_read_b64_tr_b16 v[150:151], v25 offset:6144
  s_waitcnt lgkmcnt(15)
  v_mfma_f32_16x16x32_bf16 v[112:115], v[172:175], v[192:195], v[112:115]
  v_mfma_f32_16x16x32_bf16 v[116:119], v[172:175], v[196:199], v[116:119]
  v_mfma_f32_16x16x32_bf16 v[120:123], v[172:175], v[200:203], v[120:123]
  v_mfma_f32_16x16x32_bf16 v[124:127], v[172:175], v[204:207], v[124:127]
  s_barrier
  ds_read_b128 v[192:195], v27 offset:0
  ds_read_b64_tr_b16 v[152:153], v20 offset:12288
  ds_read_b64_tr_b16 v[154:155], v20 offset:18432
  s_waitcnt lgkmcnt(9)
  v_mfma_f32_16x16x32_bf16 v[32:35], v[128:131], v[176:179], v[32:35]
  v_mfma_f32_16x16x32_bf16 v[36:39], v[128:131], v[180:183], v[36:39]
  v_mfma_f32_16x16x32_bf16 v[40:43], v[128:131], v[184:187], v[40:43]
  v_mfma_f32_16x16x32_bf16 v[44:47], v[128:131], v[188:191], v[44:47]
  ds_read_b128 v[196:199], v27 offset:2048
  ds_read_b64_tr_b16 v[156:157], v21 offset:12288
  ds_read_b64_tr_b16 v[158:159], v21 offset:18432
  v_mfma_f32_16x16x32_bf16 v[48:51], v[132:135], v[176:179], v[48:51]
  v_mfma_f32_16x16x32_bf16 v[52:55], v[132:135], v[180:183], v[52:55]
  v_mfma_f32_16x16x32_bf16 v[56:59], v[132:135], v[184:187], v[56:59]
  v_mfma_f32_16x16x32_bf16 v[60:63], v[132:135], v[188:191], v[60:63]
  ds_read_b128 v[200:203], v27 offset:4096
  ds_read_b64_tr_b16 v[160:161], v22 offset:12288
  ds_read_b64_tr_b16 v[162:163], v22 offset:18432
  v_mfma_f32_16x16x32_bf16 v[64:67], v[136:139], v[176:179], v[64:67]
  v_mfma_f32_16x16x32_bf16 v[68:71], v[136:139], v[180:183], v[68:71]
  v_mfma_f32_16x16x32_bf16 v[72:75], v[136:139], v[184:187], v[72:75]
  v_mfma_f32_16x16x32_bf16 v[76:79], v[136:139], v[188:191], v[76:79]
  ds_read_b128 v[204:207], v27 offset:6144
  ds_read_b64_tr_b16 v[164:165], v23 offset:12288
  ds_read_b64_tr_b16 v[166:167], v23 offset:18432
  s_waitcnt lgkmcnt(15)
  v_mfma_f32_16x16x32_bf16 v[80:83], v[140:143], v[176:179], v[80:83]
  v_mfma_f32_16x16x32_bf16 v[84:87], v[140:143], v[180:183], v[84:87]
  v_mfma_f32_16x16x32_bf16 v[88:91], v[140:143], v[184:187], v[88:91]
  v_mfma_f32_16x16x32_bf16 v[92:95], v[140:143], v[188:191], v[92:95]
  ds_read_b64_tr_b16 v[168:169], v24 offset:12288
  ds_read_b64_tr_b16 v[170:171], v24 offset:18432
  s_waitcnt lgkmcnt(15)
  v_mfma_f32_16x16x32_bf16 v[96:99], v[144:147], v[176:179], v[96:99]
  v_mfma_f32_16x16x32_bf16 v[100:103], v[144:147], v[180:183], v[100:103]
  v_mfma_f32_16x16x32_bf16 v[104:107], v[144:147], v[184:187], v[104:107]
  v_mfma_f32_16x16x32_bf16 v[108:111], v[144:147], v[188:191], v[108:111]
  ds_read_b64_tr_b16 v[172:173], v25 offset:12288
  ds_read_b64_tr_b16 v[174:175], v25 offset:18432
  s_waitcnt lgkmcnt(15)
  v_mfma_f32_16x16x32_bf16 v[112:115], v[148:151], v[176:179], v[112:115]
  v_mfma_f32_16x16x32_bf16 v[116:119], v[148:151], v[180:183], v[116:119]
  v_mfma_f32_16x16x32_bf16 v[120:123], v[148:151], v[184:187], v[120:123]
  v_mfma_f32_16x16x32_bf16 v[124:127], v[148:151], v[188:191], v[124:127]
  s_barrier
  ds_read_b128 v[176:179], v26 offset:16384
  ds_read_b64_tr_b16 v[128:129], v20 offset:24576
  ds_read_b64_tr_b16 v[130:131], v20 offset:30720
  s_waitcnt lgkmcnt(9)
  v_mfma_f32_16x16x32_bf16 v[32:35], v[152:155], v[192:195], v[32:35]
  v_mfma_f32_16x16x32_bf16 v[36:39], v[152:155], v[196:199], v[36:39]
  v_mfma_f32_16x16x32_bf16 v[40:43], v[152:155], v[200:203], v[40:43]
  v_mfma_f32_16x16x32_bf16 v[44:47], v[152:155], v[204:207], v[44:47]
  ds_read_b128 v[180:183], v26 offset:18432
  ds_read_b64_tr_b16 v[132:133], v21 offset:24576
  ds_read_b64_tr_b16 v[134:135], v21 offset:30720
  v_mfma_f32_16x16x32_bf16 v[48:51], v[156:159], v[192:195], v[48:51]
  v_mfma_f32_16x16x32_bf16 v[52:55], v[156:159], v[196:199], v[52:55]
  v_mfma_f32_16x16x32_bf16 v[56:59], v[156:159], v[200:203], v[56:59]
  v_mfma_f32_16x16x32_bf16 v[60:63], v[156:159], v[204:207], v[60:63]
  ds_read_b128 v[184:187], v26 offset:20480
  ds_read_b64_tr_b16 v[136:137], v22 offset:24576
  ds_read_b64_tr_b16 v[138:139], v22 offset:30720
  v_mfma_f32_16x16x32_bf16 v[64:67], v[160:163], v[192:195], v[64:67]
  v_mfma_f32_16x16x32_bf16 v[68:71], v[160:163], v[196:199], v[68:71]
  v_mfma_f32_16x16x32_bf16 v[72:75], v[160:163], v[200:203], v[72:75]
  v_mfma_f32_16x16x32_bf16 v[76:79], v[160:163], v[204:207], v[76:79]
  ds_read_b128 v[188:191], v26 offset:22528
  ds_read_b64_tr_b16 v[140:141], v23 offset:24576
  ds_read_b64_tr_b16 v[142:143], v23 offset:30720
  s_waitcnt lgkmcnt(15)
  v_mfma_f32_16x16x32_bf16 v[80:83], v[164:167], v[192:195], v[80:83]
  v_mfma_f32_16x16x32_bf16 v[84:87], v[164:167], v[196:199], v[84:87]
  v_mfma_f32_16x16x32_bf16 v[88:91], v[164:167], v[200:203], v[88:91]
  v_mfma_f32_16x16x32_bf16 v[92:95], v[164:167], v[204:207], v[92:95]
  ds_read_b64_tr_b16 v[144:145], v24 offset:24576
  ds_read_b64_tr_b16 v[146:147], v24 offset:30720
  s_waitcnt lgkmcnt(15)
  v_mfma_f32_16x16x32_bf16 v[96:99], v[168:171], v[192:195], v[96:99]
  v_mfma_f32_16x16x32_bf16 v[100:103], v[168:171], v[196:199], v[100:103]
  v_mfma_f32_16x16x32_bf16 v[104:107], v[168:171], v[200:203], v[104:107]
  v_mfma_f32_16x16x32_bf16 v[108:111], v[168:171], v[204:207], v[108:111]
  ds_read_b64_tr_b16 v[148:149], v25 offset:24576
  ds_read_b64_tr_b16 v[150:151], v25 offset:30720
  s_waitcnt lgkmcnt(15)
  v_mfma_f32_16x16x32_bf16 v[112:115], v[172:175], v[192:195], v[112:115]
  v_mfma_f32_16x16x32_bf16 v[116:119], v[172:175], v[196:199], v[116:119]
  v_mfma_f32_16x16x32_bf16 v[120:123], v[172:175], v[200:203], v[120:123]
  v_mfma_f32_16x16x32_bf16 v[124:127], v[172:175], v[204:207], v[124:127]
  s_barrier
  ds_read_b128 v[192:195], v27 offset:16384
  ds_read_b64_tr_b16 v[152:153], v20 offset:36864
  ds_read_b64_tr_b16 v[154:155], v20 offset:43008
  s_waitcnt lgkmcnt(9)
  v_mfma_f32_16x16x32_bf16 v[32:35], v[128:131], v[176:179], v[32:35]
  v_mfma_f32_16x16x32_bf16 v[36:39], v[128:131], v[180:183], v[36:39]
  v_mfma_f32_16x16x32_bf16 v[40:43], v[128:131], v[184:187], v[40:43]
  v_mfma_f32_16x16x32_bf16 v[44:47], v[128:131], v[188:191], v[44:47]
  ds_read_b128 v[196:199], v27 offset:18432
  ds_read_b64_tr_b16 v[156:157], v21 offset:36864
  ds_read_b64_tr_b16 v[158:159], v21 offset:43008
  v_mfma_f32_16x16x32_bf16 v[48:51], v[132:135], v[176:179], v[48:51]
  v_mfma_f32_16x16x32_bf16 v[52:55], v[132:135], v[180:183], v[52:55]
  v_mfma_f32_16x16x32_bf16 v[56:59], v[132:135], v[184:187], v[56:59]
  v_mfma_f32_16x16x32_bf16 v[60:63], v[132:135], v[188:191], v[60:63]
  ds_read_b128 v[200:203], v27 offset:20480
  ds_read_b64_tr_b16 v[160:161], v22 offset:36864
  ds_read_b64_tr_b16 v[162:163], v22 offset:43008
  v_mfma_f32_16x16x32_bf16 v[64:67], v[136:139], v[176:179], v[64:67]
  v_mfma_f32_16x16x32_bf16 v[68:71], v[136:139], v[180:183], v[68:71]
  v_mfma_f32_16x16x32_bf16 v[72:75], v[136:139], v[184:187], v[72:75]
  v_mfma_f32_16x16x32_bf16 v[76:79], v[136:139], v[188:191], v[76:79]
  ds_read_b128 v[204:207], v27 offset:22528
  ds_read_b64_tr_b16 v[164:165], v23 offset:36864
  ds_read_b64_tr_b16 v[166:167], v23 offset:43008
  s_waitcnt lgkmcnt(15)
  v_mfma_f32_16x16x32_bf16 v[80:83], v[140:143], v[176:179], v[80:83]
  v_mfma_f32_16x16x32_bf16 v[84:87], v[140:143], v[180:183], v[84:87]
  v_mfma_f32_16x16x32_bf16 v[88:91], v[140:143], v[184:187], v[88:91]
  v_mfma_f32_16x16x32_bf16 v[92:95], v[140:143], v[188:191], v[92:95]
  ds_read_b64_tr_b16 v[168:169], v24 offset:36864
  ds_read_b64_tr_b16 v[170:171], v24 offset:43008
  s_waitcnt lgkmcnt(15)
  v_mfma_f32_16x16x32_bf16 v[96:99], v[144:147], v[176:179], v[96:99]
  v_mfma_f32_16x16x32_bf16 v[100:103], v[144:147], v[180:183], v[100:103]
  v_mfma_f32_16x16x32_bf16 v[104:107], v[144:147], v[184:187], v[104:107]
  v_mfma_f32_16x16x32_bf16 v[108:111], v[144:147], v[188:191], v[108:111]
  ds_read_b64_tr_b16 v[172:173], v25 offset:36864
  ds_read_b64_tr_b16 v[174:175], v25 offset:43008
  s_waitcnt lgkmcnt(15)
  v_mfma_f32_16x16x32_bf16 v[112:115], v[148:151], v[176:179], v[112:115]
  v_mfma_f32_16x16x32_bf16 v[116:119], v[148:151], v[180:183], v[116:119]
  v_mfma_f32_16x16x32_bf16 v[120:123], v[148:151], v[184:187], v[120:123]
  v_mfma_f32_16x16x32_bf16 v[124:127], v[148:151], v[188:191], v[124:127]
  s_waitcnt lgkmcnt(6)
  v_mfma_f32_16x16x32_bf16 v[32:35], v[152:155], v[192:195], v[32:35]
  v_mfma_f32_16x16x32_bf16 v[36:39], v[152:155], v[196:199], v[36:39]
  v_mfma_f32_16x16x32_bf16 v[40:43], v[152:155], v[200:203], v[40:43]
  v_mfma_f32_16x16x32_bf16 v[44:47], v[152:155], v[204:207], v[44:47]
  v_mfma_f32_16x16x32_bf16 v[48:51], v[156:159], v[192:195], v[48:51]
  v_mfma_f32_16x16x32_bf16 v[52:55], v[156:159], v[196:199], v[52:55]
  v_mfma_f32_16x16x32_bf16 v[56:59], v[156:159], v[200:203], v[56:59]
  v_mfma_f32_16x16x32_bf16 v[60:63], v[156:159], v[204:207], v[60:63]
  v_mfma_f32_16x16x32_bf16 v[64:67], v[160:163], v[192:195], v[64:67]
  v_mfma_f32_16x16x32_bf16 v[68:71], v[160:163], v[196:199], v[68:71]
  v_mfma_f32_16x16x32_bf16 v[72:75], v[160:163], v[200:203], v[72:75]
  v_mfma_f32_16x16x32_bf16 v[76:79], v[160:163], v[204:207], v[76:79]
  s_waitcnt lgkmcnt(4)
  v_mfma_f32_16x16x32_bf16 v[80:83], v[164:167], v[192:195], v[80:83]
  v_mfma_f32_16x16x32_bf16 v[84:87], v[164:167], v[196:199], v[84:87]
  v_mfma_f32_16x16x32_bf16 v[88:91], v[164:167], v[200:203], v[88:91]
  v_mfma_f32_16x16x32_bf16 v[92:95], v[164:167], v[204:207], v[92:95]
  s_waitcnt lgkmcnt(2)
  v_mfma_f32_16x16x32_bf16 v[96:99], v[168:171], v[192:195], v[96:99]
  v_mfma_f32_16x16x32_bf16 v[100:103], v[168:171], v[196:199], v[100:103]
  v_mfma_f32_16x16x32_bf16 v[104:107], v[168:171], v[200:203], v[104:107]
  v_mfma_f32_16x16x32_bf16 v[108:111], v[168:171], v[204:207], v[108:111]
  s_waitcnt lgkmcnt(0)
  v_mfma_f32_16x16x32_bf16 v[112:115], v[172:175], v[192:195], v[112:115]
  v_mfma_f32_16x16x32_bf16 v[116:119], v[172:175], v[196:199], v[116:119]
  v_mfma_f32_16x16x32_bf16 v[120:123], v[172:175], v[200:203], v[120:123]
  v_mfma_f32_16x16x32_bf16 v[124:127], v[172:175], v[204:207], v[124:127]
  s_barrier
  s_lshl_b32 s12, s5, 3
  s_lshr_b32 s11, s9, 1
  s_lshl_b32 s11, s11, 2
  s_add_u32 s12, s12, s11
  s_mul_i32 s12, s12, 69760
  s_mul_i32 s11, s7, 6
  s_mul_i32 s10, s13, 3
  s_add_u32 s11, s11, s10
  s_add_u32 s11, s11, 24
  s_lshl_b32 s11, s11, 10
  s_add_u32 s12, s12, s11
  v_lshrrev_b32 v14, 1, v3
  v_lshl_add_u32 v14, v14, 4, v2
  v_lshlrev_b32 v14, 4, v14
  v_and_b32 v15, 1, v3
  v_lshl_add_u32 v14, v15, 9, v14
  v_add_u32 v8, s12, v14
  s_add_u32 s12, s12, 69760
  v_add_u32 v9, s12, v14
  s_add_u32 s12, s12, 69760
  v_add_u32 v10, s12, v14
  s_add_u32 s12, s12, 69760
  v_add_u32 v11, s12, v14
  s_add_u32 s12, s12, 69760
  s_waitcnt vmcnt(0)
  v_lshlrev_b32 v128, 16, v228
  v_and_b32 v129, 0xffff0000, v228
  v_lshlrev_b32 v130, 16, v229
  v_and_b32 v131, 0xffff0000, v229
  v_lshlrev_b32 v132, 16, v230
  v_and_b32 v133, 0xffff0000, v230
  v_lshlrev_b32 v134, 16, v231
  v_and_b32 v135, 0xffff0000, v231
  v_cvt_pk_bf16_f32 v136, v32, v33
  v_cvt_pk_bf16_f32 v137, v34, v35
  v_lshlrev_b32 v138, 16, v136
  v_and_b32 v139, 0xffff0000, v136
  v_lshlrev_b32 v140, 16, v137
  v_and_b32 v141, 0xffff0000, v137
  v_pk_add_f32 v[138:139], v[138:139], v[128:129]
  v_pk_add_f32 v[140:141], v[140:141], v[130:131]
  v_cvt_pk_bf16_f32 v136, v138, v139
  v_cvt_pk_bf16_f32 v137, v140, v141
  v_pk_max_i16 v136, v136, 0
  v_pk_max_i16 v137, v137, 0
  v_lshlrev_b32 v138, 16, v136
  v_and_b32 v139, 0xffff0000, v136
  v_lshlrev_b32 v140, 16, v137
  v_and_b32 v141, 0xffff0000, v137
  v_pk_mul_f32 v[138:139], v[138:139], v[138:139]
  v_pk_mul_f32 v[140:141], v[140:141], v[140:141]
  v_cvt_pk_bf16_f32 v152, v138, v139
  v_cvt_pk_bf16_f32 v153, v140, v141
  v_cvt_pk_bf16_f32 v144, v48, v49
  v_cvt_pk_bf16_f32 v145, v50, v51
  v_lshlrev_b32 v146, 16, v144
  v_and_b32 v147, 0xffff0000, v144
  v_lshlrev_b32 v148, 16, v145
  v_and_b32 v149, 0xffff0000, v145
  v_pk_add_f32 v[146:147], v[146:147], v[132:133]
  v_pk_add_f32 v[148:149], v[148:149], v[134:135]
  v_cvt_pk_bf16_f32 v144, v146, v147
  v_cvt_pk_bf16_f32 v145, v148, v149
  v_pk_max_i16 v144, v144, 0
  v_pk_max_i16 v145, v145, 0
  v_lshlrev_b32 v146, 16, v144
  v_and_b32 v147, 0xffff0000, v144
  v_lshlrev_b32 v148, 16, v145
  v_and_b32 v149, 0xffff0000, v145
  v_pk_mul_f32 v[146:147], v[146:147], v[146:147]
  v_pk_mul_f32 v[148:149], v[148:149], v[148:149]
  v_cvt_pk_bf16_f32 v154, v146, v147
  v_cvt_pk_bf16_f32 v155, v148, v149
  s_nop 1
  v_permlane16_swap_b32 v152, v154
  v_permlane16_swap_b32 v153, v155
  s_nop 0
  buffer_store_dwordx4 v[152:155], v8, s[48:51], 0 offen offset:0 sc1
  v_cvt_pk_bf16_f32 v136, v36, v37
  v_cvt_pk_bf16_f32 v137, v38, v39
  v_lshlrev_b32 v138, 16, v136
  v_and_b32 v139, 0xffff0000, v136
  v_lshlrev_b32 v140, 16, v137
  v_and_b32 v141, 0xffff0000, v137
  v_pk_add_f32 v[138:139], v[138:139], v[128:129]
  v_pk_add_f32 v[140:141], v[140:141], v[130:131]
  v_cvt_pk_bf16_f32 v136, v138, v139
  v_cvt_pk_bf16_f32 v137, v140, v141
  v_pk_max_i16 v136, v136, 0
  v_pk_max_i16 v137, v137, 0
  v_lshlrev_b32 v138, 16, v136
  v_and_b32 v139, 0xffff0000, v136
  v_lshlrev_b32 v140, 16, v137
  v_and_b32 v141, 0xffff0000, v137
  v_pk_mul_f32 v[138:139], v[138:139], v[138:139]
  v_pk_mul_f32 v[140:141], v[140:141], v[140:141]
  v_cvt_pk_bf16_f32 v156, v138, v139
  v_cvt_pk_bf16_f32 v157, v140, v141
  v_cvt_pk_bf16_f32 v144, v52, v53
  v_cvt_pk_bf16_f32 v145, v54, v55
  v_lshlrev_b32 v146, 16, v144
  v_and_b32 v147, 0xffff0000, v144
  v_lshlrev_b32 v148, 16, v145
  v_and_b32 v149, 0xffff0000, v145
  v_pk_add_f32 v[146:147], v[146:147], v[132:133]
  v_pk_add_f32 v[148:149], v[148:149], v[134:135]
  v_cvt_pk_bf16_f32 v144, v146, v147
  v_cvt_pk_bf16_f32 v145, v148, v149
  v_pk_max_i16 v144, v144, 0
  v_pk_max_i16 v145, v145, 0
  v_lshlrev_b32 v146, 16, v144
  v_and_b32 v147, 0xffff0000, v144
  v_lshlrev_b32 v148, 16, v145
  v_and_b32 v149, 0xffff0000, v145
  v_pk_mul_f32 v[146:147], v[146:147], v[146:147]
  v_pk_mul_f32 v[148:149], v[148:149], v[148:149]
  v_cvt_pk_bf16_f32 v158, v146, v147
  v_cvt_pk_bf16_f32 v159, v148, v149
  s_nop 1
  v_permlane16_swap_b32 v156, v158
  v_permlane16_swap_b32 v157, v159
  s_nop 0
  buffer_store_dwordx4 v[156:159], v9, s[48:51], 0 offen offset:0 sc1
  v_cvt_pk_bf16_f32 v136, v40, v41
  v_cvt_pk_bf16_f32 v137, v42, v43
  v_lshlrev_b32 v138, 16, v136
  v_and_b32 v139, 0xffff0000, v136
  v_lshlrev_b32 v140, 16, v137
  v_and_b32 v141, 0xffff0000, v137
  v_pk_add_f32 v[138:139], v[138:139], v[128:129]
  v_pk_add_f32 v[140:141], v[140:141], v[130:131]
  v_cvt_pk_bf16_f32 v136, v138, v139
  v_cvt_pk_bf16_f32 v137, v140, v141
  v_pk_max_i16 v136, v136, 0
  v_pk_max_i16 v137, v137, 0
  v_lshlrev_b32 v138, 16, v136
  v_and_b32 v139, 0xffff0000, v136
  v_lshlrev_b32 v140, 16, v137
  v_and_b32 v141, 0xffff0000, v137
  v_pk_mul_f32 v[138:139], v[138:139], v[138:139]
  v_pk_mul_f32 v[140:141], v[140:141], v[140:141]
  v_cvt_pk_bf16_f32 v160, v138, v139
  v_cvt_pk_bf16_f32 v161, v140, v141
  v_cvt_pk_bf16_f32 v144, v56, v57
  v_cvt_pk_bf16_f32 v145, v58, v59
  v_lshlrev_b32 v146, 16, v144
  v_and_b32 v147, 0xffff0000, v144
  v_lshlrev_b32 v148, 16, v145
  v_and_b32 v149, 0xffff0000, v145
  v_pk_add_f32 v[146:147], v[146:147], v[132:133]
  v_pk_add_f32 v[148:149], v[148:149], v[134:135]
  v_cvt_pk_bf16_f32 v144, v146, v147
  v_cvt_pk_bf16_f32 v145, v148, v149
  v_pk_max_i16 v144, v144, 0
  v_pk_max_i16 v145, v145, 0
  v_lshlrev_b32 v146, 16, v144
  v_and_b32 v147, 0xffff0000, v144
  v_lshlrev_b32 v148, 16, v145
  v_and_b32 v149, 0xffff0000, v145
  v_pk_mul_f32 v[146:147], v[146:147], v[146:147]
  v_pk_mul_f32 v[148:149], v[148:149], v[148:149]
  v_cvt_pk_bf16_f32 v162, v146, v147
  v_cvt_pk_bf16_f32 v163, v148, v149
  s_nop 1
  v_permlane16_swap_b32 v160, v162
  v_permlane16_swap_b32 v161, v163
  s_nop 0
  buffer_store_dwordx4 v[160:163], v10, s[48:51], 0 offen offset:0 sc1
  v_cvt_pk_bf16_f32 v136, v44, v45
  v_cvt_pk_bf16_f32 v137, v46, v47
  v_lshlrev_b32 v138, 16, v136
  v_and_b32 v139, 0xffff0000, v136
  v_lshlrev_b32 v140, 16, v137
  v_and_b32 v141, 0xffff0000, v137
  v_pk_add_f32 v[138:139], v[138:139], v[128:129]
  v_pk_add_f32 v[140:141], v[140:141], v[130:131]
  v_cvt_pk_bf16_f32 v136, v138, v139
  v_cvt_pk_bf16_f32 v137, v140, v141
  v_pk_max_i16 v136, v136, 0
  v_pk_max_i16 v137, v137, 0
  v_lshlrev_b32 v138, 16, v136
  v_and_b32 v139, 0xffff0000, v136
  v_lshlrev_b32 v140, 16, v137
  v_and_b32 v141, 0xffff0000, v137
  v_pk_mul_f32 v[138:139], v[138:139], v[138:139]
  v_pk_mul_f32 v[140:141], v[140:141], v[140:141]
  v_cvt_pk_bf16_f32 v164, v138, v139
  v_cvt_pk_bf16_f32 v165, v140, v141
  v_cvt_pk_bf16_f32 v144, v60, v61
  v_cvt_pk_bf16_f32 v145, v62, v63
  v_lshlrev_b32 v146, 16, v144
  v_and_b32 v147, 0xffff0000, v144
  v_lshlrev_b32 v148, 16, v145
  v_and_b32 v149, 0xffff0000, v145
  v_pk_add_f32 v[146:147], v[146:147], v[132:133]
  v_pk_add_f32 v[148:149], v[148:149], v[134:135]
  v_cvt_pk_bf16_f32 v144, v146, v147
  v_cvt_pk_bf16_f32 v145, v148, v149
  v_pk_max_i16 v144, v144, 0
  v_pk_max_i16 v145, v145, 0
  v_lshlrev_b32 v146, 16, v144
  v_and_b32 v147, 0xffff0000, v144
  v_lshlrev_b32 v148, 16, v145
  v_and_b32 v149, 0xffff0000, v145
  v_pk_mul_f32 v[146:147], v[146:147], v[146:147]
  v_pk_mul_f32 v[148:149], v[148:149], v[148:149]
  v_cvt_pk_bf16_f32 v166, v146, v147
  v_cvt_pk_bf16_f32 v167, v148, v149
  s_nop 1
  v_permlane16_swap_b32 v164, v166
  v_permlane16_swap_b32 v165, v167
  s_nop 0
  buffer_store_dwordx4 v[164:167], v11, s[48:51], 0 offen offset:0 sc1
  v_lshlrev_b32 v128, 16, v232
  v_and_b32 v129, 0xffff0000, v232
  v_lshlrev_b32 v130, 16, v233
  v_and_b32 v131, 0xffff0000, v233
  v_lshlrev_b32 v132, 16, v234
  v_and_b32 v133, 0xffff0000, v234
  v_lshlrev_b32 v134, 16, v235
  v_and_b32 v135, 0xffff0000, v235
  v_cvt_pk_bf16_f32 v136, v64, v65
  v_cvt_pk_bf16_f32 v137, v66, v67
  v_lshlrev_b32 v138, 16, v136
  v_and_b32 v139, 0xffff0000, v136
  v_lshlrev_b32 v140, 16, v137
  v_and_b32 v141, 0xffff0000, v137
  v_pk_add_f32 v[138:139], v[138:139], v[128:129]
  v_pk_add_f32 v[140:141], v[140:141], v[130:131]
  v_cvt_pk_bf16_f32 v136, v138, v139
  v_cvt_pk_bf16_f32 v137, v140, v141
  v_pk_max_i16 v136, v136, 0
  v_pk_max_i16 v137, v137, 0
  v_lshlrev_b32 v138, 16, v136
  v_and_b32 v139, 0xffff0000, v136
  v_lshlrev_b32 v140, 16, v137
  v_and_b32 v141, 0xffff0000, v137
  v_pk_mul_f32 v[138:139], v[138:139], v[138:139]
  v_pk_mul_f32 v[140:141], v[140:141], v[140:141]
  v_cvt_pk_bf16_f32 v152, v138, v139
  v_cvt_pk_bf16_f32 v153, v140, v141
  v_cvt_pk_bf16_f32 v144, v80, v81
  v_cvt_pk_bf16_f32 v145, v82, v83
  v_lshlrev_b32 v146, 16, v144
  v_and_b32 v147, 0xffff0000, v144
  v_lshlrev_b32 v148, 16, v145
  v_and_b32 v149, 0xffff0000, v145
  v_pk_add_f32 v[146:147], v[146:147], v[132:133]
  v_pk_add_f32 v[148:149], v[148:149], v[134:135]
  v_cvt_pk_bf16_f32 v144, v146, v147
  v_cvt_pk_bf16_f32 v145, v148, v149
  v_pk_max_i16 v144, v144, 0
  v_pk_max_i16 v145, v145, 0
  v_lshlrev_b32 v146, 16, v144
  v_and_b32 v147, 0xffff0000, v144
  v_lshlrev_b32 v148, 16, v145
  v_and_b32 v149, 0xffff0000, v145
  v_pk_mul_f32 v[146:147], v[146:147], v[146:147]
  v_pk_mul_f32 v[148:149], v[148:149], v[148:149]
  v_cvt_pk_bf16_f32 v154, v146, v147
  v_cvt_pk_bf16_f32 v155, v148, v149
  s_nop 1
  v_permlane16_swap_b32 v152, v154
  v_permlane16_swap_b32 v153, v155
  s_nop 0
  buffer_store_dwordx4 v[152:155], v8, s[48:51], 0 offen offset:1024 sc1
  v_cvt_pk_bf16_f32 v136, v68, v69
  v_cvt_pk_bf16_f32 v137, v70, v71
  v_lshlrev_b32 v138, 16, v136
  v_and_b32 v139, 0xffff0000, v136
  v_lshlrev_b32 v140, 16, v137
  v_and_b32 v141, 0xffff0000, v137
  v_pk_add_f32 v[138:139], v[138:139], v[128:129]
  v_pk_add_f32 v[140:141], v[140:141], v[130:131]
  v_cvt_pk_bf16_f32 v136, v138, v139
  v_cvt_pk_bf16_f32 v137, v140, v141
  v_pk_max_i16 v136, v136, 0
  v_pk_max_i16 v137, v137, 0
  v_lshlrev_b32 v138, 16, v136
  v_and_b32 v139, 0xffff0000, v136
  v_lshlrev_b32 v140, 16, v137
  v_and_b32 v141, 0xffff0000, v137
  v_pk_mul_f32 v[138:139], v[138:139], v[138:139]
  v_pk_mul_f32 v[140:141], v[140:141], v[140:141]
  v_cvt_pk_bf16_f32 v156, v138, v139
  v_cvt_pk_bf16_f32 v157, v140, v141
  v_cvt_pk_bf16_f32 v144, v84, v85
  v_cvt_pk_bf16_f32 v145, v86, v87
  v_lshlrev_b32 v146, 16, v144
  v_and_b32 v147, 0xffff0000, v144
  v_lshlrev_b32 v148, 16, v145
  v_and_b32 v149, 0xffff0000, v145
  v_pk_add_f32 v[146:147], v[146:147], v[132:133]
  v_pk_add_f32 v[148:149], v[148:149], v[134:135]
  v_cvt_pk_bf16_f32 v144, v146, v147
  v_cvt_pk_bf16_f32 v145, v148, v149
  v_pk_max_i16 v144, v144, 0
  v_pk_max_i16 v145, v145, 0
  v_lshlrev_b32 v146, 16, v144
  v_and_b32 v147, 0xffff0000, v144
  v_lshlrev_b32 v148, 16, v145
  v_and_b32 v149, 0xffff0000, v145
  v_pk_mul_f32 v[146:147], v[146:147], v[146:147]
  v_pk_mul_f32 v[148:149], v[148:149], v[148:149]
  v_cvt_pk_bf16_f32 v158, v146, v147
  v_cvt_pk_bf16_f32 v159, v148, v149
  s_nop 1
  v_permlane16_swap_b32 v156, v158
  v_permlane16_swap_b32 v157, v159
  s_nop 0
  buffer_store_dwordx4 v[156:159], v9, s[48:51], 0 offen offset:1024 sc1
  v_cvt_pk_bf16_f32 v136, v72, v73
  v_cvt_pk_bf16_f32 v137, v74, v75
  v_lshlrev_b32 v138, 16, v136
  v_and_b32 v139, 0xffff0000, v136
  v_lshlrev_b32 v140, 16, v137
  v_and_b32 v141, 0xffff0000, v137
  v_pk_add_f32 v[138:139], v[138:139], v[128:129]
  v_pk_add_f32 v[140:141], v[140:141], v[130:131]
  v_cvt_pk_bf16_f32 v136, v138, v139
  v_cvt_pk_bf16_f32 v137, v140, v141
  v_pk_max_i16 v136, v136, 0
  v_pk_max_i16 v137, v137, 0
  v_lshlrev_b32 v138, 16, v136
  v_and_b32 v139, 0xffff0000, v136
  v_lshlrev_b32 v140, 16, v137
  v_and_b32 v141, 0xffff0000, v137
  v_pk_mul_f32 v[138:139], v[138:139], v[138:139]
  v_pk_mul_f32 v[140:141], v[140:141], v[140:141]
  v_cvt_pk_bf16_f32 v160, v138, v139
  v_cvt_pk_bf16_f32 v161, v140, v141
  v_cvt_pk_bf16_f32 v144, v88, v89
  v_cvt_pk_bf16_f32 v145, v90, v91
  v_lshlrev_b32 v146, 16, v144
  v_and_b32 v147, 0xffff0000, v144
  v_lshlrev_b32 v148, 16, v145
  v_and_b32 v149, 0xffff0000, v145
  v_pk_add_f32 v[146:147], v[146:147], v[132:133]
  v_pk_add_f32 v[148:149], v[148:149], v[134:135]
  v_cvt_pk_bf16_f32 v144, v146, v147
  v_cvt_pk_bf16_f32 v145, v148, v149
  v_pk_max_i16 v144, v144, 0
  v_pk_max_i16 v145, v145, 0
  v_lshlrev_b32 v146, 16, v144
  v_and_b32 v147, 0xffff0000, v144
  v_lshlrev_b32 v148, 16, v145
  v_and_b32 v149, 0xffff0000, v145
  v_pk_mul_f32 v[146:147], v[146:147], v[146:147]
  v_pk_mul_f32 v[148:149], v[148:149], v[148:149]
  v_cvt_pk_bf16_f32 v162, v146, v147
  v_cvt_pk_bf16_f32 v163, v148, v149
  s_nop 1
  v_permlane16_swap_b32 v160, v162
  v_permlane16_swap_b32 v161, v163
  s_nop 0
  buffer_store_dwordx4 v[160:163], v10, s[48:51], 0 offen offset:1024 sc1
  v_cvt_pk_bf16_f32 v136, v76, v77
  v_cvt_pk_bf16_f32 v137, v78, v79
  v_lshlrev_b32 v138, 16, v136
  v_and_b32 v139, 0xffff0000, v136
  v_lshlrev_b32 v140, 16, v137
  v_and_b32 v141, 0xffff0000, v137
  v_pk_add_f32 v[138:139], v[138:139], v[128:129]
  v_pk_add_f32 v[140:141], v[140:141], v[130:131]
  v_cvt_pk_bf16_f32 v136, v138, v139
  v_cvt_pk_bf16_f32 v137, v140, v141
  v_pk_max_i16 v136, v136, 0
  v_pk_max_i16 v137, v137, 0
  v_lshlrev_b32 v138, 16, v136
  v_and_b32 v139, 0xffff0000, v136
  v_lshlrev_b32 v140, 16, v137
  v_and_b32 v141, 0xffff0000, v137
  v_pk_mul_f32 v[138:139], v[138:139], v[138:139]
  v_pk_mul_f32 v[140:141], v[140:141], v[140:141]
  v_cvt_pk_bf16_f32 v164, v138, v139
  v_cvt_pk_bf16_f32 v165, v140, v141
  v_cvt_pk_bf16_f32 v144, v92, v93
  v_cvt_pk_bf16_f32 v145, v94, v95
  v_lshlrev_b32 v146, 16, v144
  v_and_b32 v147, 0xffff0000, v144
  v_lshlrev_b32 v148, 16, v145
  v_and_b32 v149, 0xffff0000, v145
  v_pk_add_f32 v[146:147], v[146:147], v[132:133]
  v_pk_add_f32 v[148:149], v[148:149], v[134:135]
  v_cvt_pk_bf16_f32 v144, v146, v147
  v_cvt_pk_bf16_f32 v145, v148, v149
  v_pk_max_i16 v144, v144, 0
  v_pk_max_i16 v145, v145, 0
  v_lshlrev_b32 v146, 16, v144
  v_and_b32 v147, 0xffff0000, v144
  v_lshlrev_b32 v148, 16, v145
  v_and_b32 v149, 0xffff0000, v145
  v_pk_mul_f32 v[146:147], v[146:147], v[146:147]
  v_pk_mul_f32 v[148:149], v[148:149], v[148:149]
  v_cvt_pk_bf16_f32 v166, v146, v147
  v_cvt_pk_bf16_f32 v167, v148, v149
  s_nop 1
  v_permlane16_swap_b32 v164, v166
  v_permlane16_swap_b32 v165, v167
  s_nop 0
  buffer_store_dwordx4 v[164:167], v11, s[48:51], 0 offen offset:1024 sc1
  v_lshlrev_b32 v128, 16, v236
  v_and_b32 v129, 0xffff0000, v236
  v_lshlrev_b32 v130, 16, v237
  v_and_b32 v131, 0xffff0000, v237
  v_lshlrev_b32 v132, 16, v238
  v_and_b32 v133, 0xffff0000, v238
  v_lshlrev_b32 v134, 16, v239
  v_and_b32 v135, 0xffff0000, v239
  v_cvt_pk_bf16_f32 v136, v96, v97
  v_cvt_pk_bf16_f32 v137, v98, v99
  v_lshlrev_b32 v138, 16, v136
  v_and_b32 v139, 0xffff0000, v136
  v_lshlrev_b32 v140, 16, v137
  v_and_b32 v141, 0xffff0000, v137
  v_pk_add_f32 v[138:139], v[138:139], v[128:129]
  v_pk_add_f32 v[140:141], v[140:141], v[130:131]
  v_cvt_pk_bf16_f32 v136, v138, v139
  v_cvt_pk_bf16_f32 v137, v140, v141
  v_pk_max_i16 v136, v136, 0
  v_pk_max_i16 v137, v137, 0
  v_lshlrev_b32 v138, 16, v136
  v_and_b32 v139, 0xffff0000, v136
  v_lshlrev_b32 v140, 16, v137
  v_and_b32 v141, 0xffff0000, v137
  v_pk_mul_f32 v[138:139], v[138:139], v[138:139]
  v_pk_mul_f32 v[140:141], v[140:141], v[140:141]
  v_cvt_pk_bf16_f32 v152, v138, v139
  v_cvt_pk_bf16_f32 v153, v140, v141
  v_cvt_pk_bf16_f32 v144, v112, v113
  v_cvt_pk_bf16_f32 v145, v114, v115
  v_lshlrev_b32 v146, 16, v144
  v_and_b32 v147, 0xffff0000, v144
  v_lshlrev_b32 v148, 16, v145
  v_and_b32 v149, 0xffff0000, v145
  v_pk_add_f32 v[146:147], v[146:147], v[132:133]
  v_pk_add_f32 v[148:149], v[148:149], v[134:135]
  v_cvt_pk_bf16_f32 v144, v146, v147
  v_cvt_pk_bf16_f32 v145, v148, v149
  v_pk_max_i16 v144, v144, 0
  v_pk_max_i16 v145, v145, 0
  v_lshlrev_b32 v146, 16, v144
  v_and_b32 v147, 0xffff0000, v144
  v_lshlrev_b32 v148, 16, v145
  v_and_b32 v149, 0xffff0000, v145
  v_pk_mul_f32 v[146:147], v[146:147], v[146:147]
  v_pk_mul_f32 v[148:149], v[148:149], v[148:149]
  v_cvt_pk_bf16_f32 v154, v146, v147
  v_cvt_pk_bf16_f32 v155, v148, v149
  s_nop 1
  v_permlane16_swap_b32 v152, v154
  v_permlane16_swap_b32 v153, v155
  s_nop 0
  buffer_store_dwordx4 v[152:155], v8, s[48:51], 0 offen offset:2048 sc1
  v_cvt_pk_bf16_f32 v136, v100, v101
  v_cvt_pk_bf16_f32 v137, v102, v103
  v_lshlrev_b32 v138, 16, v136
  v_and_b32 v139, 0xffff0000, v136
  v_lshlrev_b32 v140, 16, v137
  v_and_b32 v141, 0xffff0000, v137
  v_pk_add_f32 v[138:139], v[138:139], v[128:129]
  v_pk_add_f32 v[140:141], v[140:141], v[130:131]
  v_cvt_pk_bf16_f32 v136, v138, v139
  v_cvt_pk_bf16_f32 v137, v140, v141
  v_pk_max_i16 v136, v136, 0
  v_pk_max_i16 v137, v137, 0
  v_lshlrev_b32 v138, 16, v136
  v_and_b32 v139, 0xffff0000, v136
  v_lshlrev_b32 v140, 16, v137
  v_and_b32 v141, 0xffff0000, v137
  v_pk_mul_f32 v[138:139], v[138:139], v[138:139]
  v_pk_mul_f32 v[140:141], v[140:141], v[140:141]
  v_cvt_pk_bf16_f32 v156, v138, v139
  v_cvt_pk_bf16_f32 v157, v140, v141
  v_cvt_pk_bf16_f32 v144, v116, v117
  v_cvt_pk_bf16_f32 v145, v118, v119
  v_lshlrev_b32 v146, 16, v144
  v_and_b32 v147, 0xffff0000, v144
  v_lshlrev_b32 v148, 16, v145
  v_and_b32 v149, 0xffff0000, v145
  v_pk_add_f32 v[146:147], v[146:147], v[132:133]
  v_pk_add_f32 v[148:149], v[148:149], v[134:135]
  v_cvt_pk_bf16_f32 v144, v146, v147
  v_cvt_pk_bf16_f32 v145, v148, v149
  v_pk_max_i16 v144, v144, 0
  v_pk_max_i16 v145, v145, 0
  v_lshlrev_b32 v146, 16, v144
  v_and_b32 v147, 0xffff0000, v144
  v_lshlrev_b32 v148, 16, v145
  v_and_b32 v149, 0xffff0000, v145
  v_pk_mul_f32 v[146:147], v[146:147], v[146:147]
  v_pk_mul_f32 v[148:149], v[148:149], v[148:149]
  v_cvt_pk_bf16_f32 v158, v146, v147
  v_cvt_pk_bf16_f32 v159, v148, v149
  s_nop 1
  v_permlane16_swap_b32 v156, v158
  v_permlane16_swap_b32 v157, v159
  s_nop 0
  buffer_store_dwordx4 v[156:159], v9, s[48:51], 0 offen offset:2048 sc1
  v_cvt_pk_bf16_f32 v136, v104, v105
  v_cvt_pk_bf16_f32 v137, v106, v107
  v_lshlrev_b32 v138, 16, v136
  v_and_b32 v139, 0xffff0000, v136
  v_lshlrev_b32 v140, 16, v137
  v_and_b32 v141, 0xffff0000, v137
  v_pk_add_f32 v[138:139], v[138:139], v[128:129]
  v_pk_add_f32 v[140:141], v[140:141], v[130:131]
  v_cvt_pk_bf16_f32 v136, v138, v139
  v_cvt_pk_bf16_f32 v137, v140, v141
  v_pk_max_i16 v136, v136, 0
  v_pk_max_i16 v137, v137, 0
  v_lshlrev_b32 v138, 16, v136
  v_and_b32 v139, 0xffff0000, v136
  v_lshlrev_b32 v140, 16, v137
  v_and_b32 v141, 0xffff0000, v137
  v_pk_mul_f32 v[138:139], v[138:139], v[138:139]
  v_pk_mul_f32 v[140:141], v[140:141], v[140:141]
  v_cvt_pk_bf16_f32 v160, v138, v139
  v_cvt_pk_bf16_f32 v161, v140, v141
  v_cvt_pk_bf16_f32 v144, v120, v121
  v_cvt_pk_bf16_f32 v145, v122, v123
  v_lshlrev_b32 v146, 16, v144
  v_and_b32 v147, 0xffff0000, v144
  v_lshlrev_b32 v148, 16, v145
  v_and_b32 v149, 0xffff0000, v145
  v_pk_add_f32 v[146:147], v[146:147], v[132:133]
  v_pk_add_f32 v[148:149], v[148:149], v[134:135]
  v_cvt_pk_bf16_f32 v144, v146, v147
  v_cvt_pk_bf16_f32 v145, v148, v149
  v_pk_max_i16 v144, v144, 0
  v_pk_max_i16 v145, v145, 0
  v_lshlrev_b32 v146, 16, v144
  v_and_b32 v147, 0xffff0000, v144
  v_lshlrev_b32 v148, 16, v145
  v_and_b32 v149, 0xffff0000, v145
  v_pk_mul_f32 v[146:147], v[146:147], v[146:147]
  v_pk_mul_f32 v[148:149], v[148:149], v[148:149]
  v_cvt_pk_bf16_f32 v162, v146, v147
  v_cvt_pk_bf16_f32 v163, v148, v149
  s_nop 1
  v_permlane16_swap_b32 v160, v162
  v_permlane16_swap_b32 v161, v163
  s_nop 0
  buffer_store_dwordx4 v[160:163], v10, s[48:51], 0 offen offset:2048 sc1
  v_cvt_pk_bf16_f32 v136, v108, v109
  v_cvt_pk_bf16_f32 v137, v110, v111
  v_lshlrev_b32 v138, 16, v136
  v_and_b32 v139, 0xffff0000, v136
  v_lshlrev_b32 v140, 16, v137
  v_and_b32 v141, 0xffff0000, v137
  v_pk_add_f32 v[138:139], v[138:139], v[128:129]
  v_pk_add_f32 v[140:141], v[140:141], v[130:131]
  v_cvt_pk_bf16_f32 v136, v138, v139
  v_cvt_pk_bf16_f32 v137, v140, v141
  v_pk_max_i16 v136, v136, 0
  v_pk_max_i16 v137, v137, 0
  v_lshlrev_b32 v138, 16, v136
  v_and_b32 v139, 0xffff0000, v136
  v_lshlrev_b32 v140, 16, v137
  v_and_b32 v141, 0xffff0000, v137
  v_pk_mul_f32 v[138:139], v[138:139], v[138:139]
  v_pk_mul_f32 v[140:141], v[140:141], v[140:141]
  v_cvt_pk_bf16_f32 v164, v138, v139
  v_cvt_pk_bf16_f32 v165, v140, v141
  v_cvt_pk_bf16_f32 v144, v124, v125
  v_cvt_pk_bf16_f32 v145, v126, v127
  v_lshlrev_b32 v146, 16, v144
  v_and_b32 v147, 0xffff0000, v144
  v_lshlrev_b32 v148, 16, v145
  v_and_b32 v149, 0xffff0000, v145
  v_pk_add_f32 v[146:147], v[146:147], v[132:133]
  v_pk_add_f32 v[148:149], v[148:149], v[134:135]
  v_cvt_pk_bf16_f32 v144, v146, v147
  v_cvt_pk_bf16_f32 v145, v148, v149
  v_pk_max_i16 v144, v144, 0
  v_pk_max_i16 v145, v145, 0
  v_lshlrev_b32 v146, 16, v144
  v_and_b32 v147, 0xffff0000, v144
  v_lshlrev_b32 v148, 16, v145
  v_and_b32 v149, 0xffff0000, v145
  v_pk_mul_f32 v[146:147], v[146:147], v[146:147]
  v_pk_mul_f32 v[148:149], v[148:149], v[148:149]
  v_cvt_pk_bf16_f32 v166, v146, v147
  v_cvt_pk_bf16_f32 v167, v148, v149
  s_nop 1
  v_permlane16_swap_b32 v164, v166
  v_permlane16_swap_b32 v165, v167
  s_nop 0
  buffer_store_dwordx4 v[164:167], v11, s[48:51], 0 offen offset:2048 sc1
  s_lshl_b32 s71, s5, 3
  s_add_u32 s71, s71, s7
  s_lshl_b32 s71, s71, 7
  s_add_u32 s71, s71, 0x11f2000
fc_b:
  s_lshl_b32 s10, s74, 2
  s_add_u32 s10, s10, s9
  s_lshl_b32 s11, s10, 4
  v_add_u32 v4, s11, v2
  v_lshlrev_b32 v6, 4, v3
  s_lshl_b32 s12, s9, 10
  s_add_u32 s12, s12, 10240
  v_add_u32 v8, s12, v7
  v_mov_b32 v9, v7
  s_lshl_b32 s12, s9, 11
  s_add_u32 s12, s12, 10240
  v_add_u32 v10, s12, v17
  v_xor_b32 v11, 64, v10
  s_mov_b32 s40, s30
  s_and_b32 s41, s31, 0xffff
  s_mov_b32 s42, 0x500
  s_mov_b32 s43, 0x00020000
  s_mov_b32 s56, s34
  s_and_b32 s57, s35, 0xffff
  s_mov_b32 s58, 0x280000
  s_mov_b32 s59, 0x00020000
  s_mul_i32 s69, s73, 10
  s_lshr_b32 s69, s69, 5
  s_lshl_b32 s70, s69, 7
  s_add_u32 s70, s70, 159744
  v_add_u32 v6, s70, v6
  v_mov_b32 v56, 0
  s_mov_b32 s77, 0
  s_barrier
  ds_read_b128 v[104:107], v10
  ds_read_b128 v[152:155], v6 offset:0
  ds_read_b128 v[64:67], v9 offset:0
  ds_read_b128 v[68:71], v9 offset:1024
  ds_read_b128 v[72:75], v9 offset:2048
  ds_read_b128 v[76:79], v9 offset:3072
  ds_read_b128 v[80:83], v9 offset:4096
  ds_read_b128 v[108:111], v11
  ds_read_b128 v[156:159], v6 offset:64
  ds_read_b128 v[84:87], v9 offset:5120
  s_waitcnt lgkmcnt(7)
  v_mfma_f32_16x16x32_bf16 v[32:35], v[64:67], v[104:107], 0
  ds_read_b128 v[88:91], v9 offset:6144
  s_waitcnt lgkmcnt(7)
  v_mfma_f32_16x16x32_bf16 v[36:39], v[68:71], v[104:107], 0
  ds_read_b128 v[92:95], v9 offset:7168
  s_waitcnt lgkmcnt(7)
  v_mfma_f32_16x16x32_bf16 v[40:43], v[72:75], v[104:107], 0
  v_mfma_f32_16x16x32_bf16 v[52:55], v[152:155], v[104:107], 0
  ds_read_b128 v[96:99], v9 offset:8192
  s_waitcnt lgkmcnt(7)
  v_mfma_f32_16x16x32_bf16 v[44:47], v[76:79], v[104:107], 0
  ds_read_b128 v[100:103], v9 offset:9216
  s_waitcnt lgkmcnt(7)
  v_mfma_f32_16x16x32_bf16 v[48:51], v[80:83], v[104:107], 0
  s_barrier
  v_add_u32 v8, 18432, v8
  v_add_u32 v9, 18432, v9
  v_add_u32 v10, 18432, v10
  v_add_u32 v11, 18432, v11
  s_add_u32 s69, s69, 1
  s_cmp_ge_u32 s69, 10
  s_cselect_b32 s70, -9, 1
  s_cselect_b32 s69, 0, s69
  s_lshl_b32 s70, s70, 7
  v_add_u32 v6, s70, v6
  s_cmp_lg_u32 s77, 0
  s_cbranch_scc1 fc_pub1
  s_getreg_b32 s72, hwreg(HW_REG_IB_STS)
  s_and_b32 s72, s72, 0xc0000f
  s_cbranch_scc1 fc_pub1
  v_mov_b32 v58, s71
  v_mov_b32 v59, 1
  s_mov_b64 exec, 1
  buffer_atomic_add v59, v58, s[48:51], 0 offen sc1
  s_mov_b64 exec, -1
  s_mov_b32 s77, 1
fc_pub1:
  ds_read_b128 v[104:107], v10
  ds_read_b128 v[152:155], v6 offset:0
  ds_read_b128 v[64:67], v9 offset:0
  s_waitcnt lgkmcnt(7)
  v_mfma_f32_16x16x32_bf16 v[32:35], v[84:87], v[108:111], v[32:35]
  ds_read_b128 v[68:71], v9 offset:1024
  s_waitcnt lgkmcnt(7)
  v_mfma_f32_16x16x32_bf16 v[36:39], v[88:91], v[108:111], v[36:39]
  ds_read_b128 v[72:75], v9 offset:2048
  s_waitcnt lgkmcnt(7)
  v_mfma_f32_16x16x32_bf16 v[40:43], v[92:95], v[108:111], v[40:43]
  v_mfma_f32_16x16x32_bf16 v[52:55], v[156:159], v[108:111], v[52:55]
  ds_read_b128 v[76:79], v9 offset:3072
  s_waitcnt lgkmcnt(7)
  v_mfma_f32_16x16x32_bf16 v[44:47], v[96:99], v[108:111], v[44:47]
  ds_read_b128 v[80:83], v9 offset:4096
  s_waitcnt lgkmcnt(7)
  v_mfma_f32_16x16x32_bf16 v[48:51], v[100:103], v[108:111], v[48:51]
  ds_read_b128 v[108:111], v11
  ds_read_b128 v[156:159], v6 offset:64
  ds_read_b128 v[84:87], v9 offset:5120
  s_waitcnt lgkmcnt(7)
  v_mfma_f32_16x16x32_bf16 v[32:35], v[64:67], v[104:107], v[32:35]
  ds_read_b128 v[88:91], v9 offset:6144
  s_waitcnt lgkmcnt(7)
  v_mfma_f32_16x16x32_bf16 v[36:39], v[68:71], v[104:107], v[36:39]
  ds_read_b128 v[92:95], v9 offset:7168
  s_waitcnt lgkmcnt(7)
  v_mfma_f32_16x16x32_bf16 v[40:43], v[72:75], v[104:107], v[40:43]
  v_mfma_f32_16x16x32_bf16 v[52:55], v[152:155], v[104:107], v[52:55]
  ds_read_b128 v[96:99], v9 offset:8192
  s_waitcnt lgkmcnt(7)
  v_mfma_f32_16x16x32_bf16 v[44:47], v[76:79], v[104:107], v[44:47]
  ds_read_b128 v[100:103], v9 offset:9216
  s_waitcnt lgkmcnt(7)
  v_mfma_f32_16x16x32_bf16 v[48:51], v[80:83], v[104:107], v[48:51]
  s_barrier
  v_add_u32 v8, 18432, v8
  v_add_u32 v9, 18432, v9
  v_add_u32 v10, 18432, v10
  v_add_u32 v11, 18432, v11
  s_add_u32 s69, s69, 1
  s_cmp_ge_u32 s69, 10
  s_cselect_b32 s70, -9, 1
  s_cselect_b32 s69, 0, s69
  s_lshl_b32 s70, s70, 7
  v_add_u32 v6, s70, v6
  s_cmp_lg_u32 s77, 0
  s_cbranch_scc1 fc_pub2
  s_getreg_b32 s72, hwreg(HW_REG_IB_STS)
  s_and_b32 s72, s72, 0xc0000f
  s_cbranch_scc1 fc_pub2
  v_mov_b32 v58, s71
  v_mov_b32 v59, 1
  s_mov_b64 exec, 1
  buffer_atomic_add v59, v58, s[48:51], 0 offen sc1
  s_mov_b64 exec, -1
  s_mov_b32 s77, 1
fc_pub2:
  ds_read_b128 v[104:107], v10
  ds_read_b128 v[152:155], v6 offset:0
  ds_read_b128 v[64:67], v9 offset:0
  s_waitcnt lgkmcnt(7)
  v_mfma_f32_16x16x32_bf16 v[32:35], v[84:87], v[108:111], v[32:35]
  ds_read_b128 v[68:71], v9 offset:1024
  s_waitcnt lgkmcnt(7)
  v_mfma_f32_16x16x32_bf16 v[36:39], v[88:91], v[108:111], v[36:39]
  ds_read_b128 v[72:75], v9 offset:2048
  s_waitcnt lgkmcnt(7)
  v_mfma_f32_16x16x32_bf16 v[40:43], v[92:95], v[108:111], v[40:43]
  v_mfma_f32_16x16x32_bf16 v[52:55], v[156:159], v[108:111], v[52:55]
  ds_read_b128 v[76:79], v9 offset:3072
  s_waitcnt lgkmcnt(7)
  v_mfma_f32_16x16x32_bf16 v[44:47], v[96:99], v[108:111], v[44:47]
  ds_read_b128 v[80:83], v9 offset:4096
  s_waitcnt lgkmcnt(7)
  v_mfma_f32_16x16x32_bf16 v[48:51], v[100:103], v[108:111], v[48:51]
  ds_read_b128 v[108:111], v11
  ds_read_b128 v[156:159], v6 offset:64
  ds_read_b128 v[84:87], v9 offset:5120
  s_waitcnt lgkmcnt(7)
  v_mfma_f32_16x16x32_bf16 v[32:35], v[64:67], v[104:107], v[32:35]
  ds_read_b128 v[88:91], v9 offset:6144
  s_waitcnt lgkmcnt(7)
  v_mfma_f32_16x16x32_bf16 v[36:39], v[68:71], v[104:107], v[36:39]
  ds_read_b128 v[92:95], v9 offset:7168
  s_waitcnt lgkmcnt(7)
  v_mfma_f32_16x16x32_bf16 v[40:43], v[72:75], v[104:107], v[40:43]
  v_mfma_f32_16x16x32_bf16 v[52:55], v[152:155], v[104:107], v[52:55]
  ds_read_b128 v[96:99], v9 offset:8192
  s_waitcnt lgkmcnt(7)
  v_mfma_f32_16x16x32_bf16 v[44:47], v[76:79], v[104:107], v[44:47]
  ds_read_b128 v[100:103], v9 offset:9216
  s_waitcnt lgkmcnt(7)
  v_mfma_f32_16x16x32_bf16 v[48:51], v[80:83], v[104:107], v[48:51]
  s_barrier
  v_add_u32 v8, 18432, v8
  v_add_u32 v9, 18432, v9
  v_add_u32 v10, 18432, v10
  v_add_u32 v11, 18432, v11
  s_add_u32 s69, s69, 1
  s_cmp_ge_u32 s69, 10
  s_cselect_b32 s70, -9, 1
  s_cselect_b32 s69, 0, s69
  s_lshl_b32 s70, s70, 7
  v_add_u32 v6, s70, v6
  s_cmp_lg_u32 s77, 0
  s_cbranch_scc1 fc_pub3
  s_getreg_b32 s72, hwreg(HW_REG_IB_STS)
  s_and_b32 s72, s72, 0xc0000f
  s_cbranch_scc1 fc_pub3
  v_mov_b32 v58, s71
  v_mov_b32 v59, 1
  s_mov_b64 exec, 1
  buffer_atomic_add v59, v58, s[48:51], 0 offen sc1
  s_mov_b64 exec, -1
  s_mov_b32 s77, 1
fc_pub3:
  ds_read_b128 v[104:107], v10
  ds_read_b128 v[152:155], v6 offset:0
  ds_read_b128 v[64:67], v9 offset:0
  s_waitcnt lgkmcnt(7)
  v_mfma_f32_16x16x32_bf16 v[32:35], v[84:87], v[108:111], v[32:35]
  ds_read_b128 v[68:71], v9 offset:1024
  s_waitcnt lgkmcnt(7)
  v_mfma_f32_16x16x32_bf16 v[36:39], v[88:91], v[108:111], v[36:39]
  ds_read_b128 v[72:75], v9 offset:2048
  s_waitcnt lgkmcnt(7)
  v_mfma_f32_16x16x32_bf16 v[40:43], v[92:95], v[108:111], v[40:43]
  v_mfma_f32_16x16x32_bf16 v[52:55], v[156:159], v[108:111], v[52:55]
  ds_read_b128 v[76:79], v9 offset:3072
  s_waitcnt lgkmcnt(7)
  v_mfma_f32_16x16x32_bf16 v[44:47], v[96:99], v[108:111], v[44:47]
  ds_read_b128 v[80:83], v9 offset:4096
  s_waitcnt lgkmcnt(7)
  v_mfma_f32_16x16x32_bf16 v[48:51], v[100:103], v[108:111], v[48:51]
  ds_read_b128 v[108:111], v11
  ds_read_b128 v[156:159], v6 offset:64
  ds_read_b128 v[84:87], v9 offset:5120
  s_waitcnt lgkmcnt(7)
  v_mfma_f32_16x16x32_bf16 v[32:35], v[64:67], v[104:107], v[32:35]
  ds_read_b128 v[88:91], v9 offset:6144
  s_waitcnt lgkmcnt(7)
  v_mfma_f32_16x16x32_bf16 v[36:39], v[68:71], v[104:107], v[36:39]
  ds_read_b128 v[92:95], v9 offset:7168
  s_waitcnt lgkmcnt(7)
  v_mfma_f32_16x16x32_bf16 v[40:43], v[72:75], v[104:107], v[40:43]
  v_mfma_f32_16x16x32_bf16 v[52:55], v[152:155], v[104:107], v[52:55]
  ds_read_b128 v[96:99], v9 offset:8192
  s_waitcnt lgkmcnt(7)
  v_mfma_f32_16x16x32_bf16 v[44:47], v[76:79], v[104:107], v[44:47]
  ds_read_b128 v[100:103], v9 offset:9216
  s_waitcnt lgkmcnt(7)
  v_mfma_f32_16x16x32_bf16 v[48:51], v[80:83], v[104:107], v[48:51]
  s_barrier
  v_add_u32 v8, 18432, v8
  v_add_u32 v9, 18432, v9
  v_add_u32 v10, 18432, v10
  v_add_u32 v11, 18432, v11
  s_add_u32 s69, s69, 1
  s_cmp_ge_u32 s69, 10
  s_cselect_b32 s70, -9, 1
  s_cselect_b32 s69, 0, s69
  s_lshl_b32 s70, s70, 7
  v_add_u32 v6, s70, v6
  s_cmp_lg_u32 s77, 0
  s_cbranch_scc1 fc_pub4
  s_getreg_b32 s72, hwreg(HW_REG_IB_STS)
  s_and_b32 s72, s72, 0xc0000f
  s_cbranch_scc1 fc_pub4
  v_mov_b32 v58, s71
  v_mov_b32 v59, 1
  s_mov_b64 exec, 1
  buffer_atomic_add v59, v58, s[48:51], 0 offen sc1
  s_mov_b64 exec, -1
  s_mov_b32 s77, 1
fc_pub4:
  ds_read_b128 v[104:107], v10
  ds_read_b128 v[152:155], v6 offset:0
  ds_read_b128 v[64:67], v9 offset:0
  s_waitcnt lgkmcnt(7)
  v_mfma_f32_16x16x32_bf16 v[32:35], v[84:87], v[108:111], v[32:35]
  ds_read_b128 v[68:71], v9 offset:1024
  s_waitcnt lgkmcnt(7)
  v_mfma_f32_16x16x32_bf16 v[36:39], v[88:91], v[108:111], v[36:39]
  ds_read_b128 v[72:75], v9 offset:2048
  s_waitcnt lgkmcnt(7)
  v_mfma_f32_16x16x32_bf16 v[40:43], v[92:95], v[108:111], v[40:43]
  v_mfma_f32_16x16x32_bf16 v[52:55], v[156:159], v[108:111], v[52:55]
  ds_read_b128 v[76:79], v9 offset:3072
  s_waitcnt lgkmcnt(7)
  v_mfma_f32_16x16x32_bf16 v[44:47], v[96:99], v[108:111], v[44:47]
  ds_read_b128 v[80:83], v9 offset:4096
  s_waitcnt lgkmcnt(7)
  v_mfma_f32_16x16x32_bf16 v[48:51], v[100:103], v[108:111], v[48:51]
  ds_read_b128 v[108:111], v11
  ds_read_b128 v[156:159], v6 offset:64
  ds_read_b128 v[84:87], v9 offset:5120
  s_waitcnt lgkmcnt(7)
  v_mfma_f32_16x16x32_bf16 v[32:35], v[64:67], v[104:107], v[32:35]
  ds_read_b128 v[88:91], v9 offset:6144
  s_waitcnt lgkmcnt(7)
  v_mfma_f32_16x16x32_bf16 v[36:39], v[68:71], v[104:107], v[36:39]
  ds_read_b128 v[92:95], v9 offset:7168
  s_waitcnt lgkmcnt(7)
  v_mfma_f32_16x16x32_bf16 v[40:43], v[72:75], v[104:107], v[40:43]
  v_mfma_f32_16x16x32_bf16 v[52:55], v[152:155], v[104:107], v[52:55]
  ds_read_b128 v[96:99], v9 offset:8192
  s_waitcnt lgkmcnt(7)
  v_mfma_f32_16x16x32_bf16 v[44:47], v[76:79], v[104:107], v[44:47]
  ds_read_b128 v[100:103], v9 offset:9216
  s_waitcnt lgkmcnt(7)
  v_mfma_f32_16x16x32_bf16 v[48:51], v[80:83], v[104:107], v[48:51]
  s_barrier
  v_add_u32 v8, 18432, v8
  v_add_u32 v9, 18432, v9
  v_add_u32 v10, 18432, v10
  v_add_u32 v11, 18432, v11
  s_add_u32 s69, s69, 1
  s_cmp_ge_u32 s69, 10
  s_cselect_b32 s70, -9, 1
  s_cselect_b32 s69, 0, s69
  s_lshl_b32 s70, s70, 7
  v_add_u32 v6, s70, v6
  s_cmp_lg_u32 s77, 0
  s_cbranch_scc1 fc_pub5
  s_waitcnt vmcnt(0)
  v_mov_b32 v58, s71
  v_mov_b32 v59, 1
  s_mov_b64 exec, 1
  buffer_atomic_add v59, v58, s[48:51], 0 offen sc1
  s_mov_b64 exec, -1
  s_mov_b32 s77, 1
fc_pub5:
  ds_read_b128 v[104:107], v10
  ds_read_b128 v[152:155], v6 offset:0
  ds_read_b128 v[64:67], v9 offset:0
  s_waitcnt lgkmcnt(7)
  v_mfma_f32_16x16x32_bf16 v[32:35], v[84:87], v[108:111], v[32:35]
  ds_read_b128 v[68:71], v9 offset:1024
  s_waitcnt lgkmcnt(7)
  v_mfma_f32_16x16x32_bf16 v[36:39], v[88:91], v[108:111], v[36:39]
  ds_read_b128 v[72:75], v9 offset:2048
  s_waitcnt lgkmcnt(7)
  v_mfma_f32_16x16x32_bf16 v[40:43], v[92:95], v[108:111], v[40:43]
  v_mfma_f32_16x16x32_bf16 v[52:55], v[156:159], v[108:111], v[52:55]
  ds_read_b128 v[76:79], v9 offset:3072
  s_waitcnt lgkmcnt(7)
  v_mfma_f32_16x16x32_bf16 v[44:47], v[96:99], v[108:111], v[44:47]
  ds_read_b128 v[80:83], v9 offset:4096
  s_waitcnt lgkmcnt(7)
  v_mfma_f32_16x16x32_bf16 v[48:51], v[100:103], v[108:111], v[48:51]
  ds_read_b128 v[108:111], v11
  ds_read_b128 v[156:159], v6 offset:64
  ds_read_b128 v[84:87], v9 offset:5120
  s_waitcnt lgkmcnt(7)
  v_mfma_f32_16x16x32_bf16 v[32:35], v[64:67], v[104:107], v[32:35]
  ds_read_b128 v[88:91], v9 offset:6144
  s_waitcnt lgkmcnt(7)
  v_mfma_f32_16x16x32_bf16 v[36:39], v[68:71], v[104:107], v[36:39]
  ds_read_b128 v[92:95], v9 offset:7168
  s_waitcnt lgkmcnt(7)
  v_mfma_f32_16x16x32_bf16 v[40:43], v[72:75], v[104:107], v[40:43]
  v_mfma_f32_16x16x32_bf16 v[52:55], v[152:155], v[104:107], v[52:55]
  ds_read_b128 v[96:99], v9 offset:8192
  s_waitcnt lgkmcnt(7)
  v_mfma_f32_16x16x32_bf16 v[44:47], v[76:79], v[104:107], v[44:47]
  ds_read_b128 v[100:103], v9 offset:9216
  s_waitcnt lgkmcnt(7)
  v_mfma_f32_16x16x32_bf16 v[48:51], v[80:83], v[104:107], v[48:51]
  s_barrier
  v_add_u32 v8, 18432, v8
  v_add_u32 v9, 18432, v9
  v_add_u32 v10, 18432, v10
  v_add_u32 v11, 18432, v11
  s_add_u32 s69, s69, 1
  s_cmp_ge_u32 s69, 10
  s_cselect_b32 s70, -9, 1
  s_cselect_b32 s69, 0, s69
  s_lshl_b32 s70, s70, 7
  v_add_u32 v6, s70, v6
  ds_read_b128 v[104:107], v10
  ds_read_b128 v[152:155], v6 offset:0
  ds_read_b128 v[64:67], v9 offset:0
  s_waitcnt lgkmcnt(7)
  v_mfma_f32_16x16x32_bf16 v[32:35], v[84:87], v[108:111], v[32:35]
  ds_read_b128 v[68:71], v9 offset:1024
  s_waitcnt lgkmcnt(7)
  v_mfma_f32_16x16x32_bf16 v[36:39], v[88:91], v[108:111], v[36:39]
  ds_read_b128 v[72:75], v9 offset:2048
  s_waitcnt lgkmcnt(7)
  v_mfma_f32_16x16x32_bf16 v[40:43], v[92:95], v[108:111], v[40:43]
  v_mfma_f32_16x16x32_bf16 v[52:55], v[156:159], v[108:111], v[52:55]
  ds_read_b128 v[76:79], v9 offset:3072
  s_waitcnt lgkmcnt(7)
  v_mfma_f32_16x16x32_bf16 v[44:47], v[96:99], v[108:111], v[44:47]
  ds_read_b128 v[80:83], v9 offset:4096
  s_waitcnt lgkmcnt(7)
  v_mfma_f32_16x16x32_bf16 v[48:51], v[100:103], v[108:111], v[48:51]
  ds_read_b128 v[108:111], v11
  ds_read_b128 v[156:159], v6 offset:64
  ds_read_b128 v[84:87], v9 offset:5120
  s_waitcnt lgkmcnt(7)
  v_mfma_f32_16x16x32_bf16 v[32:35], v[64:67], v[104:107], v[32:35]
  ds_read_b128 v[88:91], v9 offset:6144
  s_waitcnt lgkmcnt(7)
  v_mfma_f32_16x16x32_bf16 v[36:39], v[68:71], v[104:107], v[36:39]
  ds_read_b128 v[92:95], v9 offset:7168
  s_waitcnt lgkmcnt(7)
  v_mfma_f32_16x16x32_bf16 v[40:43], v[72:75], v[104:107], v[40:43]
  v_mfma_f32_16x16x32_bf16 v[52:55], v[152:155], v[104:107], v[52:55]
  ds_read_b128 v[96:99], v9 offset:8192
  s_waitcnt lgkmcnt(7)
  v_mfma_f32_16x16x32_bf16 v[44:47], v[76:79], v[104:107], v[44:47]
  ds_read_b128 v[100:103], v9 offset:9216
  s_waitcnt lgkmcnt(7)
  v_mfma_f32_16x16x32_bf16 v[48:51], v[80:83], v[104:107], v[48:51]
  s_barrier
  v_add_u32 v8, 0xfffe5000, v8
  v_add_u32 v9, 0xfffe5000, v9
  v_add_u32 v10, 0xfffe5000, v10
  v_add_u32 v11, 0xfffe5000, v11
  s_add_u32 s69, s69, 1
  s_cmp_ge_u32 s69, 10
  s_cselect_b32 s70, -9, 1
  s_cselect_b32 s69, 0, s69
  s_lshl_b32 s70, s70, 7
  v_add_u32 v6, s70, v6
  ds_read_b128 v[104:107], v10
  ds_read_b128 v[152:155], v6 offset:0
  ds_read_b128 v[64:67], v9 offset:0
  s_waitcnt lgkmcnt(7)
  v_mfma_f32_16x16x32_bf16 v[32:35], v[84:87], v[108:111], v[32:35]
  ds_read_b128 v[68:71], v9 offset:1024
  s_waitcnt lgkmcnt(7)
  v_mfma_f32_16x16x32_bf16 v[36:39], v[88:91], v[108:111], v[36:39]
  ds_read_b128 v[72:75], v9 offset:2048
  s_waitcnt lgkmcnt(7)
  v_mfma_f32_16x16x32_bf16 v[40:43], v[92:95], v[108:111], v[40:43]
  v_mfma_f32_16x16x32_bf16 v[52:55], v[156:159], v[108:111], v[52:55]
  ds_read_b128 v[76:79], v9 offset:3072
  s_waitcnt lgkmcnt(7)
  v_mfma_f32_16x16x32_bf16 v[44:47], v[96:99], v[108:111], v[44:47]
  ds_read_b128 v[80:83], v9 offset:4096
  s_waitcnt lgkmcnt(7)
  v_mfma_f32_16x16x32_bf16 v[48:51], v[100:103], v[108:111], v[48:51]
  ds_read_b128 v[108:111], v11
  ds_read_b128 v[156:159], v6 offset:64
  ds_read_b128 v[84:87], v9 offset:5120
  s_waitcnt lgkmcnt(7)
  v_mfma_f32_16x16x32_bf16 v[32:35], v[64:67], v[104:107], v[32:35]
  ds_read_b128 v[88:91], v9 offset:6144
  s_waitcnt lgkmcnt(7)
  v_mfma_f32_16x16x32_bf16 v[36:39], v[68:71], v[104:107], v[36:39]
  ds_read_b128 v[92:95], v9 offset:7168
  s_waitcnt lgkmcnt(7)
  v_mfma_f32_16x16x32_bf16 v[40:43], v[72:75], v[104:107], v[40:43]
  v_mfma_f32_16x16x32_bf16 v[52:55], v[152:155], v[104:107], v[52:55]
  ds_read_b128 v[96:99], v9 offset:8192
  s_waitcnt lgkmcnt(7)
  v_mfma_f32_16x16x32_bf16 v[44:47], v[76:79], v[104:107], v[44:47]
  ds_read_b128 v[100:103], v9 offset:9216
  s_waitcnt lgkmcnt(7)
  v_mfma_f32_16x16x32_bf16 v[48:51], v[80:83], v[104:107], v[48:51]
  s_barrier
  v_add_u32 v8, 18432, v8
  v_add_u32 v9, 18432, v9
  v_add_u32 v10, 18432, v10
  v_add_u32 v11, 18432, v11
  s_add_u32 s69, s69, 1
  s_cmp_ge_u32 s69, 10
  s_cselect_b32 s70, -9, 1
  s_cselect_b32 s69, 0, s69
  s_lshl_b32 s70, s70, 7
  v_add_u32 v6, s70, v6
  ds_read_b128 v[104:107], v10
  ds_read_b128 v[152:155], v6 offset:0
  ds_read_b128 v[64:67], v9 offset:0
  s_waitcnt lgkmcnt(7)
  v_mfma_f32_16x16x32_bf16 v[32:35], v[84:87], v[108:111], v[32:35]
  ds_read_b128 v[68:71], v9 offset:1024
  s_waitcnt lgkmcnt(7)
  v_mfma_f32_16x16x32_bf16 v[36:39], v[88:91], v[108:111], v[36:39]
  ds_read_b128 v[72:75], v9 offset:2048
  s_waitcnt lgkmcnt(7)
  v_mfma_f32_16x16x32_bf16 v[40:43], v[92:95], v[108:111], v[40:43]
  v_mfma_f32_16x16x32_bf16 v[52:55], v[156:159], v[108:111], v[52:55]
  ds_read_b128 v[76:79], v9 offset:3072
  s_waitcnt lgkmcnt(7)
  v_mfma_f32_16x16x32_bf16 v[44:47], v[96:99], v[108:111], v[44:47]
  ds_read_b128 v[80:83], v9 offset:4096
  s_waitcnt lgkmcnt(7)
  v_mfma_f32_16x16x32_bf16 v[48:51], v[100:103], v[108:111], v[48:51]
  ds_read_b128 v[108:111], v11
  ds_read_b128 v[156:159], v6 offset:64
  ds_read_b128 v[84:87], v9 offset:5120
  s_waitcnt lgkmcnt(7)
  v_mfma_f32_16x16x32_bf16 v[32:35], v[64:67], v[104:107], v[32:35]
  ds_read_b128 v[88:91], v9 offset:6144
  s_waitcnt lgkmcnt(7)
  v_mfma_f32_16x16x32_bf16 v[36:39], v[68:71], v[104:107], v[36:39]
  ds_read_b128 v[92:95], v9 offset:7168
  s_waitcnt lgkmcnt(7)
  v_mfma_f32_16x16x32_bf16 v[40:43], v[72:75], v[104:107], v[40:43]
  v_mfma_f32_16x16x32_bf16 v[52:55], v[152:155], v[104:107], v[52:55]
  ds_read_b128 v[96:99], v9 offset:8192
  s_waitcnt lgkmcnt(7)
  v_mfma_f32_16x16x32_bf16 v[44:47], v[76:79], v[104:107], v[44:47]
  ds_read_b128 v[100:103], v9 offset:9216
  s_waitcnt lgkmcnt(7)
  v_mfma_f32_16x16x32_bf16 v[48:51], v[80:83], v[104:107], v[48:51]
  s_barrier
  v_add_u32 v8, 18432, v8
  v_add_u32 v9, 18432, v9
  v_add_u32 v10, 18432, v10
  v_add_u32 v11, 18432, v11
  s_add_u32 s69, s69, 1
  s_cmp_ge_u32 s69, 10
  s_cselect_b32 s70, -9, 1
  s_cselect_b32 s69, 0, s69
  s_lshl_b32 s70, s70, 7
  v_add_u32 v6, s70, v6
  ds_read_b128 v[104:107], v10
  ds_read_b128 v[152:155], v6 offset:0
  ds_read_b128 v[64:67], v9 offset:0
  s_waitcnt lgkmcnt(7)
  v_mfma_f32_16x16x32_bf16 v[32:35], v[84:87], v[108:111], v[32:35]
  ds_read_b128 v[68:71], v9 offset:1024
  s_waitcnt lgkmcnt(7)
  v_mfma_f32_16x16x32_bf16 v[36:39], v[88:91], v[108:111], v[36:39]
  ds_read_b128 v[72:75], v9 offset:2048
  s_waitcnt lgkmcnt(7)
  v_mfma_f32_16x16x32_bf16 v[40:43], v[92:95], v[108:111], v[40:43]
  v_mfma_f32_16x16x32_bf16 v[52:55], v[156:159], v[108:111], v[52:55]
  ds_read_b128 v[76:79], v9 offset:3072
  s_waitcnt lgkmcnt(7)
  v_mfma_f32_16x16x32_bf16 v[44:47], v[96:99], v[108:111], v[44:47]
  ds_read_b128 v[80:83], v9 offset:4096
  s_waitcnt lgkmcnt(7)
  v_mfma_f32_16x16x32_bf16 v[48:51], v[100:103], v[108:111], v[48:51]
  ds_read_b128 v[108:111], v11
  ds_read_b128 v[156:159], v6 offset:64
  ds_read_b128 v[84:87], v9 offset:5120
  s_waitcnt lgkmcnt(7)
  v_mfma_f32_16x16x32_bf16 v[32:35], v[64:67], v[104:107], v[32:35]
  ds_read_b128 v[88:91], v9 offset:6144
  s_waitcnt lgkmcnt(7)
  v_mfma_f32_16x16x32_bf16 v[36:39], v[68:71], v[104:107], v[36:39]
  ds_read_b128 v[92:95], v9 offset:7168
  s_waitcnt lgkmcnt(7)
  v_mfma_f32_16x16x32_bf16 v[40:43], v[72:75], v[104:107], v[40:43]
  v_mfma_f32_16x16x32_bf16 v[52:55], v[152:155], v[104:107], v[52:55]
  ds_read_b128 v[96:99], v9 offset:8192
  s_waitcnt lgkmcnt(7)
  v_mfma_f32_16x16x32_bf16 v[44:47], v[76:79], v[104:107], v[44:47]
  ds_read_b128 v[100:103], v9 offset:9216
  s_waitcnt lgkmcnt(7)
  v_mfma_f32_16x16x32_bf16 v[48:51], v[80:83], v[104:107], v[48:51]
  s_barrier
  v_add_u32 v8, 18432, v8
  v_add_u32 v9, 18432, v9
  ds_read_b128 v[104:107], v8 offset:0
  ds_read_b128 v[64:67], v9 offset:0
  s_waitcnt lgkmcnt(6)
  v_mfma_f32_16x16x32_bf16 v[32:35], v[84:87], v[108:111], v[32:35]
  ds_read_b128 v[68:71], v9 offset:1024
  s_waitcnt lgkmcnt(6)
  v_mfma_f32_16x16x32_bf16 v[36:39], v[88:91], v[108:111], v[36:39]
  ds_read_b128 v[72:75], v9 offset:2048
  s_waitcnt lgkmcnt(6)
  v_mfma_f32_16x16x32_bf16 v[40:43], v[92:95], v[108:111], v[40:43]
  v_mfma_f32_16x16x32_bf16 v[52:55], v[156:159], v[108:111], v[52:55]
  ds_read_b128 v[76:79], v9 offset:3072
  s_waitcnt lgkmcnt(6)
  v_mfma_f32_16x16x32_bf16 v[44:47], v[96:99], v[108:111], v[44:47]
  ds_read_b128 v[80:83], v9 offset:4096
  s_waitcnt lgkmcnt(6)
  v_mfma_f32_16x16x32_bf16 v[48:51], v[100:103], v[108:111], v[48:51]
  ds_read_b128 v[108:111], v8 offset:4096
  ds_read_b128 v[84:87], v9 offset:5120
  s_waitcnt lgkmcnt(6)
  v_mfma_f32_16x16x32_bf16 v[132:135], v[64:67], v[104:107], 0
  ds_read_b128 v[88:91], v9 offset:6144
  s_waitcnt lgkmcnt(6)
  v_mfma_f32_16x16x32_bf16 v[136:139], v[68:71], v[104:107], 0
  ds_read_b128 v[92:95], v9 offset:7168
  s_waitcnt lgkmcnt(6)
  v_mfma_f32_16x16x32_bf16 v[140:143], v[72:75], v[104:107], 0
  ds_read_b128 v[96:99], v9 offset:8192
  s_waitcnt lgkmcnt(6)
  v_mfma_f32_16x16x32_bf16 v[144:147], v[76:79], v[104:107], 0
  ds_read_b128 v[100:103], v9 offset:9216
  s_waitcnt lgkmcnt(6)
  v_mfma_f32_16x16x32_bf16 v[148:151], v[80:83], v[104:107], 0
  s_barrier
  v_add_u32 v8, 18432, v8
  v_add_u32 v9, 18432, v9
  ds_read_b128 v[104:107], v8 offset:0
  ds_read_b128 v[64:67], v9 offset:0
  s_waitcnt lgkmcnt(6)
  v_mfma_f32_16x16x32_bf16 v[132:135], v[84:87], v[108:111], v[132:135]
  ds_read_b128 v[68:71], v9 offset:1024
  s_waitcnt lgkmcnt(6)
  v_mfma_f32_16x16x32_bf16 v[136:139], v[88:91], v[108:111], v[136:139]
  ds_read_b128 v[72:75], v9 offset:2048
  s_waitcnt lgkmcnt(6)
  v_mfma_f32_16x16x32_bf16 v[140:143], v[92:95], v[108:111], v[140:143]
  ds_read_b128 v[76:79], v9 offset:3072
  s_waitcnt lgkmcnt(6)
  v_mfma_f32_16x16x32_bf16 v[144:147], v[96:99], v[108:111], v[144:147]
  ds_read_b128 v[80:83], v9 offset:4096
  s_waitcnt lgkmcnt(6)
  v_mfma_f32_16x16x32_bf16 v[148:151], v[100:103], v[108:111], v[148:151]
  ds_read_b128 v[108:111], v8 offset:4096
  ds_read_b128 v[84:87], v9 offset:5120
  s_waitcnt lgkmcnt(6)
  v_mfma_f32_16x16x32_bf16 v[132:135], v[64:67], v[104:107], v[132:135]
  ds_read_b128 v[88:91], v9 offset:6144
  s_waitcnt lgkmcnt(6)
  v_mfma_f32_16x16x32_bf16 v[136:139], v[68:71], v[104:107], v[136:139]
  ds_read_b128 v[92:95], v9 offset:7168
  s_waitcnt lgkmcnt(6)
  v_mfma_f32_16x16x32_bf16 v[140:143], v[72:75], v[104:107], v[140:143]
  ds_read_b128 v[96:99], v9 offset:8192
  s_waitcnt lgkmcnt(6)
  v_mfma_f32_16x16x32_bf16 v[144:147], v[76:79], v[104:107], v[144:147]
  ds_read_b128 v[100:103], v9 offset:9216
  s_waitcnt lgkmcnt(6)
  v_mfma_f32_16x16x32_bf16 v[148:151], v[80:83], v[104:107], v[148:151]
  s_barrier
  v_add_u32 v8, 18432, v8
  v_add_u32 v9, 18432, v9
  ds_read_b128 v[104:107], v8 offset:0
  ds_read_b128 v[64:67], v9 offset:0
  s_waitcnt lgkmcnt(6)
  v_mfma_f32_16x16x32_bf16 v[132:135], v[84:87], v[108:111], v[132:135]
  ds_read_b128 v[68:71], v9 offset:1024
  s_waitcnt lgkmcnt(6)
  v_mfma_f32_16x16x32_bf16 v[136:139], v[88:91], v[108:111], v[136:139]
  ds_read_b128 v[72:75], v9 offset:2048
  s_waitcnt lgkmcnt(6)
  v_mfma_f32_16x16x32_bf16 v[140:143], v[92:95], v[108:111], v[140:143]
  ds_read_b128 v[76:79], v9 offset:3072
  s_waitcnt lgkmcnt(6)
  v_mfma_f32_16x16x32_bf16 v[144:147], v[96:99], v[108:111], v[144:147]
  ds_read_b128 v[80:83], v9 offset:4096
  s_waitcnt lgkmcnt(6)
  v_mfma_f32_16x16x32_bf16 v[148:151], v[100:103], v[108:111], v[148:151]
  ds_read_b128 v[108:111], v8 offset:4096
  ds_read_b128 v[84:87], v9 offset:5120
  s_waitcnt lgkmcnt(6)
  v_mfma_f32_16x16x32_bf16 v[132:135], v[64:67], v[104:107], v[132:135]
  ds_read_b128 v[88:91], v9 offset:6144
  s_waitcnt lgkmcnt(6)
  v_mfma_f32_16x16x32_bf16 v[136:139], v[68:71], v[104:107], v[136:139]
  ds_read_b128 v[92:95], v9 offset:7168
  s_waitcnt lgkmcnt(6)
  v_mfma_f32_16x16x32_bf16 v[140:143], v[72:75], v[104:107], v[140:143]
  ds_read_b128 v[96:99], v9 offset:8192
  s_waitcnt lgkmcnt(6)
  v_mfma_f32_16x16x32_bf16 v[144:147], v[76:79], v[104:107], v[144:147]
  ds_read_b128 v[100:103], v9 offset:9216
  s_waitcnt lgkmcnt(6)
  v_mfma_f32_16x16x32_bf16 v[148:151], v[80:83], v[104:107], v[148:151]
  s_barrier
  v_add_u32 v8, 18432, v8
  v_add_u32 v9, 18432, v9
  ds_read_b128 v[104:107], v8 offset:0
  ds_read_b128 v[64:67], v9 offset:0
  s_waitcnt lgkmcnt(6)
  v_mfma_f32_16x16x32_bf16 v[132:135], v[84:87], v[108:111], v[132:135]
  ds_read_b128 v[68:71], v9 offset:1024
  s_waitcnt lgkmcnt(6)
  v_mfma_f32_16x16x32_bf16 v[136:139], v[88:91], v[108:111], v[136:139]
  ds_read_b128 v[72:75], v9 offset:2048
  s_waitcnt lgkmcnt(6)
  v_mfma_f32_16x16x32_bf16 v[140:143], v[92:95], v[108:111], v[140:143]
  ds_read_b128 v[76:79], v9 offset:3072
  s_waitcnt lgkmcnt(6)
  v_mfma_f32_16x16x32_bf16 v[144:147], v[96:99], v[108:111], v[144:147]
  ds_read_b128 v[80:83], v9 offset:4096
  s_waitcnt lgkmcnt(6)
  v_mfma_f32_16x16x32_bf16 v[148:151], v[100:103], v[108:111], v[148:151]
  ds_read_b128 v[108:111], v8 offset:4096
  ds_read_b128 v[84:87], v9 offset:5120
  s_waitcnt lgkmcnt(6)
  v_mfma_f32_16x16x32_bf16 v[132:135], v[64:67], v[104:107], v[132:135]
  ds_read_b128 v[88:91], v9 offset:6144
  s_waitcnt lgkmcnt(6)
  v_mfma_f32_16x16x32_bf16 v[136:139], v[68:71], v[104:107], v[136:139]
  ds_read_b128 v[92:95], v9 offset:7168
  s_waitcnt lgkmcnt(6)
  v_mfma_f32_16x16x32_bf16 v[140:143], v[72:75], v[104:107], v[140:143]
  ds_read_b128 v[96:99], v9 offset:8192
  s_waitcnt lgkmcnt(6)
  v_mfma_f32_16x16x32_bf16 v[144:147], v[76:79], v[104:107], v[144:147]
  ds_read_b128 v[100:103], v9 offset:9216
  s_waitcnt lgkmcnt(6)
  v_mfma_f32_16x16x32_bf16 v[148:151], v[80:83], v[104:107], v[148:151]
  s_barrier
  v_add_u32 v8, 0xfffe5000, v8
  v_add_u32 v9, 0xfffe5000, v9
  ds_read_b128 v[104:107], v8 offset:0
  ds_read_b128 v[64:67], v9 offset:0
  s_waitcnt lgkmcnt(6)
  v_mfma_f32_16x16x32_bf16 v[132:135], v[84:87], v[108:111], v[132:135]
  ds_read_b128 v[68:71], v9 offset:1024
  s_waitcnt lgkmcnt(6)
  v_mfma_f32_16x16x32_bf16 v[136:139], v[88:91], v[108:111], v[136:139]
  ds_read_b128 v[72:75], v9 offset:2048
  s_waitcnt lgkmcnt(6)
  v_mfma_f32_16x16x32_bf16 v[140:143], v[92:95], v[108:111], v[140:143]
  ds_read_b128 v[76:79], v9 offset:3072
  s_waitcnt lgkmcnt(6)
  v_mfma_f32_16x16x32_bf16 v[144:147], v[96:99], v[108:111], v[144:147]
  ds_read_b128 v[80:83], v9 offset:4096
  s_waitcnt lgkmcnt(6)
  v_mfma_f32_16x16x32_bf16 v[148:151], v[100:103], v[108:111], v[148:151]
  ds_read_b128 v[108:111], v8 offset:4096
  ds_read_b128 v[84:87], v9 offset:5120
  s_waitcnt lgkmcnt(6)
  v_mfma_f32_16x16x32_bf16 v[132:135], v[64:67], v[104:107], v[132:135]
  ds_read_b128 v[88:91], v9 offset:6144
  s_waitcnt lgkmcnt(6)
  v_mfma_f32_16x16x32_bf16 v[136:139], v[68:71], v[104:107], v[136:139]
  ds_read_b128 v[92:95], v9 offset:7168
  s_waitcnt lgkmcnt(6)
  v_mfma_f32_16x16x32_bf16 v[140:143], v[72:75], v[104:107], v[140:143]
  ds_read_b128 v[96:99], v9 offset:8192
  s_waitcnt lgkmcnt(6)
  v_mfma_f32_16x16x32_bf16 v[144:147], v[76:79], v[104:107], v[144:147]
  ds_read_b128 v[100:103], v9 offset:9216
  s_waitcnt lgkmcnt(6)
  v_mfma_f32_16x16x32_bf16 v[148:151], v[80:83], v[104:107], v[148:151]
  s_barrier
  v_add_u32 v8, 18432, v8
  v_add_u32 v9, 18432, v9
  ds_read_b128 v[104:107], v8 offset:0
  ds_read_b128 v[64:67], v9 offset:0
  s_waitcnt lgkmcnt(6)
  v_mfma_f32_16x16x32_bf16 v[132:135], v[84:87], v[108:111], v[132:135]
  ds_read_b128 v[68:71], v9 offset:1024
  s_waitcnt lgkmcnt(6)
  v_mfma_f32_16x16x32_bf16 v[136:139], v[88:91], v[108:111], v[136:139]
  ds_read_b128 v[72:75], v9 offset:2048
  s_waitcnt lgkmcnt(6)
  v_mfma_f32_16x16x32_bf16 v[140:143], v[92:95], v[108:111], v[140:143]
  ds_read_b128 v[76:79], v9 offset:3072
  s_waitcnt lgkmcnt(6)
  v_mfma_f32_16x16x32_bf16 v[144:147], v[96:99], v[108:111], v[144:147]
  ds_read_b128 v[80:83], v9 offset:4096
  s_waitcnt lgkmcnt(6)
  v_mfma_f32_16x16x32_bf16 v[148:151], v[100:103], v[108:111], v[148:151]
  ds_read_b128 v[108:111], v8 offset:4096
  ds_read_b128 v[84:87], v9 offset:5120
  s_waitcnt lgkmcnt(6)
  v_mfma_f32_16x16x32_bf16 v[132:135], v[64:67], v[104:107], v[132:135]
  ds_read_b128 v[88:91], v9 offset:6144
  s_waitcnt lgkmcnt(6)
  v_mfma_f32_16x16x32_bf16 v[136:139], v[68:71], v[104:107], v[136:139]
  ds_read_b128 v[92:95], v9 offset:7168
  s_waitcnt lgkmcnt(6)
  v_mfma_f32_16x16x32_bf16 v[140:143], v[72:75], v[104:107], v[140:143]
  ds_read_b128 v[96:99], v9 offset:8192
  s_waitcnt lgkmcnt(6)
  v_mfma_f32_16x16x32_bf16 v[144:147], v[76:79], v[104:107], v[144:147]
  ds_read_b128 v[100:103], v9 offset:9216
  s_waitcnt lgkmcnt(6)
  v_mfma_f32_16x16x32_bf16 v[148:151], v[80:83], v[104:107], v[148:151]
  s_barrier
  v_add_u32 v8, 18432, v8
  v_add_u32 v9, 18432, v9
  ds_read_b128 v[104:107], v8 offset:0
  ds_read_b128 v[64:67], v9 offset:0
  s_waitcnt lgkmcnt(6)
  v_mfma_f32_16x16x32_bf16 v[132:135], v[84:87], v[108:111], v[132:135]
  ds_read_b128 v[68:71], v9 offset:1024
  s_waitcnt lgkmcnt(6)
  v_mfma_f32_16x16x32_bf16 v[136:139], v[88:91], v[108:111], v[136:139]
  ds_read_b128 v[72:75], v9 offset:2048
  s_waitcnt lgkmcnt(6)
  v_mfma_f32_16x16x32_bf16 v[140:143], v[92:95], v[108:111], v[140:143]
  ds_read_b128 v[76:79], v9 offset:3072
  s_waitcnt lgkmcnt(6)
  v_mfma_f32_16x16x32_bf16 v[144:147], v[96:99], v[108:111], v[144:147]
  ds_read_b128 v[80:83], v9 offset:4096
  s_waitcnt lgkmcnt(6)
  v_mfma_f32_16x16x32_bf16 v[148:151], v[100:103], v[108:111], v[148:151]
  ds_read_b128 v[108:111], v8 offset:4096
  ds_read_b128 v[84:87], v9 offset:5120
  s_waitcnt lgkmcnt(6)
  v_mfma_f32_16x16x32_bf16 v[132:135], v[64:67], v[104:107], v[132:135]
  ds_read_b128 v[88:91], v9 offset:6144
  s_waitcnt lgkmcnt(6)
  v_mfma_f32_16x16x32_bf16 v[136:139], v[68:71], v[104:107], v[136:139]
  ds_read_b128 v[92:95], v9 offset:7168
  s_waitcnt lgkmcnt(6)
  v_mfma_f32_16x16x32_bf16 v[140:143], v[72:75], v[104:107], v[140:143]
  ds_read_b128 v[96:99], v9 offset:8192
  s_waitcnt lgkmcnt(6)
  v_mfma_f32_16x16x32_bf16 v[144:147], v[76:79], v[104:107], v[144:147]
  ds_read_b128 v[100:103], v9 offset:9216
  s_waitcnt lgkmcnt(6)
  v_mfma_f32_16x16x32_bf16 v[148:151], v[80:83], v[104:107], v[148:151]
  s_barrier
  v_add_u32 v8, 18432, v8
  v_add_u32 v9, 18432, v9
  ds_read_b128 v[104:107], v8 offset:0
  ds_read_b128 v[64:67], v9 offset:0
  s_waitcnt lgkmcnt(6)
  v_mfma_f32_16x16x32_bf16 v[132:135], v[84:87], v[108:111], v[132:135]
  ds_read_b128 v[68:71], v9 offset:1024
  s_waitcnt lgkmcnt(6)
  v_mfma_f32_16x16x32_bf16 v[136:139], v[88:91], v[108:111], v[136:139]
  ds_read_b128 v[72:75], v9 offset:2048
  s_waitcnt lgkmcnt(6)
  v_mfma_f32_16x16x32_bf16 v[140:143], v[92:95], v[108:111], v[140:143]
  ds_read_b128 v[76:79], v9 offset:3072
  s_waitcnt lgkmcnt(6)
  v_mfma_f32_16x16x32_bf16 v[144:147], v[96:99], v[108:111], v[144:147]
  ds_read_b128 v[80:83], v9 offset:4096
  s_waitcnt lgkmcnt(6)
  v_mfma_f32_16x16x32_bf16 v[148:151], v[100:103], v[108:111], v[148:151]
  ds_read_b128 v[108:111], v8 offset:4096
  ds_read_b128 v[84:87], v9 offset:5120
  s_waitcnt lgkmcnt(6)
  v_mfma_f32_16x16x32_bf16 v[132:135], v[64:67], v[104:107], v[132:135]
  ds_read_b128 v[88:91], v9 offset:6144
  s_waitcnt lgkmcnt(6)
  v_mfma_f32_16x16x32_bf16 v[136:139], v[68:71], v[104:107], v[136:139]
  ds_read_b128 v[92:95], v9 offset:7168
  s_waitcnt lgkmcnt(6)
  v_mfma_f32_16x16x32_bf16 v[140:143], v[72:75], v[104:107], v[140:143]
  ds_read_b128 v[96:99], v9 offset:8192
  s_waitcnt lgkmcnt(6)
  v_mfma_f32_16x16x32_bf16 v[144:147], v[76:79], v[104:107], v[144:147]
  ds_read_b128 v[100:103], v9 offset:9216
  s_waitcnt lgkmcnt(6)
  v_mfma_f32_16x16x32_bf16 v[148:151], v[80:83], v[104:107], v[148:151]
  s_barrier
  v_add_u32 v8, 18432, v8
  v_add_u32 v9, 18432, v9
  ds_read_b128 v[104:107], v8 offset:0
  ds_read_b128 v[64:67], v9 offset:0
  s_waitcnt lgkmcnt(6)
  v_mfma_f32_16x16x32_bf16 v[132:135], v[84:87], v[108:111], v[132:135]
  ds_read_b128 v[68:71], v9 offset:1024
  s_waitcnt lgkmcnt(6)
  v_mfma_f32_16x16x32_bf16 v[136:139], v[88:91], v[108:111], v[136:139]
  ds_read_b128 v[72:75], v9 offset:2048
  s_waitcnt lgkmcnt(6)
  v_mfma_f32_16x16x32_bf16 v[140:143], v[92:95], v[108:111], v[140:143]
  ds_read_b128 v[76:79], v9 offset:3072
  s_waitcnt lgkmcnt(6)
  v_mfma_f32_16x16x32_bf16 v[144:147], v[96:99], v[108:111], v[144:147]
  ds_read_b128 v[80:83], v9 offset:4096
  s_waitcnt lgkmcnt(6)
  v_mfma_f32_16x16x32_bf16 v[148:151], v[100:103], v[108:111], v[148:151]
  ds_read_b128 v[108:111], v8 offset:4096
  ds_read_b128 v[84:87], v9 offset:5120
  s_waitcnt lgkmcnt(6)
  v_mfma_f32_16x16x32_bf16 v[132:135], v[64:67], v[104:107], v[132:135]
  ds_read_b128 v[88:91], v9 offset:6144
  s_waitcnt lgkmcnt(6)
  v_mfma_f32_16x16x32_bf16 v[136:139], v[68:71], v[104:107], v[136:139]
  ds_read_b128 v[92:95], v9 offset:7168
  s_waitcnt lgkmcnt(6)
  v_mfma_f32_16x16x32_bf16 v[140:143], v[72:75], v[104:107], v[140:143]
  ds_read_b128 v[96:99], v9 offset:8192
  s_waitcnt lgkmcnt(6)
  v_mfma_f32_16x16x32_bf16 v[144:147], v[76:79], v[104:107], v[144:147]
  ds_read_b128 v[100:103], v9 offset:9216
  s_waitcnt lgkmcnt(6)
  v_mfma_f32_16x16x32_bf16 v[148:151], v[80:83], v[104:107], v[148:151]
  s_barrier
  v_add_u32 v8, 18432, v8
  v_add_u32 v9, 18432, v9
  s_mov_b32 s60, 0x3fb8aa3b
  s_mov_b32 s61, 0x3fb8aa3b
  s_mov_b32 s62, 1.0
  s_mov_b32 s63, 1.0
  s_mov_b32 s64, 0x358637bd
  s_mov_b32 s65, 0x358637bd
  v_cvt_pk_bf16_f32 v212, v32, v33
  v_cvt_pk_bf16_f32 v213, v34, v35
  v_lshlrev_b32 v214, 16, v212
  v_and_b32 v215, 0xffff0000, v212
  v_lshlrev_b32 v216, 16, v213
  v_and_b32 v217, 0xffff0000, v213
  v_pk_mul_f32 v[218:219], v[214:215], s[60:61]
  v_pk_mul_f32 v[220:221], v[216:217], s[60:61]
  v_exp_f32 v218, v218
  v_exp_f32 v219, v219
  v_exp_f32 v220, v220
  v_exp_f32 v221, v221
  v_pk_add_f32 v[214:215], v[214:215], s[62:63]
  v_pk_add_f32 v[216:217], v[216:217], s[62:63]
  v_med3_f32 v214, v214, v218, 1.0
  v_med3_f32 v215, v215, v219, 1.0
  v_med3_f32 v216, v216, v220, 1.0
  v_med3_f32 v217, v217, v221, 1.0
  v_cvt_pk_bf16_f32 v212, v214, v215
  v_cvt_pk_bf16_f32 v213, v216, v217
  v_lshlrev_b32 v214, 16, v212
  v_and_b32 v215, 0xffff0000, v212
  v_lshlrev_b32 v216, 16, v213
  v_and_b32 v217, 0xffff0000, v213
  v_pk_add_f32 v[214:215], v[214:215], s[64:65]
  v_pk_add_f32 v[216:217], v[216:217], s[64:65]
  v_cvt_pk_bf16_f32 v152, v214, v215
  v_cvt_pk_bf16_f32 v153, v216, v217
  v_cvt_pk_bf16_f32 v224, v36, v37
  v_cvt_pk_bf16_f32 v225, v38, v39
  v_lshlrev_b32 v226, 16, v224
  v_and_b32 v227, 0xffff0000, v224
  v_lshlrev_b32 v228, 16, v225
  v_and_b32 v229, 0xffff0000, v225
  v_pk_mul_f32 v[230:231], v[226:227], s[60:61]
  v_pk_mul_f32 v[232:233], v[228:229], s[60:61]
  v_exp_f32 v230, v230
  v_exp_f32 v231, v231
  v_exp_f32 v232, v232
  v_exp_f32 v233, v233
  v_pk_add_f32 v[226:227], v[226:227], s[62:63]
  v_pk_add_f32 v[228:229], v[228:229], s[62:63]
  v_med3_f32 v226, v226, v230, 1.0
  v_med3_f32 v227, v227, v231, 1.0
  v_med3_f32 v228, v228, v232, 1.0
  v_med3_f32 v229, v229, v233, 1.0
  v_cvt_pk_bf16_f32 v224, v226, v227
  v_cvt_pk_bf16_f32 v225, v228, v229
  v_lshlrev_b32 v226, 16, v224
  v_and_b32 v227, 0xffff0000, v224
  v_lshlrev_b32 v228, 16, v225
  v_and_b32 v229, 0xffff0000, v225
  v_pk_add_f32 v[226:227], v[226:227], s[64:65]
  v_pk_add_f32 v[228:229], v[228:229], s[64:65]
  v_cvt_pk_bf16_f32 v154, v226, v227
  v_cvt_pk_bf16_f32 v155, v228, v229
  v_cvt_pk_bf16_f32 v212, v40, v41
  v_cvt_pk_bf16_f32 v213, v42, v43
  v_lshlrev_b32 v214, 16, v212
  v_and_b32 v215, 0xffff0000, v212
  v_lshlrev_b32 v216, 16, v213
  v_and_b32 v217, 0xffff0000, v213
  v_pk_mul_f32 v[218:219], v[214:215], s[60:61]
  v_pk_mul_f32 v[220:221], v[216:217], s[60:61]
  v_exp_f32 v218, v218
  v_exp_f32 v219, v219
  v_exp_f32 v220, v220
  v_exp_f32 v221, v221
  v_pk_add_f32 v[214:215], v[214:215], s[62:63]
  v_pk_add_f32 v[216:217], v[216:217], s[62:63]
  v_med3_f32 v214, v214, v218, 1.0
  v_med3_f32 v215, v215, v219, 1.0
  v_med3_f32 v216, v216, v220, 1.0
  v_med3_f32 v217, v217, v221, 1.0
  v_cvt_pk_bf16_f32 v212, v214, v215
  v_cvt_pk_bf16_f32 v213, v216, v217
  v_lshlrev_b32 v214, 16, v212
  v_and_b32 v215, 0xffff0000, v212
  v_lshlrev_b32 v216, 16, v213
  v_and_b32 v217, 0xffff0000, v213
  v_pk_add_f32 v[214:215], v[214:215], s[64:65]
  v_pk_add_f32 v[216:217], v[216:217], s[64:65]
  v_cvt_pk_bf16_f32 v156, v214, v215
  v_cvt_pk_bf16_f32 v157, v216, v217
  v_cvt_pk_bf16_f32 v224, v44, v45
  v_cvt_pk_bf16_f32 v225, v46, v47
  v_lshlrev_b32 v226, 16, v224
  v_and_b32 v227, 0xffff0000, v224
  v_lshlrev_b32 v228, 16, v225
  v_and_b32 v229, 0xffff0000, v225
  v_pk_mul_f32 v[230:231], v[226:227], s[60:61]
  v_pk_mul_f32 v[232:233], v[228:229], s[60:61]
  v_exp_f32 v230, v230
  v_exp_f32 v231, v231
  v_exp_f32 v232, v232
  v_exp_f32 v233, v233
  v_pk_add_f32 v[226:227], v[226:227], s[62:63]
  v_pk_add_f32 v[228:229], v[228:229], s[62:63]
  v_med3_f32 v226, v226, v230, 1.0
  v_med3_f32 v227, v227, v231, 1.0
  v_med3_f32 v228, v228, v232, 1.0
  v_med3_f32 v229, v229, v233, 1.0
  v_cvt_pk_bf16_f32 v224, v226, v227
  v_cvt_pk_bf16_f32 v225, v228, v229
  v_lshlrev_b32 v226, 16, v224
  v_and_b32 v227, 0xffff0000, v224
  v_lshlrev_b32 v228, 16, v225
  v_and_b32 v229, 0xffff0000, v225
  v_pk_add_f32 v[226:227], v[226:227], s[64:65]
  v_pk_add_f32 v[228:229], v[228:229], s[64:65]
  v_cvt_pk_bf16_f32 v158, v226, v227
  v_cvt_pk_bf16_f32 v159, v228, v229
  v_cvt_pk_bf16_f32 v212, v48, v49
  v_cvt_pk_bf16_f32 v213, v50, v51
  v_lshlrev_b32 v214, 16, v212
  v_and_b32 v215, 0xffff0000, v212
  v_lshlrev_b32 v216, 16, v213
  v_and_b32 v217, 0xffff0000, v213
  v_pk_mul_f32 v[218:219], v[214:215], s[60:61]
  v_pk_mul_f32 v[220:221], v[216:217], s[60:61]
  v_exp_f32 v218, v218
  v_exp_f32 v219, v219
  v_exp_f32 v220, v220
  v_exp_f32 v221, v221
  v_pk_add_f32 v[214:215], v[214:215], s[62:63]
  v_pk_add_f32 v[216:217], v[216:217], s[62:63]
  v_med3_f32 v214, v214, v218, 1.0
  v_med3_f32 v215, v215, v219, 1.0
  v_med3_f32 v216, v216, v220, 1.0
  v_med3_f32 v217, v217, v221, 1.0
  v_cvt_pk_bf16_f32 v212, v214, v215
  v_cvt_pk_bf16_f32 v213, v216, v217
  v_lshlrev_b32 v214, 16, v212
  v_and_b32 v215, 0xffff0000, v212
  v_lshlrev_b32 v216, 16, v213
  v_and_b32 v217, 0xffff0000, v213
  v_pk_add_f32 v[214:215], v[214:215], s[64:65]
  v_pk_add_f32 v[216:217], v[216:217], s[64:65]
  v_cvt_pk_bf16_f32 v160, v214, v215
  v_cvt_pk_bf16_f32 v161, v216, v217
  v_mov_b32 v162, 0
  v_mov_b32 v163, 0
  v_mul_u32_u24 v14, 192, v2
  v_lshl_add_u32 v14, v3, 3, v14
  v_add_u32 v14, 129024, v14
  s_mul_i32 s12, s10, 69760
  s_mul_i32 s11, s75, 2560
  s_add_u32 s12, s12, s11
  s_add_u32 s12, s12, 4096
  v_lshrrev_b32 v15, 1, v3
  v_lshl_add_u32 v15, v15, 4, v2
  v_lshlrev_b32 v15, 4, v15
  v_add_u32 v13, s12, v15
  v_and_b32 v15, 1, v3
  v_lshl_add_u32 v12, v15, 9, v13
  s_barrier
  ds_read_b64 v[164:165], v14 offset:0
  ds_read_b64 v[166:167], v14 offset:32
  ds_read_b64 v[172:173], v14 offset:15360
  ds_read_b64 v[174:175], v14 offset:15392
  ds_read_b64 v[180:181], v14 offset:3072
  ds_read_b64 v[182:183], v14 offset:3104
  ds_read_b64 v[184:185], v14 offset:3136
  ds_read_b64 v[186:187], v14 offset:3168
  ds_read_b64 v[188:189], v14 offset:18432
  ds_read_b64 v[190:191], v14 offset:18464
  ds_read_b64 v[192:193], v14 offset:18496
  ds_read_b64 v[194:195], v14 offset:18528
  s_waitcnt lgkmcnt(8)
  v_mfma_f32_16x16x32_bf16 v[196:199], v[164:167], v[152:155], 0
  v_mfma_f32_16x16x32_bf16 v[200:203], v[172:175], v[152:155], 0
  s_waitcnt lgkmcnt(0)
  v_mfma_f32_16x16x32_bf16 v[204:207], v[180:183], v[152:155], 0
  v_mfma_f32_16x16x32_bf16 v[204:207], v[184:187], v[156:159], v[204:207]
  v_mfma_f32_16x16x32_bf16 v[208:211], v[188:191], v[152:155], 0
  v_mfma_f32_16x16x32_bf16 v[208:211], v[192:195], v[156:159], v[208:211]
  ds_read_b64 v[164:165], v14 offset:6144
  ds_read_b64 v[166:167], v14 offset:6176
  ds_read_b64 v[168:169], v14 offset:6208
  ds_read_b64 v[170:171], v14 offset:6240
  ds_read_b64 v[172:173], v14 offset:21504
  ds_read_b64 v[174:175], v14 offset:21536
  ds_read_b64 v[176:177], v14 offset:21568
  ds_read_b64 v[178:179], v14 offset:21600
  s_nop 3
  v_cvt_pk_bf16_f32 v212, v196, v197
  v_cvt_pk_bf16_f32 v213, v198, v199
  v_cvt_pk_bf16_f32 v214, v200, v201
  v_cvt_pk_bf16_f32 v215, v202, v203
  v_lshlrev_b32 v216, 16, v212
  v_and_b32 v217, 0xffff0000, v212
  v_lshlrev_b32 v218, 16, v213
  v_and_b32 v219, 0xffff0000, v213
  v_lshlrev_b32 v220, 16, v214
  v_and_b32 v221, 0xffff0000, v214
  v_lshlrev_b32 v222, 16, v215
  v_and_b32 v223, 0xffff0000, v215
  v_pk_add_f32 v[220:221], v[220:221], s[64:65]
  v_pk_add_f32 v[222:223], v[222:223], s[64:65]
  v_cvt_pk_bf16_f32 v214, v220, v221
  v_cvt_pk_bf16_f32 v215, v222, v223
  v_lshlrev_b32 v220, 16, v214
  v_and_b32 v221, 0xffff0000, v214
  v_lshlrev_b32 v222, 16, v215
  v_and_b32 v223, 0xffff0000, v215
  v_rcp_f32 v224, v220
  v_rcp_f32 v225, v221
  v_rcp_f32 v226, v222
  v_rcp_f32 v227, v223
  s_nop 0
  v_pk_mul_f32 v[228:229], v[216:217], v[224:225]
  v_pk_mul_f32 v[230:231], v[218:219], v[226:227]
  v_fma_f32 v216, -v220, v228, v216
  v_fma_f32 v217, -v221, v229, v217
  v_fma_f32 v218, -v222, v230, v218
  v_fma_f32 v219, -v223, v231, v219
  v_fma_f32 v228, v216, v224, v228
  v_fma_f32 v229, v217, v225, v229
  v_fma_f32 v230, v218, v226, v230
  v_fma_f32 v231, v219, v227, v231
  v_cvt_pk_bf16_f32 v236, v228, v229
  v_cvt_pk_bf16_f32 v237, v230, v231
  s_waitcnt lgkmcnt(0)
  v_mfma_f32_16x16x32_bf16 v[196:199], v[164:167], v[152:155], 0
  v_mfma_f32_16x16x32_bf16 v[196:199], v[168:171], v[156:159], v[196:199]
  v_mfma_f32_16x16x32_bf16 v[200:203], v[172:175], v[152:155], 0
  v_mfma_f32_16x16x32_bf16 v[200:203], v[176:179], v[156:159], v[200:203]
  ds_read_b64 v[180:181], v14 offset:9280
  ds_read_b64 v[182:183], v14 offset:9312
  ds_read_b64 v[184:185], v14 offset:9344
  ds_read_b64 v[186:187], v14 offset:9376
  ds_read_b64 v[188:189], v14 offset:24640
  ds_read_b64 v[190:191], v14 offset:24672
  ds_read_b64 v[192:193], v14 offset:24704
  ds_read_b64 v[194:195], v14 offset:24736
  v_cvt_pk_bf16_f32 v212, v204, v205
  v_cvt_pk_bf16_f32 v213, v206, v207
  v_cvt_pk_bf16_f32 v214, v208, v209
  v_cvt_pk_bf16_f32 v215, v210, v211
  v_lshlrev_b32 v216, 16, v212
  v_and_b32 v217, 0xffff0000, v212
  v_lshlrev_b32 v218, 16, v213
  v_and_b32 v219, 0xffff0000, v213
  v_lshlrev_b32 v220, 16, v214
  v_and_b32 v221, 0xffff0000, v214
  v_lshlrev_b32 v222, 16, v215
  v_and_b32 v223, 0xffff0000, v215
  v_pk_add_f32 v[220:221], v[220:221], s[64:65]
  v_pk_add_f32 v[222:223], v[222:223], s[64:65]
  v_cvt_pk_bf16_f32 v214, v220, v221
  v_cvt_pk_bf16_f32 v215, v222, v223
  v_lshlrev_b32 v220, 16, v214
  v_and_b32 v221, 0xffff0000, v214
  v_lshlrev_b32 v222, 16, v215
  v_and_b32 v223, 0xffff0000, v215
  v_rcp_f32 v224, v220
  v_rcp_f32 v225, v221
  v_rcp_f32 v226, v222
  v_rcp_f32 v227, v223
  s_nop 0
  v_pk_mul_f32 v[228:229], v[216:217], v[224:225]
  v_pk_mul_f32 v[230:231], v[218:219], v[226:227]
  v_fma_f32 v216, -v220, v228, v216
  v_fma_f32 v217, -v221, v229, v217
  v_fma_f32 v218, -v222, v230, v218
  v_fma_f32 v219, -v223, v231, v219
  v_fma_f32 v228, v216, v224, v228
  v_fma_f32 v229, v217, v225, v229
  v_fma_f32 v230, v218, v226, v230
  v_fma_f32 v231, v219, v227, v231
  v_cvt_pk_bf16_f32 v238, v228, v229
  v_cvt_pk_bf16_f32 v239, v230, v231
  s_nop 1
  v_permlane16_swap_b32 v236, v238
  v_permlane16_swap_b32 v237, v239
  s_nop 0
  buffer_store_dwordx4 v[236:239], v12, s[48:51], 0 offen offset:0 sc1
  s_waitcnt lgkmcnt(0)
  v_mfma_f32_16x16x32_bf16 v[204:207], v[180:183], v[156:159], 0
  v_mfma_f32_16x16x32_bf16 v[204:207], v[184:187], v[160:163], v[204:207]
  v_mfma_f32_16x16x32_bf16 v[208:211], v[188:191], v[156:159], 0
  v_mfma_f32_16x16x32_bf16 v[208:211], v[192:195], v[160:163], v[208:211]
  ds_read_b64 v[164:165], v14 offset:12352
  ds_read_b64 v[166:167], v14 offset:12384
  ds_read_b64 v[168:169], v14 offset:12416
  ds_read_b64 v[170:171], v14 offset:12448
  ds_read_b64 v[172:173], v14 offset:27712
  ds_read_b64 v[174:175], v14 offset:27744
  ds_read_b64 v[176:177], v14 offset:27776
  ds_read_b64 v[178:179], v14 offset:27808
  v_cvt_pk_bf16_f32 v212, v196, v197
  v_cvt_pk_bf16_f32 v213, v198, v199
  v_cvt_pk_bf16_f32 v214, v200, v201
  v_cvt_pk_bf16_f32 v215, v202, v203
  v_lshlrev_b32 v216, 16, v212
  v_and_b32 v217, 0xffff0000, v212
  v_lshlrev_b32 v218, 16, v213
  v_and_b32 v219, 0xffff0000, v213
  v_lshlrev_b32 v220, 16, v214
  v_and_b32 v221, 0xffff0000, v214
  v_lshlrev_b32 v222, 16, v215
  v_and_b32 v223, 0xffff0000, v215
  v_pk_add_f32 v[220:221], v[220:221], s[64:65]
  v_pk_add_f32 v[222:223], v[222:223], s[64:65]
  v_cvt_pk_bf16_f32 v214, v220, v221
  v_cvt_pk_bf16_f32 v215, v222, v223
  v_lshlrev_b32 v220, 16, v214
  v_and_b32 v221, 0xffff0000, v214
  v_lshlrev_b32 v222, 16, v215
  v_and_b32 v223, 0xffff0000, v215
  v_rcp_f32 v224, v220
  v_rcp_f32 v225, v221
  v_rcp_f32 v226, v222
  v_rcp_f32 v227, v223
  s_nop 0
  v_pk_mul_f32 v[228:229], v[216:217], v[224:225]
  v_pk_mul_f32 v[230:231], v[218:219], v[226:227]
  v_fma_f32 v216, -v220, v228, v216
  v_fma_f32 v217, -v221, v229, v217
  v_fma_f32 v218, -v222, v230, v218
  v_fma_f32 v219, -v223, v231, v219
  v_fma_f32 v228, v216, v224, v228
  v_fma_f32 v229, v217, v225, v229
  v_fma_f32 v230, v218, v226, v230
  v_fma_f32 v231, v219, v227, v231
  v_cvt_pk_bf16_f32 v240, v228, v229
  v_cvt_pk_bf16_f32 v241, v230, v231
  s_waitcnt lgkmcnt(0)
  v_mfma_f32_16x16x32_bf16 v[196:199], v[164:167], v[156:159], 0
  v_mfma_f32_16x16x32_bf16 v[196:199], v[168:171], v[160:163], v[196:199]
  v_mfma_f32_16x16x32_bf16 v[200:203], v[172:175], v[156:159], 0
  v_mfma_f32_16x16x32_bf16 v[200:203], v[176:179], v[160:163], v[200:203]
  v_cvt_pk_bf16_f32 v212, v204, v205
  v_cvt_pk_bf16_f32 v213, v206, v207
  v_cvt_pk_bf16_f32 v214, v208, v209
  v_cvt_pk_bf16_f32 v215, v210, v211
  v_lshlrev_b32 v216, 16, v212
  v_and_b32 v217, 0xffff0000, v212
  v_lshlrev_b32 v218, 16, v213
  v_and_b32 v219, 0xffff0000, v213
  v_lshlrev_b32 v220, 16, v214
  v_and_b32 v221, 0xffff0000, v214
  v_lshlrev_b32 v222, 16, v215
  v_and_b32 v223, 0xffff0000, v215
  v_pk_add_f32 v[220:221], v[220:221], s[64:65]
  v_pk_add_f32 v[222:223], v[222:223], s[64:65]
  v_cvt_pk_bf16_f32 v214, v220, v221
  v_cvt_pk_bf16_f32 v215, v222, v223
  v_lshlrev_b32 v220, 16, v214
  v_and_b32 v221, 0xffff0000, v214
  v_lshlrev_b32 v222, 16, v215
  v_and_b32 v223, 0xffff0000, v215
  v_rcp_f32 v224, v220
  v_rcp_f32 v225, v221
  v_rcp_f32 v226, v222
  v_rcp_f32 v227, v223
  s_nop 0
  v_pk_mul_f32 v[228:229], v[216:217], v[224:225]
  v_pk_mul_f32 v[230:231], v[218:219], v[226:227]
  v_fma_f32 v216, -v220, v228, v216
  v_fma_f32 v217, -v221, v229, v217
  v_fma_f32 v218, -v222, v230, v218
  v_fma_f32 v219, -v223, v231, v219
  v_fma_f32 v228, v216, v224, v228
  v_fma_f32 v229, v217, v225, v229
  v_fma_f32 v230, v218, v226, v230
  v_fma_f32 v231, v219, v227, v231
  v_cvt_pk_bf16_f32 v242, v228, v229
  v_cvt_pk_bf16_f32 v243, v230, v231
  s_nop 1
  v_permlane16_swap_b32 v240, v242
  v_permlane16_swap_b32 v241, v243
  s_nop 0
  buffer_store_dwordx4 v[240:243], v12, s[48:51], 0 offen offset:1024 sc1
  s_nop 7
  v_cvt_pk_bf16_f32 v212, v196, v197
  v_cvt_pk_bf16_f32 v213, v198, v199
  v_cvt_pk_bf16_f32 v214, v200, v201
  v_cvt_pk_bf16_f32 v215, v202, v203
  v_lshlrev_b32 v216, 16, v212
  v_and_b32 v217, 0xffff0000, v212
  v_lshlrev_b32 v218, 16, v213
  v_and_b32 v219, 0xffff0000, v213
  v_lshlrev_b32 v220, 16, v214
  v_and_b32 v221, 0xffff0000, v214
  v_lshlrev_b32 v222, 16, v215
  v_and_b32 v223, 0xffff0000, v215
  v_pk_add_f32 v[220:221], v[220:221], s[64:65]
  v_pk_add_f32 v[222:223], v[222:223], s[64:65]
  v_cvt_pk_bf16_f32 v214, v220, v221
  v_cvt_pk_bf16_f32 v215, v222, v223
  v_lshlrev_b32 v220, 16, v214
  v_and_b32 v221, 0xffff0000, v214
  v_lshlrev_b32 v222, 16, v215
  v_and_b32 v223, 0xffff0000, v215
  v_rcp_f32 v224, v220
  v_rcp_f32 v225, v221
  v_rcp_f32 v226, v222
  v_rcp_f32 v227, v223
  s_nop 0
  v_pk_mul_f32 v[228:229], v[216:217], v[224:225]
  v_pk_mul_f32 v[230:231], v[218:219], v[226:227]
  v_fma_f32 v216, -v220, v228, v216
  v_fma_f32 v217, -v221, v229, v217
  v_fma_f32 v218, -v222, v230, v218
  v_fma_f32 v219, -v223, v231, v219
  v_fma_f32 v228, v216, v224, v228
  v_fma_f32 v229, v217, v225, v229
  v_fma_f32 v230, v218, v226, v230
  v_fma_f32 v231, v219, v227, v231
  v_cvt_pk_bf16_f32 v244, v228, v229
  v_cvt_pk_bf16_f32 v245, v230, v231
  v_mov_b32 v246, v244
  v_mov_b32 v247, v245
  s_nop 1
  v_permlane16_swap_b32 v244, v246
  v_permlane16_swap_b32 v245, v247
  s_nop 0
  buffer_store_dwordx4 v[244:247], v13, s[48:51], 0 offen offset:2048 sc1
  v_mov_b32 v56, v52
  v_cvt_pk_bf16_f32 v56, v56, v56
  v_lshlrev_b32 v56, 16, v56
  v_mul_f32 v56, 0xbfb8aa3b, v56
  v_exp_f32 v56, v56
  s_nop 0
  v_add_f32 v56, 1.0, v56
  v_rcp_f32 v56, v56
  s_nop 0
  v_cvt_pk_bf16_f32 v56, v56, v56
  v_lshlrev_b32 v56, 16, v56
  v_sub_f32 v57, 1.0, v56
  v_cvt_pk_bf16_f32 v57, v57, v57
  v_lshlrev_b32 v57, 16, v57
  s_lshl_b32 s71, s74, 7
  s_add_u32 s71, s71, 0x11f1000
  s_mov_b32 s77, 0
  ds_read_b128 v[104:107], v8 offset:0
  ds_read_b128 v[64:67], v9 offset:0
  v_mfma_f32_16x16x32_bf16 v[132:135], v[84:87], v[108:111], v[132:135]
  ds_read_b128 v[68:71], v9 offset:1024
  v_mfma_f32_16x16x32_bf16 v[136:139], v[88:91], v[108:111], v[136:139]
  ds_read_b128 v[72:75], v9 offset:2048
  v_mfma_f32_16x16x32_bf16 v[140:143], v[92:95], v[108:111], v[140:143]
  ds_read_b128 v[76:79], v9 offset:3072
  v_mfma_f32_16x16x32_bf16 v[144:147], v[96:99], v[108:111], v[144:147]
  ds_read_b128 v[80:83], v9 offset:4096
  v_mfma_f32_16x16x32_bf16 v[148:151], v[100:103], v[108:111], v[148:151]
  ds_read_b128 v[108:111], v8 offset:4096
  ds_read_b128 v[84:87], v9 offset:5120
  s_waitcnt lgkmcnt(6)
  v_mfma_f32_16x16x32_bf16 v[132:135], v[64:67], v[104:107], v[132:135]
  ds_read_b128 v[88:91], v9 offset:6144
  s_waitcnt lgkmcnt(6)
  v_mfma_f32_16x16x32_bf16 v[136:139], v[68:71], v[104:107], v[136:139]
  ds_read_b128 v[92:95], v9 offset:7168
  s_waitcnt lgkmcnt(6)
  v_mfma_f32_16x16x32_bf16 v[140:143], v[72:75], v[104:107], v[140:143]
  ds_read_b128 v[96:99], v9 offset:8192
  s_waitcnt lgkmcnt(6)
  v_mfma_f32_16x16x32_bf16 v[144:147], v[76:79], v[104:107], v[144:147]
  ds_read_b128 v[100:103], v9 offset:9216
  s_waitcnt lgkmcnt(6)
  v_mfma_f32_16x16x32_bf16 v[148:151], v[80:83], v[104:107], v[148:151]
  s_barrier
  v_add_u32 v8, 18432, v8
  v_add_u32 v9, 18432, v9
  s_cmp_lg_u32 s77, 0
  s_cbranch_scc1 fc_pub20
  s_getreg_b32 s72, hwreg(HW_REG_IB_STS)
  s_and_b32 s72, s72, 0xc0000f
  s_cbranch_scc1 fc_pub20
  v_mov_b32 v58, s71
  v_mov_b32 v59, 1
  s_mov_b64 exec, 1
  buffer_atomic_add v59, v58, s[48:51], 0 offen sc1
  s_mov_b64 exec, -1
  s_mov_b32 s77, 1
fc_pub20:
  ds_read_b128 v[104:107], v8 offset:0
  ds_read_b128 v[64:67], v9 offset:0
  s_waitcnt lgkmcnt(6)
  v_mfma_f32_16x16x32_bf16 v[132:135], v[84:87], v[108:111], v[132:135]
  ds_read_b128 v[68:71], v9 offset:1024
  s_waitcnt lgkmcnt(6)
  v_mfma_f32_16x16x32_bf16 v[136:139], v[88:91], v[108:111], v[136:139]
  ds_read_b128 v[72:75], v9 offset:2048
  s_waitcnt lgkmcnt(6)
  v_mfma_f32_16x16x32_bf16 v[140:143], v[92:95], v[108:111], v[140:143]
  ds_read_b128 v[76:79], v9 offset:3072
  s_waitcnt lgkmcnt(6)
  v_mfma_f32_16x16x32_bf16 v[144:147], v[96:99], v[108:111], v[144:147]
  ds_read_b128 v[80:83], v9 offset:4096
  s_waitcnt lgkmcnt(6)
  v_mfma_f32_16x16x32_bf16 v[148:151], v[100:103], v[108:111], v[148:151]
  ds_read_b128 v[108:111], v8 offset:4096
  ds_read_b128 v[84:87], v9 offset:5120
  s_waitcnt lgkmcnt(6)
  v_mfma_f32_16x16x32_bf16 v[132:135], v[64:67], v[104:107], v[132:135]
  ds_read_b128 v[88:91], v9 offset:6144
  s_waitcnt lgkmcnt(6)
  v_mfma_f32_16x16x32_bf16 v[136:139], v[68:71], v[104:107], v[136:139]
  ds_read_b128 v[92:95], v9 offset:7168
  s_waitcnt lgkmcnt(6)
  v_mfma_f32_16x16x32_bf16 v[140:143], v[72:75], v[104:107], v[140:143]
  ds_read_b128 v[96:99], v9 offset:8192
  s_waitcnt lgkmcnt(6)
  v_mfma_f32_16x16x32_bf16 v[144:147], v[76:79], v[104:107], v[144:147]
  ds_read_b128 v[100:103], v9 offset:9216
  s_waitcnt lgkmcnt(6)
  v_mfma_f32_16x16x32_bf16 v[148:151], v[80:83], v[104:107], v[148:151]
  s_barrier
  v_add_u32 v8, 0xfffe5000, v8
  v_add_u32 v9, 0xfffe5000, v9
  s_cmp_lg_u32 s77, 0
  s_cbranch_scc1 fc_pub21
  s_getreg_b32 s72, hwreg(HW_REG_IB_STS)
  s_and_b32 s72, s72, 0xc0000f
  s_cbranch_scc1 fc_pub21
  v_mov_b32 v58, s71
  v_mov_b32 v59, 1
  s_mov_b64 exec, 1
  buffer_atomic_add v59, v58, s[48:51], 0 offen sc1
  s_mov_b64 exec, -1
  s_mov_b32 s77, 1
fc_pub21:
  ds_read_b128 v[104:107], v8 offset:0
  ds_read_b128 v[64:67], v9 offset:0
  s_waitcnt lgkmcnt(6)
  v_mfma_f32_16x16x32_bf16 v[132:135], v[84:87], v[108:111], v[132:135]
  ds_read_b128 v[68:71], v9 offset:1024
  s_waitcnt lgkmcnt(6)
  v_mfma_f32_16x16x32_bf16 v[136:139], v[88:91], v[108:111], v[136:139]
  ds_read_b128 v[72:75], v9 offset:2048
  s_waitcnt lgkmcnt(6)
  v_mfma_f32_16x16x32_bf16 v[140:143], v[92:95], v[108:111], v[140:143]
  ds_read_b128 v[76:79], v9 offset:3072
  s_waitcnt lgkmcnt(6)
  v_mfma_f32_16x16x32_bf16 v[144:147], v[96:99], v[108:111], v[144:147]
  ds_read_b128 v[80:83], v9 offset:4096
  s_waitcnt lgkmcnt(6)
  v_mfma_f32_16x16x32_bf16 v[148:151], v[100:103], v[108:111], v[148:151]
  ds_read_b128 v[108:111], v8 offset:4096
  ds_read_b128 v[84:87], v9 offset:5120
  s_waitcnt lgkmcnt(6)
  v_mfma_f32_16x16x32_bf16 v[132:135], v[64:67], v[104:107], v[132:135]
  ds_read_b128 v[88:91], v9 offset:6144
  s_waitcnt lgkmcnt(6)
  v_mfma_f32_16x16x32_bf16 v[136:139], v[68:71], v[104:107], v[136:139]
  ds_read_b128 v[92:95], v9 offset:7168
  s_waitcnt lgkmcnt(6)
  v_mfma_f32_16x16x32_bf16 v[140:143], v[72:75], v[104:107], v[140:143]
  ds_read_b128 v[96:99], v9 offset:8192
  s_waitcnt lgkmcnt(6)
  v_mfma_f32_16x16x32_bf16 v[144:147], v[76:79], v[104:107], v[144:147]
  ds_read_b128 v[100:103], v9 offset:9216
  s_waitcnt lgkmcnt(6)
  v_mfma_f32_16x16x32_bf16 v[148:151], v[80:83], v[104:107], v[148:151]
  s_barrier
  v_add_u32 v8, 18432, v8
  v_add_u32 v9, 18432, v9
  s_cmp_lg_u32 s77, 0
  s_cbranch_scc1 fc_pub22
  s_getreg_b32 s72, hwreg(HW_REG_IB_STS)
  s_and_b32 s72, s72, 0xc0000f
  s_cbranch_scc1 fc_pub22
  v_mov_b32 v58, s71
  v_mov_b32 v59, 1
  s_mov_b64 exec, 1
  buffer_atomic_add v59, v58, s[48:51], 0 offen sc1
  s_mov_b64 exec, -1
  s_mov_b32 s77, 1
fc_pub22:
  ds_read_b128 v[104:107], v8 offset:0
  ds_read_b128 v[64:67], v9 offset:0
  s_waitcnt lgkmcnt(6)
  v_mfma_f32_16x16x32_bf16 v[132:135], v[84:87], v[108:111], v[132:135]
  ds_read_b128 v[68:71], v9 offset:1024
  s_waitcnt lgkmcnt(6)
  v_mfma_f32_16x16x32_bf16 v[136:139], v[88:91], v[108:111], v[136:139]
  ds_read_b128 v[72:75], v9 offset:2048
  s_waitcnt lgkmcnt(6)
  v_mfma_f32_16x16x32_bf16 v[140:143], v[92:95], v[108:111], v[140:143]
  ds_read_b128 v[76:79], v9 offset:3072
  s_waitcnt lgkmcnt(6)
  v_mfma_f32_16x16x32_bf16 v[144:147], v[96:99], v[108:111], v[144:147]
  ds_read_b128 v[80:83], v9 offset:4096
  s_waitcnt lgkmcnt(6)
  v_mfma_f32_16x16x32_bf16 v[148:151], v[100:103], v[108:111], v[148:151]
  ds_read_b128 v[108:111], v8 offset:4096
  ds_read_b128 v[84:87], v9 offset:5120
  s_waitcnt lgkmcnt(6)
  v_mfma_f32_16x16x32_bf16 v[132:135], v[64:67], v[104:107], v[132:135]
  ds_read_b128 v[88:91], v9 offset:6144
  s_waitcnt lgkmcnt(6)
  v_mfma_f32_16x16x32_bf16 v[136:139], v[68:71], v[104:107], v[136:139]
  ds_read_b128 v[92:95], v9 offset:7168
  s_waitcnt lgkmcnt(6)
  v_mfma_f32_16x16x32_bf16 v[140:143], v[72:75], v[104:107], v[140:143]
  ds_read_b128 v[96:99], v9 offset:8192
  s_waitcnt lgkmcnt(6)
  v_mfma_f32_16x16x32_bf16 v[144:147], v[76:79], v[104:107], v[144:147]
  ds_read_b128 v[100:103], v9 offset:9216
  s_waitcnt lgkmcnt(6)
  v_mfma_f32_16x16x32_bf16 v[148:151], v[80:83], v[104:107], v[148:151]
  s_barrier
  v_add_u32 v8, 18432, v8
  v_add_u32 v9, 18432, v9
  s_cmp_lg_u32 s77, 0
  s_cbranch_scc1 fc_pub23
  s_getreg_b32 s72, hwreg(HW_REG_IB_STS)
  s_and_b32 s72, s72, 0xc0000f
  s_cbranch_scc1 fc_pub23
  v_mov_b32 v58, s71
  v_mov_b32 v59, 1
  s_mov_b64 exec, 1
  buffer_atomic_add v59, v58, s[48:51], 0 offen sc1
  s_mov_b64 exec, -1
  s_mov_b32 s77, 1
fc_pub23:
  ds_read_b128 v[104:107], v8 offset:0
  ds_read_b128 v[64:67], v9 offset:0
  s_waitcnt lgkmcnt(6)
  v_mfma_f32_16x16x32_bf16 v[132:135], v[84:87], v[108:111], v[132:135]
  ds_read_b128 v[68:71], v9 offset:1024
  s_waitcnt lgkmcnt(6)
  v_mfma_f32_16x16x32_bf16 v[136:139], v[88:91], v[108:111], v[136:139]
  ds_read_b128 v[72:75], v9 offset:2048
  s_waitcnt lgkmcnt(6)
  v_mfma_f32_16x16x32_bf16 v[140:143], v[92:95], v[108:111], v[140:143]
  ds_read_b128 v[76:79], v9 offset:3072
  s_waitcnt lgkmcnt(6)
  v_mfma_f32_16x16x32_bf16 v[144:147], v[96:99], v[108:111], v[144:147]
  ds_read_b128 v[80:83], v9 offset:4096
  s_waitcnt lgkmcnt(6)
  v_mfma_f32_16x16x32_bf16 v[148:151], v[100:103], v[108:111], v[148:151]
  ds_read_b128 v[108:111], v8 offset:4096
  ds_read_b128 v[84:87], v9 offset:5120
  s_waitcnt lgkmcnt(6)
  v_mfma_f32_16x16x32_bf16 v[132:135], v[64:67], v[104:107], v[132:135]
  ds_read_b128 v[88:91], v9 offset:6144
  s_waitcnt lgkmcnt(6)
  v_mfma_f32_16x16x32_bf16 v[136:139], v[68:71], v[104:107], v[136:139]
  ds_read_b128 v[92:95], v9 offset:7168
  s_waitcnt lgkmcnt(6)
  v_mfma_f32_16x16x32_bf16 v[140:143], v[72:75], v[104:107], v[140:143]
  ds_read_b128 v[96:99], v9 offset:8192
  s_waitcnt lgkmcnt(6)
  v_mfma_f32_16x16x32_bf16 v[144:147], v[76:79], v[104:107], v[144:147]
  ds_read_b128 v[100:103], v9 offset:9216
  s_waitcnt lgkmcnt(6)
  v_mfma_f32_16x16x32_bf16 v[148:151], v[80:83], v[104:107], v[148:151]
  s_barrier
  v_add_u32 v8, 18432, v8
  v_add_u32 v9, 18432, v9
  s_cmp_lg_u32 s77, 0
  s_cbranch_scc1 fc_pub24
  s_getreg_b32 s72, hwreg(HW_REG_IB_STS)
  s_and_b32 s72, s72, 0xc0000f
  s_cbranch_scc1 fc_pub24
  v_mov_b32 v58, s71
  v_mov_b32 v59, 1
  s_mov_b64 exec, 1
  buffer_atomic_add v59, v58, s[48:51], 0 offen sc1
  s_mov_b64 exec, -1
  s_mov_b32 s77, 1
fc_pub24:
  ds_read_b128 v[104:107], v8 offset:0
  ds_read_b128 v[64:67], v9 offset:0
  s_waitcnt lgkmcnt(6)
  v_mfma_f32_16x16x32_bf16 v[132:135], v[84:87], v[108:111], v[132:135]
  ds_read_b128 v[68:71], v9 offset:1024
  s_waitcnt lgkmcnt(6)
  v_mfma_f32_16x16x32_bf16 v[136:139], v[88:91], v[108:111], v[136:139]
  ds_read_b128 v[72:75], v9 offset:2048
  s_waitcnt lgkmcnt(6)
  v_mfma_f32_16x16x32_bf16 v[140:143], v[92:95], v[108:111], v[140:143]
  ds_read_b128 v[76:79], v9 offset:3072
  s_waitcnt lgkmcnt(6)
  v_mfma_f32_16x16x32_bf16 v[144:147], v[96:99], v[108:111], v[144:147]
  ds_read_b128 v[80:83], v9 offset:4096
  s_waitcnt lgkmcnt(6)
  v_mfma_f32_16x16x32_bf16 v[148:151], v[100:103], v[108:111], v[148:151]
  ds_read_b128 v[108:111], v8 offset:4096
  ds_read_b128 v[84:87], v9 offset:5120
  s_waitcnt lgkmcnt(6)
  v_mfma_f32_16x16x32_bf16 v[132:135], v[64:67], v[104:107], v[132:135]
  ds_read_b128 v[88:91], v9 offset:6144
  s_waitcnt lgkmcnt(6)
  v_mfma_f32_16x16x32_bf16 v[136:139], v[68:71], v[104:107], v[136:139]
  ds_read_b128 v[92:95], v9 offset:7168
  s_waitcnt lgkmcnt(6)
  v_mfma_f32_16x16x32_bf16 v[140:143], v[72:75], v[104:107], v[140:143]
  ds_read_b128 v[96:99], v9 offset:8192
  s_waitcnt lgkmcnt(6)
  v_mfma_f32_16x16x32_bf16 v[144:147], v[76:79], v[104:107], v[144:147]
  ds_read_b128 v[100:103], v9 offset:9216
  s_waitcnt lgkmcnt(6)
  v_mfma_f32_16x16x32_bf16 v[148:151], v[80:83], v[104:107], v[148:151]
  s_barrier
  v_add_u32 v8, 18432, v8
  v_add_u32 v9, 18432, v9
  s_cmp_lg_u32 s77, 0
  s_cbranch_scc1 fc_pub25
  s_getreg_b32 s72, hwreg(HW_REG_IB_STS)
  s_and_b32 s72, s72, 0xc0000f
  s_cbranch_scc1 fc_pub25
  v_mov_b32 v58, s71
  v_mov_b32 v59, 1
  s_mov_b64 exec, 1
  buffer_atomic_add v59, v58, s[48:51], 0 offen sc1
  s_mov_b64 exec, -1
  s_mov_b32 s77, 1
fc_pub25:
  ds_read_b128 v[104:107], v8 offset:0
  ds_read_b128 v[64:67], v9 offset:0
  s_waitcnt lgkmcnt(6)
  v_mfma_f32_16x16x32_bf16 v[132:135], v[84:87], v[108:111], v[132:135]
  ds_read_b128 v[68:71], v9 offset:1024
  s_waitcnt lgkmcnt(6)
  v_mfma_f32_16x16x32_bf16 v[136:139], v[88:91], v[108:111], v[136:139]
  ds_read_b128 v[72:75], v9 offset:2048
  s_waitcnt lgkmcnt(6)
  v_mfma_f32_16x16x32_bf16 v[140:143], v[92:95], v[108:111], v[140:143]
  ds_read_b128 v[76:79], v9 offset:3072
  s_waitcnt lgkmcnt(6)
  v_mfma_f32_16x16x32_bf16 v[144:147], v[96:99], v[108:111], v[144:147]
  ds_read_b128 v[80:83], v9 offset:4096
  s_waitcnt lgkmcnt(6)
  v_mfma_f32_16x16x32_bf16 v[148:151], v[100:103], v[108:111], v[148:151]
  ds_read_b128 v[108:111], v8 offset:4096
  ds_read_b128 v[84:87], v9 offset:5120
  s_waitcnt lgkmcnt(6)
  v_mfma_f32_16x16x32_bf16 v[132:135], v[64:67], v[104:107], v[132:135]
  ds_read_b128 v[88:91], v9 offset:6144
  s_waitcnt lgkmcnt(6)
  v_mfma_f32_16x16x32_bf16 v[136:139], v[68:71], v[104:107], v[136:139]
  ds_read_b128 v[92:95], v9 offset:7168
  s_waitcnt lgkmcnt(6)
  v_mfma_f32_16x16x32_bf16 v[140:143], v[72:75], v[104:107], v[140:143]
  ds_read_b128 v[96:99], v9 offset:8192
  s_waitcnt lgkmcnt(6)
  v_mfma_f32_16x16x32_bf16 v[144:147], v[76:79], v[104:107], v[144:147]
  ds_read_b128 v[100:103], v9 offset:9216
  s_waitcnt lgkmcnt(6)
  v_mfma_f32_16x16x32_bf16 v[148:151], v[80:83], v[104:107], v[148:151]
  s_barrier
  v_add_u32 v8, 18432, v8
  v_add_u32 v9, 18432, v9
  s_cmp_lg_u32 s77, 0
  s_cbranch_scc1 fc_pub26
  s_getreg_b32 s72, hwreg(HW_REG_IB_STS)
  s_and_b32 s72, s72, 0xc0000f
  s_cbranch_scc1 fc_pub26
  v_mov_b32 v58, s71
  v_mov_b32 v59, 1
  s_mov_b64 exec, 1
  buffer_atomic_add v59, v58, s[48:51], 0 offen sc1
  s_mov_b64 exec, -1
  s_mov_b32 s77, 1
fc_pub26:
  ds_read_b128 v[104:107], v8 offset:0
  ds_read_b128 v[64:67], v9 offset:0
  s_waitcnt lgkmcnt(6)
  v_mfma_f32_16x16x32_bf16 v[132:135], v[84:87], v[108:111], v[132:135]
  ds_read_b128 v[68:71], v9 offset:1024
  s_waitcnt lgkmcnt(6)
  v_mfma_f32_16x16x32_bf16 v[136:139], v[88:91], v[108:111], v[136:139]
  ds_read_b128 v[72:75], v9 offset:2048
  s_waitcnt lgkmcnt(6)
  v_mfma_f32_16x16x32_bf16 v[140:143], v[92:95], v[108:111], v[140:143]
  ds_read_b128 v[76:79], v9 offset:3072
  s_waitcnt lgkmcnt(6)
  v_mfma_f32_16x16x32_bf16 v[144:147], v[96:99], v[108:111], v[144:147]
  ds_read_b128 v[80:83], v9 offset:4096
  s_waitcnt lgkmcnt(6)
  v_mfma_f32_16x16x32_bf16 v[148:151], v[100:103], v[108:111], v[148:151]
  ds_read_b128 v[108:111], v8 offset:4096
  ds_read_b128 v[84:87], v9 offset:5120
  s_waitcnt lgkmcnt(6)
  v_mfma_f32_16x16x32_bf16 v[132:135], v[64:67], v[104:107], v[132:135]
  ds_read_b128 v[88:91], v9 offset:6144
  s_waitcnt lgkmcnt(6)
  v_mfma_f32_16x16x32_bf16 v[136:139], v[68:71], v[104:107], v[136:139]
  ds_read_b128 v[92:95], v9 offset:7168
  s_waitcnt lgkmcnt(6)
  v_mfma_f32_16x16x32_bf16 v[140:143], v[72:75], v[104:107], v[140:143]
  ds_read_b128 v[96:99], v9 offset:8192
  s_waitcnt lgkmcnt(6)
  v_mfma_f32_16x16x32_bf16 v[144:147], v[76:79], v[104:107], v[144:147]
  ds_read_b128 v[100:103], v9 offset:9216
  s_waitcnt lgkmcnt(6)
  v_mfma_f32_16x16x32_bf16 v[148:151], v[80:83], v[104:107], v[148:151]
  s_barrier
  v_add_u32 v8, 18432, v8
  v_add_u32 v9, 18432, v9
  s_cmp_lg_u32 s77, 0
  s_cbranch_scc1 fc_pub27
  s_waitcnt vmcnt(0)
  v_mov_b32 v58, s71
  v_mov_b32 v59, 1
  s_mov_b64 exec, 1
  buffer_atomic_add v59, v58, s[48:51], 0 offen sc1
  s_mov_b64 exec, -1
  s_mov_b32 s77, 1
fc_pub27:
  ds_read_b128 v[104:107], v8 offset:0
  ds_read_b128 v[64:67], v9 offset:0
  s_waitcnt lgkmcnt(6)
  v_mfma_f32_16x16x32_bf16 v[132:135], v[84:87], v[108:111], v[132:135]
  ds_read_b128 v[68:71], v9 offset:1024
  s_waitcnt lgkmcnt(6)
  v_mfma_f32_16x16x32_bf16 v[136:139], v[88:91], v[108:111], v[136:139]
  ds_read_b128 v[72:75], v9 offset:2048
  s_waitcnt lgkmcnt(6)
  v_mfma_f32_16x16x32_bf16 v[140:143], v[92:95], v[108:111], v[140:143]
  ds_read_b128 v[76:79], v9 offset:3072
  s_waitcnt lgkmcnt(6)
  v_mfma_f32_16x16x32_bf16 v[144:147], v[96:99], v[108:111], v[144:147]
  ds_read_b128 v[80:83], v9 offset:4096
  s_waitcnt lgkmcnt(6)
  v_mfma_f32_16x16x32_bf16 v[148:151], v[100:103], v[108:111], v[148:151]
  ds_read_b128 v[108:111], v8 offset:4096
  ds_read_b128 v[84:87], v9 offset:5120
  s_waitcnt lgkmcnt(6)
  v_mfma_f32_16x16x32_bf16 v[132:135], v[64:67], v[104:107], v[132:135]
  ds_read_b128 v[88:91], v9 offset:6144
  s_waitcnt lgkmcnt(6)
  v_mfma_f32_16x16x32_bf16 v[136:139], v[68:71], v[104:107], v[136:139]
  ds_read_b128 v[92:95], v9 offset:7168
  s_waitcnt lgkmcnt(6)
  v_mfma_f32_16x16x32_bf16 v[140:143], v[72:75], v[104:107], v[140:143]
  ds_read_b128 v[96:99], v9 offset:8192
  s_waitcnt lgkmcnt(6)
  v_mfma_f32_16x16x32_bf16 v[144:147], v[76:79], v[104:107], v[144:147]
  ds_read_b128 v[100:103], v9 offset:9216
  s_waitcnt lgkmcnt(6)
  v_mfma_f32_16x16x32_bf16 v[148:151], v[80:83], v[104:107], v[148:151]
  s_barrier
  v_add_u32 v8, 0xfffe5000, v8
  v_add_u32 v9, 0xfffe5000, v9
  ds_read_b128 v[104:107], v8 offset:0
  ds_read_b128 v[64:67], v9 offset:0
  s_waitcnt lgkmcnt(6)
  v_mfma_f32_16x16x32_bf16 v[132:135], v[84:87], v[108:111], v[132:135]
  ds_read_b128 v[68:71], v9 offset:1024
  s_waitcnt lgkmcnt(6)
  v_mfma_f32_16x16x32_bf16 v[136:139], v[88:91], v[108:111], v[136:139]
  ds_read_b128 v[72:75], v9 offset:2048
  s_waitcnt lgkmcnt(6)
  v_mfma_f32_16x16x32_bf16 v[140:143], v[92:95], v[108:111], v[140:143]
  ds_read_b128 v[76:79], v9 offset:3072
  s_waitcnt lgkmcnt(6)
  v_mfma_f32_16x16x32_bf16 v[144:147], v[96:99], v[108:111], v[144:147]
  ds_read_b128 v[80:83], v9 offset:4096
  s_waitcnt lgkmcnt(6)
  v_mfma_f32_16x16x32_bf16 v[148:151], v[100:103], v[108:111], v[148:151]
  ds_read_b128 v[108:111], v8 offset:4096
  ds_read_b128 v[84:87], v9 offset:5120
  s_waitcnt lgkmcnt(6)
  v_mfma_f32_16x16x32_bf16 v[132:135], v[64:67], v[104:107], v[132:135]
  ds_read_b128 v[88:91], v9 offset:6144
  s_waitcnt lgkmcnt(6)
  v_mfma_f32_16x16x32_bf16 v[136:139], v[68:71], v[104:107], v[136:139]
  ds_read_b128 v[92:95], v9 offset:7168
  s_waitcnt lgkmcnt(6)
  v_mfma_f32_16x16x32_bf16 v[140:143], v[72:75], v[104:107], v[140:143]
  ds_read_b128 v[96:99], v9 offset:8192
  s_waitcnt lgkmcnt(6)
  v_mfma_f32_16x16x32_bf16 v[144:147], v[76:79], v[104:107], v[144:147]
  ds_read_b128 v[100:103], v9 offset:9216
  s_waitcnt lgkmcnt(6)
  v_mfma_f32_16x16x32_bf16 v[148:151], v[80:83], v[104:107], v[148:151]
  s_barrier
  v_add_u32 v8, 18432, v8
  v_add_u32 v9, 18432, v9
  ds_read_b128 v[104:107], v8 offset:0
  ds_read_b128 v[64:67], v9 offset:0
  s_waitcnt lgkmcnt(6)
  v_mfma_f32_16x16x32_bf16 v[132:135], v[84:87], v[108:111], v[132:135]
  ds_read_b128 v[68:71], v9 offset:1024
  s_waitcnt lgkmcnt(6)
  v_mfma_f32_16x16x32_bf16 v[136:139], v[88:91], v[108:111], v[136:139]
  ds_read_b128 v[72:75], v9 offset:2048
  s_waitcnt lgkmcnt(6)
  v_mfma_f32_16x16x32_bf16 v[140:143], v[92:95], v[108:111], v[140:143]
  ds_read_b128 v[76:79], v9 offset:3072
  s_waitcnt lgkmcnt(6)
  v_mfma_f32_16x16x32_bf16 v[144:147], v[96:99], v[108:111], v[144:147]
  ds_read_b128 v[80:83], v9 offset:4096
  s_waitcnt lgkmcnt(6)
  v_mfma_f32_16x16x32_bf16 v[148:151], v[100:103], v[108:111], v[148:151]
  ds_read_b128 v[108:111], v8 offset:4096
  ds_read_b128 v[84:87], v9 offset:5120
  s_waitcnt lgkmcnt(6)
  v_mfma_f32_16x16x32_bf16 v[132:135], v[64:67], v[104:107], v[132:135]
  ds_read_b128 v[88:91], v9 offset:6144
  s_waitcnt lgkmcnt(6)
  v_mfma_f32_16x16x32_bf16 v[136:139], v[68:71], v[104:107], v[136:139]
  ds_read_b128 v[92:95], v9 offset:7168
  s_waitcnt lgkmcnt(6)
  v_mfma_f32_16x16x32_bf16 v[140:143], v[72:75], v[104:107], v[140:143]
  ds_read_b128 v[96:99], v9 offset:8192
  s_waitcnt lgkmcnt(6)
  v_mfma_f32_16x16x32_bf16 v[144:147], v[76:79], v[104:107], v[144:147]
  ds_read_b128 v[100:103], v9 offset:9216
  s_waitcnt lgkmcnt(6)
  v_mfma_f32_16x16x32_bf16 v[148:151], v[80:83], v[104:107], v[148:151]
  s_barrier
  v_add_u32 v8, 18432, v8
  v_add_u32 v9, 18432, v9
  ds_read_b128 v[104:107], v8 offset:0
  ds_read_b128 v[64:67], v9 offset:0
  s_waitcnt lgkmcnt(6)
  v_mfma_f32_16x16x32_bf16 v[132:135], v[84:87], v[108:111], v[132:135]
  ds_read_b128 v[68:71], v9 offset:1024
  s_waitcnt lgkmcnt(6)
  v_mfma_f32_16x16x32_bf16 v[136:139], v[88:91], v[108:111], v[136:139]
  ds_read_b128 v[72:75], v9 offset:2048
  s_waitcnt lgkmcnt(6)
  v_mfma_f32_16x16x32_bf16 v[140:143], v[92:95], v[108:111], v[140:143]
  ds_read_b128 v[76:79], v9 offset:3072
  s_waitcnt lgkmcnt(6)
  v_mfma_f32_16x16x32_bf16 v[144:147], v[96:99], v[108:111], v[144:147]
  ds_read_b128 v[80:83], v9 offset:4096
  s_waitcnt lgkmcnt(6)
  v_mfma_f32_16x16x32_bf16 v[148:151], v[100:103], v[108:111], v[148:151]
  ds_read_b128 v[108:111], v8 offset:4096
  ds_read_b128 v[84:87], v9 offset:5120
  s_waitcnt lgkmcnt(6)
  v_mfma_f32_16x16x32_bf16 v[132:135], v[64:67], v[104:107], v[132:135]
  ds_read_b128 v[88:91], v9 offset:6144
  s_waitcnt lgkmcnt(6)
  v_mfma_f32_16x16x32_bf16 v[136:139], v[68:71], v[104:107], v[136:139]
  ds_read_b128 v[92:95], v9 offset:7168
  s_waitcnt lgkmcnt(6)
  v_mfma_f32_16x16x32_bf16 v[140:143], v[72:75], v[104:107], v[140:143]
  ds_read_b128 v[96:99], v9 offset:8192
  s_waitcnt lgkmcnt(6)
  v_mfma_f32_16x16x32_bf16 v[144:147], v[76:79], v[104:107], v[144:147]
  ds_read_b128 v[100:103], v9 offset:9216
  s_waitcnt lgkmcnt(6)
  v_mfma_f32_16x16x32_bf16 v[148:151], v[80:83], v[104:107], v[148:151]
  s_barrier
  v_add_u32 v8, 18432, v8
  v_add_u32 v9, 18432, v9
  ds_read_b128 v[104:107], v8 offset:0
  ds_read_b128 v[64:67], v9 offset:0
  s_waitcnt lgkmcnt(6)
  v_mfma_f32_16x16x32_bf16 v[132:135], v[84:87], v[108:111], v[132:135]
  ds_read_b128 v[68:71], v9 offset:1024
  s_waitcnt lgkmcnt(6)
  v_mfma_f32_16x16x32_bf16 v[136:139], v[88:91], v[108:111], v[136:139]
  ds_read_b128 v[72:75], v9 offset:2048
  s_waitcnt lgkmcnt(6)
  v_mfma_f32_16x16x32_bf16 v[140:143], v[92:95], v[108:111], v[140:143]
  ds_read_b128 v[76:79], v9 offset:3072
  s_waitcnt lgkmcnt(6)
  v_mfma_f32_16x16x32_bf16 v[144:147], v[96:99], v[108:111], v[144:147]
  ds_read_b128 v[80:83], v9 offset:4096
  s_waitcnt lgkmcnt(6)
  v_mfma_f32_16x16x32_bf16 v[148:151], v[100:103], v[108:111], v[148:151]
  ds_read_b128 v[108:111], v8 offset:4096
  ds_read_b128 v[84:87], v9 offset:5120
  s_waitcnt lgkmcnt(6)
  v_mfma_f32_16x16x32_bf16 v[132:135], v[64:67], v[104:107], v[132:135]
  ds_read_b128 v[88:91], v9 offset:6144
  s_waitcnt lgkmcnt(6)
  v_mfma_f32_16x16x32_bf16 v[136:139], v[68:71], v[104:107], v[136:139]
  ds_read_b128 v[92:95], v9 offset:7168
  s_waitcnt lgkmcnt(6)
  v_mfma_f32_16x16x32_bf16 v[140:143], v[72:75], v[104:107], v[140:143]
  ds_read_b128 v[96:99], v9 offset:8192
  s_waitcnt lgkmcnt(6)
  v_mfma_f32_16x16x32_bf16 v[144:147], v[76:79], v[104:107], v[144:147]
  ds_read_b128 v[100:103], v9 offset:9216
  s_waitcnt lgkmcnt(6)
  v_mfma_f32_16x16x32_bf16 v[148:151], v[80:83], v[104:107], v[148:151]
  s_barrier
  v_add_u32 v8, 18432, v8
  v_add_u32 v9, 18432, v9
  ds_read_b128 v[104:107], v8 offset:0
  ds_read_b128 v[64:67], v9 offset:0
  s_waitcnt lgkmcnt(6)
  v_mfma_f32_16x16x32_bf16 v[132:135], v[84:87], v[108:111], v[132:135]
  ds_read_b128 v[68:71], v9 offset:1024
  s_waitcnt lgkmcnt(6)
  v_mfma_f32_16x16x32_bf16 v[136:139], v[88:91], v[108:111], v[136:139]
  ds_read_b128 v[72:75], v9 offset:2048
  s_waitcnt lgkmcnt(6)
  v_mfma_f32_16x16x32_bf16 v[140:143], v[92:95], v[108:111], v[140:143]
  ds_read_b128 v[76:79], v9 offset:3072
  s_waitcnt lgkmcnt(6)
  v_mfma_f32_16x16x32_bf16 v[144:147], v[96:99], v[108:111], v[144:147]
  ds_read_b128 v[80:83], v9 offset:4096
  s_waitcnt lgkmcnt(6)
  v_mfma_f32_16x16x32_bf16 v[148:151], v[100:103], v[108:111], v[148:151]
  ds_read_b128 v[108:111], v8 offset:4096
  ds_read_b128 v[84:87], v9 offset:5120
  s_waitcnt lgkmcnt(6)
  v_mfma_f32_16x16x32_bf16 v[132:135], v[64:67], v[104:107], v[132:135]
  ds_read_b128 v[88:91], v9 offset:6144
  s_waitcnt lgkmcnt(6)
  v_mfma_f32_16x16x32_bf16 v[136:139], v[68:71], v[104:107], v[136:139]
  ds_read_b128 v[92:95], v9 offset:7168
  s_waitcnt lgkmcnt(6)
  v_mfma_f32_16x16x32_bf16 v[140:143], v[72:75], v[104:107], v[140:143]
  ds_read_b128 v[96:99], v9 offset:8192
  s_waitcnt lgkmcnt(6)
  v_mfma_f32_16x16x32_bf16 v[144:147], v[76:79], v[104:107], v[144:147]
  ds_read_b128 v[100:103], v9 offset:9216
  s_waitcnt lgkmcnt(6)
  v_mfma_f32_16x16x32_bf16 v[148:151], v[80:83], v[104:107], v[148:151]
  s_barrier
  v_add_u32 v8, 18432, v8
  v_add_u32 v9, 18432, v9
  ds_read_b128 v[104:107], v8 offset:0
  ds_read_b128 v[64:67], v9 offset:0
  s_waitcnt lgkmcnt(6)
  v_mfma_f32_16x16x32_bf16 v[132:135], v[84:87], v[108:111], v[132:135]
  ds_read_b128 v[68:71], v9 offset:1024
  s_waitcnt lgkmcnt(6)
  v_mfma_f32_16x16x32_bf16 v[136:139], v[88:91], v[108:111], v[136:139]
  ds_read_b128 v[72:75], v9 offset:2048
  s_waitcnt lgkmcnt(6)
  v_mfma_f32_16x16x32_bf16 v[140:143], v[92:95], v[108:111], v[140:143]
  ds_read_b128 v[76:79], v9 offset:3072
  s_waitcnt lgkmcnt(6)
  v_mfma_f32_16x16x32_bf16 v[144:147], v[96:99], v[108:111], v[144:147]
  ds_read_b128 v[80:83], v9 offset:4096
  s_waitcnt lgkmcnt(6)
  v_mfma_f32_16x16x32_bf16 v[148:151], v[100:103], v[108:111], v[148:151]
  ds_read_b128 v[108:111], v8 offset:4096
  ds_read_b128 v[84:87], v9 offset:5120
  s_waitcnt lgkmcnt(6)
  v_mfma_f32_16x16x32_bf16 v[132:135], v[64:67], v[104:107], v[132:135]
  ds_read_b128 v[88:91], v9 offset:6144
  s_waitcnt lgkmcnt(6)
  v_mfma_f32_16x16x32_bf16 v[136:139], v[68:71], v[104:107], v[136:139]
  ds_read_b128 v[92:95], v9 offset:7168
  s_waitcnt lgkmcnt(6)
  v_mfma_f32_16x16x32_bf16 v[140:143], v[72:75], v[104:107], v[140:143]
  ds_read_b128 v[96:99], v9 offset:8192
  s_waitcnt lgkmcnt(6)
  v_mfma_f32_16x16x32_bf16 v[144:147], v[76:79], v[104:107], v[144:147]
  ds_read_b128 v[100:103], v9 offset:9216
  s_waitcnt lgkmcnt(6)
  v_mfma_f32_16x16x32_bf16 v[148:151], v[80:83], v[104:107], v[148:151]
  s_barrier
  v_add_u32 v8, 18432, v8
  v_add_u32 v9, 18432, v9
  ds_read_b128 v[104:107], v8 offset:0
  ds_read_b128 v[64:67], v9 offset:0
  s_waitcnt lgkmcnt(6)
  v_mfma_f32_16x16x32_bf16 v[132:135], v[84:87], v[108:111], v[132:135]
  ds_read_b128 v[68:71], v9 offset:1024
  s_waitcnt lgkmcnt(6)
  v_mfma_f32_16x16x32_bf16 v[136:139], v[88:91], v[108:111], v[136:139]
  ds_read_b128 v[72:75], v9 offset:2048
  s_waitcnt lgkmcnt(6)
  v_mfma_f32_16x16x32_bf16 v[140:143], v[92:95], v[108:111], v[140:143]
  ds_read_b128 v[76:79], v9 offset:3072
  s_waitcnt lgkmcnt(6)
  v_mfma_f32_16x16x32_bf16 v[144:147], v[96:99], v[108:111], v[144:147]
  ds_read_b128 v[80:83], v9 offset:4096
  s_waitcnt lgkmcnt(6)
  v_mfma_f32_16x16x32_bf16 v[148:151], v[100:103], v[108:111], v[148:151]
  ds_read_b128 v[108:111], v8 offset:4096
  ds_read_b128 v[84:87], v9 offset:5120
  s_waitcnt lgkmcnt(6)
  v_mfma_f32_16x16x32_bf16 v[112:115], v[64:67], v[104:107], 0
  ds_read_b128 v[88:91], v9 offset:6144
  s_waitcnt lgkmcnt(6)
  v_mfma_f32_16x16x32_bf16 v[116:119], v[68:71], v[104:107], 0
  ds_read_b128 v[92:95], v9 offset:7168
  s_waitcnt lgkmcnt(6)
  v_mfma_f32_16x16x32_bf16 v[120:123], v[72:75], v[104:107], 0
  ds_read_b128 v[96:99], v9 offset:8192
  s_waitcnt lgkmcnt(6)
  v_mfma_f32_16x16x32_bf16 v[124:127], v[76:79], v[104:107], 0
  ds_read_b128 v[100:103], v9 offset:9216
  s_waitcnt lgkmcnt(6)
  v_mfma_f32_16x16x32_bf16 v[128:131], v[80:83], v[104:107], 0
  s_barrier
  v_add_u32 v8, 0xfffe5000, v8
  v_add_u32 v9, 0xfffe5000, v9
  ds_read_b128 v[104:107], v8 offset:0
  ds_read_b128 v[64:67], v9 offset:0
  s_waitcnt lgkmcnt(6)
  v_mfma_f32_16x16x32_bf16 v[112:115], v[84:87], v[108:111], v[112:115]
  ds_read_b128 v[68:71], v9 offset:1024
  s_waitcnt lgkmcnt(6)
  v_mfma_f32_16x16x32_bf16 v[116:119], v[88:91], v[108:111], v[116:119]
  ds_read_b128 v[72:75], v9 offset:2048
  s_waitcnt lgkmcnt(6)
  v_mfma_f32_16x16x32_bf16 v[120:123], v[92:95], v[108:111], v[120:123]
  ds_read_b128 v[76:79], v9 offset:3072
  s_waitcnt lgkmcnt(6)
  v_mfma_f32_16x16x32_bf16 v[124:127], v[96:99], v[108:111], v[124:127]
  ds_read_b128 v[80:83], v9 offset:4096
  s_waitcnt lgkmcnt(6)
  v_mfma_f32_16x16x32_bf16 v[128:131], v[100:103], v[108:111], v[128:131]
  s_mul_i32 s12, s75, 160
  v_lshl_add_u32 v28, v3, 3, s12
  buffer_load_dwordx2 v[240:241], v28, s[40:43], 0 offen offset:0
  buffer_load_dwordx2 v[242:243], v28, s[40:43], 0 offen offset:32
  buffer_load_dwordx2 v[244:245], v28, s[40:43], 0 offen offset:64
  buffer_load_dwordx2 v[246:247], v28, s[40:43], 0 offen offset:96
  buffer_load_dwordx2 v[248:249], v28, s[40:43], 0 offen offset:128
  ds_read_b128 v[108:111], v8 offset:4096
  ds_read_b128 v[84:87], v9 offset:5120
  s_waitcnt lgkmcnt(6)
  v_mfma_f32_16x16x32_bf16 v[112:115], v[64:67], v[104:107], v[112:115]
  ds_read_b128 v[88:91], v9 offset:6144
  s_waitcnt lgkmcnt(6)
  v_mfma_f32_16x16x32_bf16 v[116:119], v[68:71], v[104:107], v[116:119]
  ds_read_b128 v[92:95], v9 offset:7168
  s_waitcnt lgkmcnt(6)
  v_mfma_f32_16x16x32_bf16 v[120:123], v[72:75], v[104:107], v[120:123]
  ds_read_b128 v[96:99], v9 offset:8192
  s_waitcnt lgkmcnt(6)
  v_mfma_f32_16x16x32_bf16 v[124:127], v[76:79], v[104:107], v[124:127]
  ds_read_b128 v[100:103], v9 offset:9216
  s_waitcnt lgkmcnt(6)
  v_mfma_f32_16x16x32_bf16 v[128:131], v[80:83], v[104:107], v[128:131]
  s_barrier
  v_add_u32 v8, 18432, v8
  v_add_u32 v9, 18432, v9
  ds_read_b128 v[104:107], v8 offset:0
  ds_read_b128 v[64:67], v9 offset:0
  s_waitcnt lgkmcnt(6)
  v_mfma_f32_16x16x32_bf16 v[112:115], v[84:87], v[108:111], v[112:115]
  ds_read_b128 v[68:71], v9 offset:1024
  s_waitcnt lgkmcnt(6)
  v_mfma_f32_16x16x32_bf16 v[116:119], v[88:91], v[108:111], v[116:119]
  ds_read_b128 v[72:75], v9 offset:2048
  s_waitcnt lgkmcnt(6)
  v_mfma_f32_16x16x32_bf16 v[120:123], v[92:95], v[108:111], v[120:123]
  ds_read_b128 v[76:79], v9 offset:3072
  s_waitcnt lgkmcnt(6)
  v_mfma_f32_16x16x32_bf16 v[124:127], v[96:99], v[108:111], v[124:127]
  ds_read_b128 v[80:83], v9 offset:4096
  s_waitcnt lgkmcnt(6)
  v_mfma_f32_16x16x32_bf16 v[128:131], v[100:103], v[108:111], v[128:131]
  ds_read_b128 v[108:111], v8 offset:4096
  ds_read_b128 v[84:87], v9 offset:5120
  s_waitcnt lgkmcnt(6)
  v_mfma_f32_16x16x32_bf16 v[112:115], v[64:67], v[104:107], v[112:115]
  ds_read_b128 v[88:91], v9 offset:6144
  s_waitcnt lgkmcnt(6)
  v_mfma_f32_16x16x32_bf16 v[116:119], v[68:71], v[104:107], v[116:119]
  ds_read_b128 v[92:95], v9 offset:7168
  s_waitcnt lgkmcnt(6)
  v_mfma_f32_16x16x32_bf16 v[120:123], v[72:75], v[104:107], v[120:123]
  ds_read_b128 v[96:99], v9 offset:8192
  s_waitcnt lgkmcnt(6)
  v_mfma_f32_16x16x32_bf16 v[124:127], v[76:79], v[104:107], v[124:127]
  ds_read_b128 v[100:103], v9 offset:9216
  s_waitcnt lgkmcnt(6)
  v_mfma_f32_16x16x32_bf16 v[128:131], v[80:83], v[104:107], v[128:131]
  s_barrier
  v_add_u32 v8, 18432, v8
  v_add_u32 v9, 18432, v9
  ds_read_b128 v[104:107], v8 offset:0
  ds_read_b128 v[64:67], v9 offset:0
  s_waitcnt lgkmcnt(6)
  v_mfma_f32_16x16x32_bf16 v[112:115], v[84:87], v[108:111], v[112:115]
  ds_read_b128 v[68:71], v9 offset:1024
  s_waitcnt lgkmcnt(6)
  v_mfma_f32_16x16x32_bf16 v[116:119], v[88:91], v[108:111], v[116:119]
  ds_read_b128 v[72:75], v9 offset:2048
  s_waitcnt lgkmcnt(6)
  v_mfma_f32_16x16x32_bf16 v[120:123], v[92:95], v[108:111], v[120:123]
  ds_read_b128 v[76:79], v9 offset:3072
  s_waitcnt lgkmcnt(6)
  v_mfma_f32_16x16x32_bf16 v[124:127], v[96:99], v[108:111], v[124:127]
  ds_read_b128 v[80:83], v9 offset:4096
  s_waitcnt lgkmcnt(6)
  v_mfma_f32_16x16x32_bf16 v[128:131], v[100:103], v[108:111], v[128:131]
  ds_read_b128 v[108:111], v8 offset:4096
  ds_read_b128 v[84:87], v9 offset:5120
  s_waitcnt lgkmcnt(6)
  v_mfma_f32_16x16x32_bf16 v[112:115], v[64:67], v[104:107], v[112:115]
  ds_read_b128 v[88:91], v9 offset:6144
  s_waitcnt lgkmcnt(6)
  v_mfma_f32_16x16x32_bf16 v[116:119], v[68:71], v[104:107], v[116:119]
  ds_read_b128 v[92:95], v9 offset:7168
  s_waitcnt lgkmcnt(6)
  v_mfma_f32_16x16x32_bf16 v[120:123], v[72:75], v[104:107], v[120:123]
  ds_read_b128 v[96:99], v9 offset:8192
  s_waitcnt lgkmcnt(6)
  v_mfma_f32_16x16x32_bf16 v[124:127], v[76:79], v[104:107], v[124:127]
  ds_read_b128 v[100:103], v9 offset:9216
  s_waitcnt lgkmcnt(6)
  v_mfma_f32_16x16x32_bf16 v[128:131], v[80:83], v[104:107], v[128:131]
  s_barrier
  v_add_u32 v8, 18432, v8
  v_add_u32 v9, 18432, v9
  ds_read_b128 v[104:107], v8 offset:0
  ds_read_b128 v[64:67], v9 offset:0
  s_waitcnt lgkmcnt(6)
  v_mfma_f32_16x16x32_bf16 v[112:115], v[84:87], v[108:111], v[112:115]
  ds_read_b128 v[68:71], v9 offset:1024
  s_waitcnt lgkmcnt(6)
  v_mfma_f32_16x16x32_bf16 v[116:119], v[88:91], v[108:111], v[116:119]
  ds_read_b128 v[72:75], v9 offset:2048
  s_waitcnt lgkmcnt(6)
  v_mfma_f32_16x16x32_bf16 v[120:123], v[92:95], v[108:111], v[120:123]
  ds_read_b128 v[76:79], v9 offset:3072
  s_waitcnt lgkmcnt(6)
  v_mfma_f32_16x16x32_bf16 v[124:127], v[96:99], v[108:111], v[124:127]
  ds_read_b128 v[80:83], v9 offset:4096
  s_waitcnt lgkmcnt(6)
  v_mfma_f32_16x16x32_bf16 v[128:131], v[100:103], v[108:111], v[128:131]
  ds_read_b128 v[108:111], v8 offset:4096
  ds_read_b128 v[84:87], v9 offset:5120
  s_waitcnt lgkmcnt(6)
  v_mfma_f32_16x16x32_bf16 v[112:115], v[64:67], v[104:107], v[112:115]
  ds_read_b128 v[88:91], v9 offset:6144
  s_waitcnt lgkmcnt(6)
  v_mfma_f32_16x16x32_bf16 v[116:119], v[68:71], v[104:107], v[116:119]
  ds_read_b128 v[92:95], v9 offset:7168
  s_waitcnt lgkmcnt(6)
  v_mfma_f32_16x16x32_bf16 v[120:123], v[72:75], v[104:107], v[120:123]
  ds_read_b128 v[96:99], v9 offset:8192
  s_waitcnt lgkmcnt(6)
  v_mfma_f32_16x16x32_bf16 v[124:127], v[76:79], v[104:107], v[124:127]
  ds_read_b128 v[100:103], v9 offset:9216
  s_waitcnt lgkmcnt(6)
  v_mfma_f32_16x16x32_bf16 v[128:131], v[80:83], v[104:107], v[128:131]
  s_barrier
  v_add_u32 v8, 18432, v8
  v_add_u32 v9, 18432, v9
  ds_read_b128 v[104:107], v8 offset:0
  ds_read_b128 v[64:67], v9 offset:0
  s_waitcnt lgkmcnt(6)
  v_mfma_f32_16x16x32_bf16 v[112:115], v[84:87], v[108:111], v[112:115]
  ds_read_b128 v[68:71], v9 offset:1024
  s_waitcnt lgkmcnt(6)
  v_mfma_f32_16x16x32_bf16 v[116:119], v[88:91], v[108:111], v[116:119]
  ds_read_b128 v[72:75], v9 offset:2048
  s_waitcnt lgkmcnt(6)
  v_mfma_f32_16x16x32_bf16 v[120:123], v[92:95], v[108:111], v[120:123]
  ds_read_b128 v[76:79], v9 offset:3072
  s_waitcnt lgkmcnt(6)
  v_mfma_f32_16x16x32_bf16 v[124:127], v[96:99], v[108:111], v[124:127]
  ds_read_b128 v[80:83], v9 offset:4096
  s_waitcnt lgkmcnt(6)
  v_mfma_f32_16x16x32_bf16 v[128:131], v[100:103], v[108:111], v[128:131]
  ds_read_b128 v[108:111], v8 offset:4096
  ds_read_b128 v[84:87], v9 offset:5120
  s_waitcnt lgkmcnt(6)
  v_mfma_f32_16x16x32_bf16 v[112:115], v[64:67], v[104:107], v[112:115]
  ds_read_b128 v[88:91], v9 offset:6144
  s_waitcnt lgkmcnt(6)
  v_mfma_f32_16x16x32_bf16 v[116:119], v[68:71], v[104:107], v[116:119]
  ds_read_b128 v[92:95], v9 offset:7168
  s_waitcnt lgkmcnt(6)
  v_mfma_f32_16x16x32_bf16 v[120:123], v[72:75], v[104:107], v[120:123]
  ds_read_b128 v[96:99], v9 offset:8192
  s_waitcnt lgkmcnt(6)
  v_mfma_f32_16x16x32_bf16 v[124:127], v[76:79], v[104:107], v[124:127]
  ds_read_b128 v[100:103], v9 offset:9216
  s_waitcnt lgkmcnt(6)
  v_mfma_f32_16x16x32_bf16 v[128:131], v[80:83], v[104:107], v[128:131]
  s_barrier
  v_add_u32 v8, 18432, v8
  v_add_u32 v9, 18432, v9
  ds_read_b128 v[104:107], v8 offset:0
  ds_read_b128 v[64:67], v9 offset:0
  s_waitcnt lgkmcnt(6)
  v_mfma_f32_16x16x32_bf16 v[112:115], v[84:87], v[108:111], v[112:115]
  ds_read_b128 v[68:71], v9 offset:1024
  s_waitcnt lgkmcnt(6)
  v_mfma_f32_16x16x32_bf16 v[116:119], v[88:91], v[108:111], v[116:119]
  ds_read_b128 v[72:75], v9 offset:2048
  s_waitcnt lgkmcnt(6)
  v_mfma_f32_16x16x32_bf16 v[120:123], v[92:95], v[108:111], v[120:123]
  ds_read_b128 v[76:79], v9 offset:3072
  s_waitcnt lgkmcnt(6)
  v_mfma_f32_16x16x32_bf16 v[124:127], v[96:99], v[108:111], v[124:127]
  ds_read_b128 v[80:83], v9 offset:4096
  s_waitcnt lgkmcnt(6)
  v_mfma_f32_16x16x32_bf16 v[128:131], v[100:103], v[108:111], v[128:131]
  ds_read_b128 v[108:111], v8 offset:4096
  ds_read_b128 v[84:87], v9 offset:5120
  s_waitcnt lgkmcnt(6)
  v_mfma_f32_16x16x32_bf16 v[112:115], v[64:67], v[104:107], v[112:115]
  ds_read_b128 v[88:91], v9 offset:6144
  s_waitcnt lgkmcnt(6)
  v_mfma_f32_16x16x32_bf16 v[116:119], v[68:71], v[104:107], v[116:119]
  ds_read_b128 v[92:95], v9 offset:7168
  s_waitcnt lgkmcnt(6)
  v_mfma_f32_16x16x32_bf16 v[120:123], v[72:75], v[104:107], v[120:123]
  ds_read_b128 v[96:99], v9 offset:8192
  s_waitcnt lgkmcnt(6)
  v_mfma_f32_16x16x32_bf16 v[124:127], v[76:79], v[104:107], v[124:127]
  ds_read_b128 v[100:103], v9 offset:9216
  s_waitcnt lgkmcnt(6)
  v_mfma_f32_16x16x32_bf16 v[128:131], v[80:83], v[104:107], v[128:131]
  s_barrier
  v_add_u32 v8, 18432, v8
  v_add_u32 v9, 18432, v9
  ds_read_b128 v[104:107], v8 offset:0
  ds_read_b128 v[64:67], v9 offset:0
  s_waitcnt lgkmcnt(6)
  v_mfma_f32_16x16x32_bf16 v[112:115], v[84:87], v[108:111], v[112:115]
  ds_read_b128 v[68:71], v9 offset:1024
  s_waitcnt lgkmcnt(6)
  v_mfma_f32_16x16x32_bf16 v[116:119], v[88:91], v[108:111], v[116:119]
  ds_read_b128 v[72:75], v9 offset:2048
  s_waitcnt lgkmcnt(6)
  v_mfma_f32_16x16x32_bf16 v[120:123], v[92:95], v[108:111], v[120:123]
  ds_read_b128 v[76:79], v9 offset:3072
  s_waitcnt lgkmcnt(6)
  v_mfma_f32_16x16x32_bf16 v[124:127], v[96:99], v[108:111], v[124:127]
  ds_read_b128 v[80:83], v9 offset:4096
  s_waitcnt lgkmcnt(6)
  v_mfma_f32_16x16x32_bf16 v[128:131], v[100:103], v[108:111], v[128:131]
  ds_read_b128 v[108:111], v8 offset:4096
  ds_read_b128 v[84:87], v9 offset:5120
  s_waitcnt lgkmcnt(6)
  v_mfma_f32_16x16x32_bf16 v[112:115], v[64:67], v[104:107], v[112:115]
  ds_read_b128 v[88:91], v9 offset:6144
  s_waitcnt lgkmcnt(6)
  v_mfma_f32_16x16x32_bf16 v[116:119], v[68:71], v[104:107], v[116:119]
  ds_read_b128 v[92:95], v9 offset:7168
  s_waitcnt lgkmcnt(6)
  v_mfma_f32_16x16x32_bf16 v[120:123], v[72:75], v[104:107], v[120:123]
  ds_read_b128 v[96:99], v9 offset:8192
  s_waitcnt lgkmcnt(6)
  v_mfma_f32_16x16x32_bf16 v[124:127], v[76:79], v[104:107], v[124:127]
  ds_read_b128 v[100:103], v9 offset:9216
  s_waitcnt lgkmcnt(6)
  v_mfma_f32_16x16x32_bf16 v[128:131], v[80:83], v[104:107], v[128:131]
  s_barrier
  v_add_u32 v8, 0xfffe5000, v8
  v_add_u32 v9, 0xfffe5000, v9
  ds_read_b128 v[104:107], v8 offset:0
  ds_read_b128 v[64:67], v9 offset:0
  s_waitcnt lgkmcnt(6)
  v_mfma_f32_16x16x32_bf16 v[112:115], v[84:87], v[108:111], v[112:115]
  ds_read_b128 v[68:71], v9 offset:1024
  s_waitcnt lgkmcnt(6)
  v_mfma_f32_16x16x32_bf16 v[116:119], v[88:91], v[108:111], v[116:119]
  ds_read_b128 v[72:75], v9 offset:2048
  s_waitcnt lgkmcnt(6)
  v_mfma_f32_16x16x32_bf16 v[120:123], v[92:95], v[108:111], v[120:123]
  ds_read_b128 v[76:79], v9 offset:3072
  s_waitcnt lgkmcnt(6)
  v_mfma_f32_16x16x32_bf16 v[124:127], v[96:99], v[108:111], v[124:127]
  ds_read_b128 v[80:83], v9 offset:4096
  s_waitcnt lgkmcnt(6)
  v_mfma_f32_16x16x32_bf16 v[128:131], v[100:103], v[108:111], v[128:131]
  ds_read_b128 v[108:111], v8 offset:4096
  ds_read_b128 v[84:87], v9 offset:5120
  s_waitcnt lgkmcnt(6)
  v_mfma_f32_16x16x32_bf16 v[112:115], v[64:67], v[104:107], v[112:115]
  ds_read_b128 v[88:91], v9 offset:6144
  s_waitcnt lgkmcnt(6)
  v_mfma_f32_16x16x32_bf16 v[116:119], v[68:71], v[104:107], v[116:119]
  ds_read_b128 v[92:95], v9 offset:7168
  s_waitcnt lgkmcnt(6)
  v_mfma_f32_16x16x32_bf16 v[120:123], v[72:75], v[104:107], v[120:123]
  ds_read_b128 v[96:99], v9 offset:8192
  s_waitcnt lgkmcnt(6)
  v_mfma_f32_16x16x32_bf16 v[124:127], v[76:79], v[104:107], v[124:127]
  ds_read_b128 v[100:103], v9 offset:9216
  s_waitcnt lgkmcnt(6)
  v_mfma_f32_16x16x32_bf16 v[128:131], v[80:83], v[104:107], v[128:131]
  s_barrier
  v_add_u32 v8, 18432, v8
  v_add_u32 v9, 18432, v9
  ds_read_b128 v[104:107], v8 offset:0
  ds_read_b128 v[64:67], v9 offset:0
  s_waitcnt lgkmcnt(6)
  v_mfma_f32_16x16x32_bf16 v[112:115], v[84:87], v[108:111], v[112:115]
  ds_read_b128 v[68:71], v9 offset:1024
  s_waitcnt lgkmcnt(6)
  v_mfma_f32_16x16x32_bf16 v[116:119], v[88:91], v[108:111], v[116:119]
  ds_read_b128 v[72:75], v9 offset:2048
  s_waitcnt lgkmcnt(6)
  v_mfma_f32_16x16x32_bf16 v[120:123], v[92:95], v[108:111], v[120:123]
  ds_read_b128 v[76:79], v9 offset:3072
  s_waitcnt lgkmcnt(6)
  v_mfma_f32_16x16x32_bf16 v[124:127], v[96:99], v[108:111], v[124:127]
  ds_read_b128 v[80:83], v9 offset:4096
  s_waitcnt lgkmcnt(6)
  v_mfma_f32_16x16x32_bf16 v[128:131], v[100:103], v[108:111], v[128:131]
  ds_read_b128 v[108:111], v8 offset:4096
  ds_read_b128 v[84:87], v9 offset:5120
  s_waitcnt lgkmcnt(6)
  v_mfma_f32_16x16x32_bf16 v[112:115], v[64:67], v[104:107], v[112:115]
  ds_read_b128 v[88:91], v9 offset:6144
  s_waitcnt lgkmcnt(6)
  v_mfma_f32_16x16x32_bf16 v[116:119], v[68:71], v[104:107], v[116:119]
  ds_read_b128 v[92:95], v9 offset:7168
  s_waitcnt lgkmcnt(6)
  v_mfma_f32_16x16x32_bf16 v[120:123], v[72:75], v[104:107], v[120:123]
  ds_read_b128 v[96:99], v9 offset:8192
  s_waitcnt lgkmcnt(6)
  v_mfma_f32_16x16x32_bf16 v[124:127], v[76:79], v[104:107], v[124:127]
  ds_read_b128 v[100:103], v9 offset:9216
  s_waitcnt lgkmcnt(6)
  v_mfma_f32_16x16x32_bf16 v[128:131], v[80:83], v[104:107], v[128:131]
  s_waitcnt lgkmcnt(4)
  v_mfma_f32_16x16x32_bf16 v[112:115], v[84:87], v[108:111], v[112:115]
  s_waitcnt lgkmcnt(3)
  v_mfma_f32_16x16x32_bf16 v[116:119], v[88:91], v[108:111], v[116:119]
  s_waitcnt lgkmcnt(2)
  v_mfma_f32_16x16x32_bf16 v[120:123], v[92:95], v[108:111], v[120:123]
  s_waitcnt lgkmcnt(1)
  v_mfma_f32_16x16x32_bf16 v[124:127], v[96:99], v[108:111], v[124:127]
  s_waitcnt lgkmcnt(0)
  v_mfma_f32_16x16x32_bf16 v[128:131], v[100:103], v[108:111], v[128:131]
  v_mul_u32_u24 v5, 1280, v4
  v_lshl_add_u32 v5, v3, 3, v5
  s_mul_i32 s12, s75, 160
  v_add_u32 v5, s12, v5
  s_waitcnt vmcnt(0)
  s_nop 5
  v_cvt_pk_bf16_f32 v160, v112, v113
  v_cvt_pk_bf16_f32 v161, v114, v115
  v_cvt_pk_bf16_f32 v162, v132, v133
  v_cvt_pk_bf16_f32 v163, v134, v135
  v_lshlrev_b32 v164, 16, v160
  v_and_b32 v165, 0xffff0000, v160
  v_lshlrev_b32 v166, 16, v161
  v_and_b32 v167, 0xffff0000, v161
  v_lshlrev_b32 v168, 16, v162
  v_and_b32 v169, 0xffff0000, v162
  v_lshlrev_b32 v170, 16, v163
  v_and_b32 v171, 0xffff0000, v163
  v_lshlrev_b32 v172, 16, v240
  v_and_b32 v173, 0xffff0000, v240
  v_lshlrev_b32 v174, 16, v241
  v_and_b32 v175, 0xffff0000, v241
  v_pk_add_f32 v[168:169], v[168:169], v[172:173]
  v_pk_add_f32 v[170:171], v[170:171], v[174:175]
  v_mul_f32 v164, v56, v164
  v_mul_f32 v165, v56, v165
  v_mul_f32 v166, v56, v166
  v_mul_f32 v167, v56, v167
  v_cvt_pk_bf16_f32 v162, v168, v169
  v_cvt_pk_bf16_f32 v163, v170, v171
  v_cvt_pk_bf16_f32 v160, v164, v165
  v_cvt_pk_bf16_f32 v161, v166, v167
  v_lshlrev_b32 v168, 16, v162
  v_and_b32 v169, 0xffff0000, v162
  v_lshlrev_b32 v170, 16, v163
  v_and_b32 v171, 0xffff0000, v163
  v_lshlrev_b32 v164, 16, v160
  v_and_b32 v165, 0xffff0000, v160
  v_lshlrev_b32 v166, 16, v161
  v_and_b32 v167, 0xffff0000, v161
  v_mul_f32 v168, v57, v168
  v_mul_f32 v169, v57, v169
  v_mul_f32 v170, v57, v170
  v_mul_f32 v171, v57, v171
  v_cvt_pk_bf16_f32 v162, v168, v169
  v_cvt_pk_bf16_f32 v163, v170, v171
  v_lshlrev_b32 v168, 16, v162
  v_and_b32 v169, 0xffff0000, v162
  v_lshlrev_b32 v170, 16, v163
  v_and_b32 v171, 0xffff0000, v163
  v_pk_add_f32 v[164:165], v[164:165], v[168:169]
  v_pk_add_f32 v[166:167], v[166:167], v[170:171]
  v_cvt_pk_bf16_f32 v180, v164, v165
  v_cvt_pk_bf16_f32 v181, v166, v167
  buffer_store_dwordx2 v[180:181], v5, s[56:59], 0 offen offset:0
  v_cvt_pk_bf16_f32 v160, v116, v117
  v_cvt_pk_bf16_f32 v161, v118, v119
  v_cvt_pk_bf16_f32 v162, v136, v137
  v_cvt_pk_bf16_f32 v163, v138, v139
  v_lshlrev_b32 v164, 16, v160
  v_and_b32 v165, 0xffff0000, v160
  v_lshlrev_b32 v166, 16, v161
  v_and_b32 v167, 0xffff0000, v161
  v_lshlrev_b32 v168, 16, v162
  v_and_b32 v169, 0xffff0000, v162
  v_lshlrev_b32 v170, 16, v163
  v_and_b32 v171, 0xffff0000, v163
  v_lshlrev_b32 v172, 16, v242
  v_and_b32 v173, 0xffff0000, v242
  v_lshlrev_b32 v174, 16, v243
  v_and_b32 v175, 0xffff0000, v243
  v_pk_add_f32 v[168:169], v[168:169], v[172:173]
  v_pk_add_f32 v[170:171], v[170:171], v[174:175]
  v_mul_f32 v164, v56, v164
  v_mul_f32 v165, v56, v165
  v_mul_f32 v166, v56, v166
  v_mul_f32 v167, v56, v167
  v_cvt_pk_bf16_f32 v162, v168, v169
  v_cvt_pk_bf16_f32 v163, v170, v171
  v_cvt_pk_bf16_f32 v160, v164, v165
  v_cvt_pk_bf16_f32 v161, v166, v167
  v_lshlrev_b32 v168, 16, v162
  v_and_b32 v169, 0xffff0000, v162
  v_lshlrev_b32 v170, 16, v163
  v_and_b32 v171, 0xffff0000, v163
  v_lshlrev_b32 v164, 16, v160
  v_and_b32 v165, 0xffff0000, v160
  v_lshlrev_b32 v166, 16, v161
  v_and_b32 v167, 0xffff0000, v161
  v_mul_f32 v168, v57, v168
  v_mul_f32 v169, v57, v169
  v_mul_f32 v170, v57, v170
  v_mul_f32 v171, v57, v171
  v_cvt_pk_bf16_f32 v162, v168, v169
  v_cvt_pk_bf16_f32 v163, v170, v171
  v_lshlrev_b32 v168, 16, v162
  v_and_b32 v169, 0xffff0000, v162
  v_lshlrev_b32 v170, 16, v163
  v_and_b32 v171, 0xffff0000, v163
  v_pk_add_f32 v[164:165], v[164:165], v[168:169]
  v_pk_add_f32 v[166:167], v[166:167], v[170:171]
  v_cvt_pk_bf16_f32 v182, v164, v165
  v_cvt_pk_bf16_f32 v183, v166, v167
  buffer_store_dwordx2 v[182:183], v5, s[56:59], 0 offen offset:32
  v_cvt_pk_bf16_f32 v160, v120, v121
  v_cvt_pk_bf16_f32 v161, v122, v123
  v_cvt_pk_bf16_f32 v162, v140, v141
  v_cvt_pk_bf16_f32 v163, v142, v143
  v_lshlrev_b32 v164, 16, v160
  v_and_b32 v165, 0xffff0000, v160
  v_lshlrev_b32 v166, 16, v161
  v_and_b32 v167, 0xffff0000, v161
  v_lshlrev_b32 v168, 16, v162
  v_and_b32 v169, 0xffff0000, v162
  v_lshlrev_b32 v170, 16, v163
  v_and_b32 v171, 0xffff0000, v163
  v_lshlrev_b32 v172, 16, v244
  v_and_b32 v173, 0xffff0000, v244
  v_lshlrev_b32 v174, 16, v245
  v_and_b32 v175, 0xffff0000, v245
  v_pk_add_f32 v[168:169], v[168:169], v[172:173]
  v_pk_add_f32 v[170:171], v[170:171], v[174:175]
  v_mul_f32 v164, v56, v164
  v_mul_f32 v165, v56, v165
  v_mul_f32 v166, v56, v166
  v_mul_f32 v167, v56, v167
  v_cvt_pk_bf16_f32 v162, v168, v169
  v_cvt_pk_bf16_f32 v163, v170, v171
  v_cvt_pk_bf16_f32 v160, v164, v165
  v_cvt_pk_bf16_f32 v161, v166, v167
  v_lshlrev_b32 v168, 16, v162
  v_and_b32 v169, 0xffff0000, v162
  v_lshlrev_b32 v170, 16, v163
  v_and_b32 v171, 0xffff0000, v163
  v_lshlrev_b32 v164, 16, v160
  v_and_b32 v165, 0xffff0000, v160
  v_lshlrev_b32 v166, 16, v161
  v_and_b32 v167, 0xffff0000, v161
  v_mul_f32 v168, v57, v168
  v_mul_f32 v169, v57, v169
  v_mul_f32 v170, v57, v170
  v_mul_f32 v171, v57, v171
  v_cvt_pk_bf16_f32 v162, v168, v169
  v_cvt_pk_bf16_f32 v163, v170, v171
  v_lshlrev_b32 v168, 16, v162
  v_and_b32 v169, 0xffff0000, v162
  v_lshlrev_b32 v170, 16, v163
  v_and_b32 v171, 0xffff0000, v163
  v_pk_add_f32 v[164:165], v[164:165], v[168:169]
  v_pk_add_f32 v[166:167], v[166:167], v[170:171]
  v_cvt_pk_bf16_f32 v184, v164, v165
  v_cvt_pk_bf16_f32 v185, v166, v167
  buffer_store_dwordx2 v[184:185], v5, s[56:59], 0 offen offset:64
  v_cvt_pk_bf16_f32 v160, v124, v125
  v_cvt_pk_bf16_f32 v161, v126, v127
  v_cvt_pk_bf16_f32 v162, v144, v145
  v_cvt_pk_bf16_f32 v163, v146, v147
  v_lshlrev_b32 v164, 16, v160
  v_and_b32 v165, 0xffff0000, v160
  v_lshlrev_b32 v166, 16, v161
  v_and_b32 v167, 0xffff0000, v161
  v_lshlrev_b32 v168, 16, v162
  v_and_b32 v169, 0xffff0000, v162
  v_lshlrev_b32 v170, 16, v163
  v_and_b32 v171, 0xffff0000, v163
  v_lshlrev_b32 v172, 16, v246
  v_and_b32 v173, 0xffff0000, v246
  v_lshlrev_b32 v174, 16, v247
  v_and_b32 v175, 0xffff0000, v247
  v_pk_add_f32 v[168:169], v[168:169], v[172:173]
  v_pk_add_f32 v[170:171], v[170:171], v[174:175]
  v_mul_f32 v164, v56, v164
  v_mul_f32 v165, v56, v165
  v_mul_f32 v166, v56, v166
  v_mul_f32 v167, v56, v167
  v_cvt_pk_bf16_f32 v162, v168, v169
  v_cvt_pk_bf16_f32 v163, v170, v171
  v_cvt_pk_bf16_f32 v160, v164, v165
  v_cvt_pk_bf16_f32 v161, v166, v167
  v_lshlrev_b32 v168, 16, v162
  v_and_b32 v169, 0xffff0000, v162
  v_lshlrev_b32 v170, 16, v163
  v_and_b32 v171, 0xffff0000, v163
  v_lshlrev_b32 v164, 16, v160
  v_and_b32 v165, 0xffff0000, v160
  v_lshlrev_b32 v166, 16, v161
  v_and_b32 v167, 0xffff0000, v161
  v_mul_f32 v168, v57, v168
  v_mul_f32 v169, v57, v169
  v_mul_f32 v170, v57, v170
  v_mul_f32 v171, v57, v171
  v_cvt_pk_bf16_f32 v162, v168, v169
  v_cvt_pk_bf16_f32 v163, v170, v171
  v_lshlrev_b32 v168, 16, v162
  v_and_b32 v169, 0xffff0000, v162
  v_lshlrev_b32 v170, 16, v163
  v_and_b32 v171, 0xffff0000, v163
  v_pk_add_f32 v[164:165], v[164:165], v[168:169]
  v_pk_add_f32 v[166:167], v[166:167], v[170:171]
  v_cvt_pk_bf16_f32 v186, v164, v165
  v_cvt_pk_bf16_f32 v187, v166, v167
  buffer_store_dwordx2 v[186:187], v5, s[56:59], 0 offen offset:96
  v_cvt_pk_bf16_f32 v160, v128, v129
  v_cvt_pk_bf16_f32 v161, v130, v131
  v_cvt_pk_bf16_f32 v162, v148, v149
  v_cvt_pk_bf16_f32 v163, v150, v151
  v_lshlrev_b32 v164, 16, v160
  v_and_b32 v165, 0xffff0000, v160
  v_lshlrev_b32 v166, 16, v161
  v_and_b32 v167, 0xffff0000, v161
  v_lshlrev_b32 v168, 16, v162
  v_and_b32 v169, 0xffff0000, v162
  v_lshlrev_b32 v170, 16, v163
  v_and_b32 v171, 0xffff0000, v163
  v_lshlrev_b32 v172, 16, v248
  v_and_b32 v173, 0xffff0000, v248
  v_lshlrev_b32 v174, 16, v249
  v_and_b32 v175, 0xffff0000, v249
  v_pk_add_f32 v[168:169], v[168:169], v[172:173]
  v_pk_add_f32 v[170:171], v[170:171], v[174:175]
  v_mul_f32 v164, v56, v164
  v_mul_f32 v165, v56, v165
  v_mul_f32 v166, v56, v166
  v_mul_f32 v167, v56, v167
  v_cvt_pk_bf16_f32 v162, v168, v169
  v_cvt_pk_bf16_f32 v163, v170, v171
  v_cvt_pk_bf16_f32 v160, v164, v165
  v_cvt_pk_bf16_f32 v161, v166, v167
  v_lshlrev_b32 v168, 16, v162
  v_and_b32 v169, 0xffff0000, v162
  v_lshlrev_b32 v170, 16, v163
  v_and_b32 v171, 0xffff0000, v163
  v_lshlrev_b32 v164, 16, v160
  v_and_b32 v165, 0xffff0000, v160
  v_lshlrev_b32 v166, 16, v161
  v_and_b32 v167, 0xffff0000, v161
  v_mul_f32 v168, v57, v168
  v_mul_f32 v169, v57, v169
  v_mul_f32 v170, v57, v170
  v_mul_f32 v171, v57, v171
  v_cvt_pk_bf16_f32 v162, v168, v169
  v_cvt_pk_bf16_f32 v163, v170, v171
  v_lshlrev_b32 v168, 16, v162
  v_and_b32 v169, 0xffff0000, v162
  v_lshlrev_b32 v170, 16, v163
  v_and_b32 v171, 0xffff0000, v163
  v_pk_add_f32 v[164:165], v[164:165], v[168:169]
  v_pk_add_f32 v[166:167], v[166:167], v[170:171]
  v_cvt_pk_bf16_f32 v188, v164, v165
  v_cvt_pk_bf16_f32 v189, v166, v167
  buffer_store_dwordx2 v[188:189], v5, s[56:59], 0 offen offset:128
f_exit:
  s_endpgm
f_code_end:
.section .rodata,"a"
.p2align 6
.amdhsa_kernel fused_kernel
  .amdhsa_next_free_vgpr 256
  .amdhsa_next_free_sgpr 102
  .amdhsa_accum_offset 256
  .amdhsa_group_segment_fixed_size 0
  .amdhsa_kernarg_size 96
  .amdhsa_user_sgpr_count 2
  .amdhsa_user_sgpr_kernarg_segment_ptr 1
  .amdhsa_system_sgpr_workgroup_id_x 1
.end_amdhsa_kernel
```
